```python
import torch

def _softmax(x, axis=-1):
    return torch.softmax(x, dim=axis)
def _gelu(x):
    return torch.nn.functional.gelu(x, approximate="tanh")
def _silu(x):
    return torch.nn.functional.silu(x)
def _sigmoid(x):
    return torch.sigmoid(x)
def _layernorm(x, axis=-1, eps=1e-5):
    m = x.mean(dim=axis, keepdim=True)
    v = x.var(dim=axis, keepdim=True, unbiased=False)
    return (x - m) / torch.sqrt(v + eps)
def _scatter_add(tgt, idx, src, axis=0):
    return tgt.clone().index_add_(axis, idx, src)
def _segment_sum(src, seg, n):
    out = torch.zeros((n,) + src.shape[1:], dtype=src.dtype)
    return out.index_add_(0, seg, src)
def _pad(x, pw):
    flat = tuple(v for pair in reversed(pw) for v in pair)
    return torch.nn.functional.pad(x, flat)

kernel_name = 'interleave_layers__spectral_gfnet__softmax_full_mha__prompt'

def setup_inputs():

    _w = (lambda a: (lambda t: t.to(torch.bfloat16) if t.is_floating_point() else t)(torch.as_tensor(a)))
    def _A_setup():
        B, S, D = 1, 2048, 512
        Df = D // 2 + 1
        return {
            "x": _w((lambda *s: torch.randn(*s, dtype=torch.bfloat16) * 0.05)(B, S, D)),
            "w_r": _w((lambda *s: torch.randn(*s, dtype=torch.bfloat16) * 0.8)(S, Df) * 0.02),
            "w_i": _w((lambda *s: torch.randn(*s, dtype=torch.bfloat16) * 0.8)(S, Df) * 0.02),
        }
    _A_in = _A_setup()

    def _B_setup():
        B, S, D = 1, 2048, 512
        return {
            "x": _w((lambda *s: torch.randn(*s, dtype=torch.bfloat16) * 0.05)(B, S, D)),
            "wqkv": _w((lambda *s: torch.randn(*s, dtype=torch.bfloat16) * 0.05)(D, 3 * D)),
            "wo": _w((lambda *s: torch.randn(*s, dtype=torch.bfloat16) * 0.05)(D, D)),
        }
    _B_in = _B_setup()

    return {
        "A_x": _A_in["x"],
        "A_w_r": _A_in["w_r"],
        "A_w_i": _A_in["w_i"],
        "B_x": _B_in["x"],
        "B_wqkv": _B_in["wqkv"],
        "B_wo": _B_in["wo"],
    }

def reference(A_x, A_w_r, A_w_i, B_x, B_wqkv, B_wo):
    def _A_ref(x, w_r, w_i):
        B, S, D = x.shape
        X = (lambda x, axes=(-2,-1): torch.fft.rfft2(x.float(), dim=axes))(x, axes=(-2, -1))
        W = w_r + 1j * w_i
        X = X * W
        y = (lambda x, s, axes=(-2,-1): torch.fft.irfft2(x, s=s, dim=axes).to(torch.bfloat16))(X, (S, D), axes=(-2, -1))
        return y

    def _B_ref(x, wqkv, wo):
        B, S, D = x.shape
        H = 32; Dh = D // H
        qkv = (lambda x, *d: x.permute(*d))((x @ wqkv).reshape(B, S, 3, H, Dh), 2, 0, 3, 1, 4)
        q, k, v = qkv[0], qkv[1], qkv[2]
        scale = Dh ** -0.5
        scores = torch.einsum("bhqd,bhkd->bhqk", q, k) * scale
        p = _softmax(scores, axis=-1)
        o = torch.einsum("bhqk,bhkd->bhqd", p, v)
        return (lambda x, *d: x.permute(*d))(o, 0, 2, 1, 3).reshape(B, S, D) @ wo

    x = A_x
    x = x + _A_ref(_layernorm(x, axis=-1), A_w_r, A_w_i)
    x = x + _B_ref(_layernorm(x, axis=-1), B_wqkv, B_wo)
    x = x + _A_ref(_layernorm(x, axis=-1), A_w_r, A_w_i)
    x = x + _B_ref(_layernorm(x, axis=-1), B_wqkv, B_wo)
    return x
```

```asm
; @launch grid=(256,1,1) block=(512,1,1) lds=163840
.amdgcn_target "amdgcn-amd-amdhsa--gfx950"
.text
.globl interleave_layers__spectral_gfnet__softmax_full_mha__prompt_kernel
.p2align 8
.type interleave_layers__spectral_gfnet__softmax_full_mha__prompt_kernel,@function
interleave_layers__spectral_gfnet__softmax_full_mha__prompt_kernel:
    s_cmp_ge_u32 s2, 256
    s_cbranch_scc1 main_done
    s_load_dwordx16 s[24:39], s[0:1], 0
    s_load_dwordx2 s[4:5], s[0:1], 64
    v_and_b32 v1, 63, v0
    v_lshrrev_b32 v2, 6, v0
    s_nop 0
    v_readfirstlane_b32 s20, v2
    s_cmp_ge_u32 s2, 32
    s_cbranch_scc1 no_pf
    s_getpc_b64 s[6:7]
pf_here:
    s_lshl_b32 s22, s20, 13
    v_lshl_add_u32 v6, v1, 7, s22
    v_min_u32 v6, code_end-interleave_layers__spectral_gfnet__softmax_full_mha__prompt_kernel-4, v6
    s_sub_u32 s6, s6, pf_here-interleave_layers__spectral_gfnet__softmax_full_mha__prompt_kernel
    s_subb_u32 s7, s7, 0
    v_mov_b32 v7, s7
    v_add_co_u32 v6, vcc, s6, v6
    s_nop 1
    v_addc_co_u32 v7, vcc, 0, v7, vcc
    global_load_dword v15, v[6:7], off
no_pf:
    s_mov_b32 s21, 0
    s_and_b32 s3, s20, 3
    v_and_b32 v3, 31, v1
    v_lshrrev_b32 v4, 5, v1
    v_lshlrev_b32 v5, 4, v1
    v_mov_b32 v248, 151296
    v_mov_b32 v11, 0
    v_mov_b32 v252, 0
    v_mov_b32 v253, 0
    v_mov_b32 v254, 0
    v_mov_b32 v255, 0
    ds_write_b128 v248, v[252:255]
    s_mov_b32 s44, 0
    s_mov_b32 s45, 0
    s_mov_b32 s46, 3932160
    s_mov_b32 s48, 4194304
    s_mov_b32 s49, 10485760
    s_mov_b32 s50, 3997696
    s_and_b32 s22, s2, 7
    s_lshr_b32 s23, s2, 3
    s_lshr_b32 s40, s23, 3
    s_mov_b32 s47, 4
    s_cmp_lt_u32 s40, 2
    s_cselect_b32 s47, 6, s47
    s_cmp_eq_u32 s40, 3
    s_cselect_b32 s47, 8, s47
    s_add_u32 s41, s47, 4
    s_cmp_lt_u32 s23, 12
    s_cselect_b32 s47, s41, s47
    s_waitcnt lgkmcnt(0)
    s_barrier
    s_mov_b32 s8, s4
    s_and_b32 s9, s5, 0xffff
    s_mov_b32 s10, 32505856
    s_mov_b32 s11, 0x20000
    s_mov_b32 s12, s24
    s_and_b32 s13, s25, 0xffff
    s_mov_b32 s14, 2097152
    s_mov_b32 s15, 0x20000
    s_mov_b32 s16, s36
    s_and_b32 s17, s37, 0xffff
    s_mov_b32 s18, 2097152
    s_mov_b32 s19, 0x20000
    s_cmp_ge_u32 s20, 4
    s_cbranch_scc1 p0_b
    s_setprio 3
    s_mov_b32 s53, 0
    s_lshl_b32 s51, s22, 3
    s_and_b32 s41, s23, 7
    s_add_u32 s51, s51, s41
    s_mov_b32 s52, s40
    v_mul_u32_u24 v12, 1040, v3
    v_lshl_add_u32 v12, v4, 4, v12
    s_xor_b32 s55, s3, 3
    s_or_b32 s55, s2, s55
    s_cmp_lg_u32 s55, 0
    s_cbranch_scc1 p0_gen
    v_lshrrev_b32 v6, 2, v1
    v_lshlrev_b32 v6, 8, v6
    v_and_b32 v7, 3, v1
    v_lshl_add_u32 v6, v7, 4, v6
    s_add_u32 s41, s50, 32768
    buffer_store_dwordx4 v[252:255], v6, s[8:11], s41 offen sc1
    s_add_u32 s41, s50, 36864
    buffer_store_dwordx4 v[252:255], v6, s[8:11], s41 offen sc1
    s_add_u32 s41, s50, 40960
    buffer_store_dwordx4 v[252:255], v6, s[8:11], s41 offen sc1
    s_add_u32 s41, s50, 49152
    buffer_store_dwordx4 v[252:255], v6, s[8:11], s41 offen sc1
    s_add_u32 s41, s50, 53248
    buffer_store_dwordx4 v[252:255], v6, s[8:11], s41 offen sc1
    s_add_u32 s41, s50, 57344
    buffer_store_dwordx4 v[252:255], v6, s[8:11], s41 offen sc1
    s_add_u32 s41, s50, 0
    buffer_store_dwordx4 v[252:255], v6, s[8:11], s41 offen sc1
    s_add_u32 s41, s50, 4096
    buffer_store_dwordx4 v[252:255], v6, s[8:11], s41 offen sc1
    s_add_u32 s41, s50, 8192
    buffer_store_dwordx4 v[252:255], v6, s[8:11], s41 offen sc1
    s_add_u32 s41, s50, 16384
    buffer_store_dwordx4 v[252:255], v6, s[8:11], s41 offen sc1
    s_add_u32 s41, s50, 20480
    buffer_store_dwordx4 v[252:255], v6, s[8:11], s41 offen sc1
    s_add_u32 s41, s50, 24576
    buffer_store_dwordx4 v[252:255], v6, s[8:11], s41 offen sc1
    s_branch p0_gen
p0_b:
    s_lshl_b32 s51, s22, 3
    s_and_b32 s41, s23, 7
    s_add_u32 s51, s51, s41
    s_and_b32 s41, s51, 1
    s_lshl_b32 s41, s41, 20
    s_lshr_b32 s42, s51, 1
    s_lshl_b32 s42, s42, 10
    s_add_u32 s41, s41, s42
    s_lshl_b32 s42, s3, 18
    s_add_u32 s41, s41, s42
    s_mul_i32 s42, s3, 8320
    s_add_u32 m0, s42, 0
    s_add_u32 s43, s41, 0
    buffer_load_dwordx4 v5, s[12:15], s43 offen lds
    s_add_u32 m0, s42, 1040
    s_add_u32 s43, s41, 32768
    buffer_load_dwordx4 v5, s[12:15], s43 offen lds
    s_add_u32 m0, s42, 2080
    s_add_u32 s43, s41, 65536
    buffer_load_dwordx4 v5, s[12:15], s43 offen lds
    s_add_u32 m0, s42, 3120
    s_add_u32 s43, s41, 98304
    buffer_load_dwordx4 v5, s[12:15], s43 offen lds
    s_add_u32 m0, s42, 4160
    s_add_u32 s43, s41, 131072
    buffer_load_dwordx4 v5, s[12:15], s43 offen lds
    s_add_u32 m0, s42, 5200
    s_add_u32 s43, s41, 163840
    buffer_load_dwordx4 v5, s[12:15], s43 offen lds
    s_add_u32 m0, s42, 6240
    s_add_u32 s43, s41, 196608
    buffer_load_dwordx4 v5, s[12:15], s43 offen lds
    s_add_u32 m0, s42, 7280
    s_add_u32 s43, s41, 229376
    buffer_load_dwordx4 v5, s[12:15], s43 offen lds
    s_cmp_ge_u32 s23, 24
    s_cbranch_scc1 p0_wt
    s_mov_b32 s56, s32
    s_and_b32 s57, s33, 0xffff
    s_mov_b32 s58, 1572864
    s_mov_b32 s59, 0x20000
    s_mov_b32 s60, s34
    s_and_b32 s61, s35, 0xffff
    s_mov_b32 s62, 524288
    s_mov_b32 s63, 0x20000
    s_mov_b32 s53, 1
    s_mul_i32 s52, s23, 43
    s_lshr_b32 s52, s52, 8
    s_mul_i32 s41, s52, 6
    s_sub_u32 s41, s23, s41
    s_mul_i32 s51, s22, 6
    s_add_u32 s51, s51, s41
    v_lshrrev_b32 v6, 2, v1
    v_mul_u32_u24 v6, 3072, v6
    v_and_b32 v7, 3, v1
    v_lshl_add_u32 v6, v7, 4, v6
    s_lshl_b32 s41, s51, 6
    s_mul_i32 s42, s3, 393216
    s_add_u32 s41, s41, s42
    s_lshl_b32 s42, s3, 13
    s_add_u32 m0, s42, 65536
    s_add_u32 s43, s41, 0
    buffer_load_dwordx4 v6, s[56:59], s43 offen lds
    s_add_u32 m0, s42, 66560
    s_add_u32 s43, s41, 49152
    buffer_load_dwordx4 v6, s[56:59], s43 offen lds
    s_add_u32 m0, s42, 67584
    s_add_u32 s43, s41, 98304
    buffer_load_dwordx4 v6, s[56:59], s43 offen lds
    s_add_u32 m0, s42, 68608
    s_add_u32 s43, s41, 147456
    buffer_load_dwordx4 v6, s[56:59], s43 offen lds
    s_add_u32 m0, s42, 69632
    s_add_u32 s43, s41, 196608
    buffer_load_dwordx4 v6, s[56:59], s43 offen lds
    s_add_u32 m0, s42, 70656
    s_add_u32 s43, s41, 245760
    buffer_load_dwordx4 v6, s[56:59], s43 offen lds
    s_add_u32 m0, s42, 71680
    s_add_u32 s43, s41, 294912
    buffer_load_dwordx4 v6, s[56:59], s43 offen lds
    s_add_u32 m0, s42, 72704
    s_add_u32 s43, s41, 344064
    buffer_load_dwordx4 v6, s[56:59], s43 offen lds
    v_and_b32 v6, 15, v1
    v_lshrrev_b32 v6, 2, v6
    v_lshl_add_u32 v6, v4, 3, v6
    v_lshlrev_b32 v12, 6, v6
    v_lshl_add_u32 v12, v7, 3, v12
    v_and_b32 v7, 16, v1
    v_lshl_add_u32 v12, v7, 1, v12
    v_add_u32 v12, 65536, v12
    s_mov_b32 s55, 4
    s_mul_i32 s31, s22, 24
    s_add_u32 s31, s31, s23
    s_lshl_b32 s31, s31, 2
    s_add_u32 s31, s31, s3
    s_waitcnt vmcnt(8)
    v_mov_b32 v248, 151296
    v_mov_b32 v249, 1
    s_waitcnt lgkmcnt(0)
    s_mov_b64 exec, 1
    ds_add_u32 v248, v249 offset:0
    s_mov_b64 exec, -1
    v_lshlrev_b32 v11, 10, v4
    v_lshl_add_u32 v11, v3, 4, v11
    s_and_b32 s30, s51, 15
    s_mul_i32 s30, s30, 98304
    s_lshr_b32 s43, s51, 4
    s_lshl_b32 s43, s43, 15
    s_add_u32 s30, s30, s43
    s_lshl_b32 s43, s52, 2
    s_add_u32 s43, s43, s3
    s_lshl_b32 s43, s43, 11
    s_add_u32 s30, s30, s43
    s_add_u32 s30, s30, 2359296
    s_cmp_ge_u32 s23, 12
    s_cbranch_scc1 p0_nowqf
    v_mov_b32 v252, -1
    v_mov_b32 v253, -1
    v_mov_b32 v254, -1
    v_mov_b32 v255, -1
    buffer_store_dwordx4 v[252:255], v11, s[8:11], s30 offen sc1
    buffer_store_dwordx4 v[252:255], v11, s[8:11], s30 offen offset:512 sc1
p0_nowqf:
    s_cmp_ge_u32 s31, 256
    s_cbranch_scc1 p0_noftw
    v_lshrrev_b32 v6, 4, v1
    v_lshrrev_b32 v7, 1, v6
    v_lshlrev_b32 v7, 14, v7
    v_and_b32 v6, 1, v6
    v_lshl_add_u32 v7, v6, 12, v7
    v_and_b32 v6, 15, v1
    v_lshl_add_u32 v7, v6, 2, v7
    s_lshr_b32 s41, s31, 4
    s_lshl_b32 s41, s41, 6
    s_and_b32 s42, s31, 15
    s_lshl_b32 s42, s42, 15
    s_add_u32 s41, s41, s42
    s_add_u32 s42, s41, 8192
    buffer_load_dword v56, v7, s[60:63], s41 offen offset:0
    buffer_load_dword v57, v7, s[60:63], s41 offen offset:1024
    buffer_load_dword v58, v7, s[60:63], s41 offen offset:2048
    buffer_load_dword v59, v7, s[60:63], s41 offen offset:3072
    buffer_load_dword v60, v7, s[60:63], s42 offen offset:0
    buffer_load_dword v61, v7, s[60:63], s42 offen offset:1024
    buffer_load_dword v62, v7, s[60:63], s42 offen offset:2048
    buffer_load_dword v63, v7, s[60:63], s42 offen offset:3072
p0_noftw:
    s_branch p0_stats
p0_wt:
    s_mov_b32 s56, s26
    s_and_b32 s57, s27, 0xffff
    s_mov_b32 s58, 1052672
    s_mov_b32 s59, 0x20000
    s_mov_b32 s60, s28
    s_and_b32 s61, s29, 0xffff
    s_mov_b32 s62, 1052672
    s_mov_b32 s63, 0x20000
    s_setprio 2
    s_sub_u32 s41, s23, 24
    s_lshl_b32 s42, s41, 2
    s_add_u32 s42, s42, s3
    s_lshl_b32 s42, s42, 3
    s_add_u32 s42, s42, s22
    s_mul_i32 s42, s42, 4112
    s_add_u32 s43, s42, 4096
    s_mul_i32 s31, s3, 10240
    s_add_u32 m0, s31, 98816
    s_nop 0
    buffer_load_dwordx4 v5, s[56:59], s42 offen offset:0 lds
    buffer_load_dwordx4 v5, s[56:59], s42 offen offset:1024 lds
    buffer_load_dwordx4 v5, s[56:59], s42 offen offset:2048 lds
    buffer_load_dwordx4 v5, s[56:59], s42 offen offset:3072 lds
    s_add_u32 m0, s31, 102912
    s_nop 0
    buffer_load_dwordx4 v5, s[56:59], s43 offen lds
    s_add_u32 m0, s31, 103936
    s_nop 0
    buffer_load_dwordx4 v5, s[60:63], s42 offen offset:0 lds
    buffer_load_dwordx4 v5, s[60:63], s42 offen offset:1024 lds
    buffer_load_dwordx4 v5, s[60:63], s42 offen offset:2048 lds
    buffer_load_dwordx4 v5, s[60:63], s42 offen offset:3072 lds
    s_add_u32 m0, s31, 108032
    s_nop 0
    buffer_load_dwordx4 v5, s[60:63], s43 offen lds
    s_mov_b32 s56, s34
    s_and_b32 s57, s35, 0xffff
    s_mov_b32 s58, 524288
    s_mov_b32 s59, 0x20000
    s_mov_b32 s53, 2
    s_and_b32 s51, s41, 1
    s_lshl_b32 s51, s51, 3
    s_add_u32 s51, s51, s22
    s_lshr_b32 s52, s41, 1
    s_lshl_b32 s42, s51, 15
    s_lshl_b32 s43, s3, 13
    s_add_u32 s42, s42, s43
    s_mul_i32 s43, s3, 8320
    s_add_u32 m0, s43, 65536
    s_add_u32 s31, s42, 0
    buffer_load_dwordx4 v5, s[56:59], s31 offen lds
    s_add_u32 m0, s43, 66576
    s_add_u32 s31, s42, 1024
    buffer_load_dwordx4 v5, s[56:59], s31 offen lds
    s_add_u32 m0, s43, 67616
    s_add_u32 s31, s42, 2048
    buffer_load_dwordx4 v5, s[56:59], s31 offen lds
    s_add_u32 m0, s43, 68656
    s_add_u32 s31, s42, 3072
    buffer_load_dwordx4 v5, s[56:59], s31 offen lds
    s_add_u32 m0, s43, 69696
    s_add_u32 s31, s42, 4096
    buffer_load_dwordx4 v5, s[56:59], s31 offen lds
    s_add_u32 m0, s43, 70736
    s_add_u32 s31, s42, 5120
    buffer_load_dwordx4 v5, s[56:59], s31 offen lds
    s_add_u32 m0, s43, 71776
    s_add_u32 s31, s42, 6144
    buffer_load_dwordx4 v5, s[56:59], s31 offen lds
    s_add_u32 m0, s43, 72816
    s_add_u32 s31, s42, 7168
    buffer_load_dwordx4 v5, s[56:59], s31 offen lds
    v_lshrrev_b32 v6, 3, v1
    v_and_b32 v7, 7, v1
    s_lshl_b32 s31, s3, 6
    v_add_u32 v8, s31, v6
    v_mul_u32_u24 v9, 514, v7
    v_add_u32 v9, 98816, v9
    v_lshl_add_u32 v10, v8, 1, v9
    v_cmp_eq_u32 vcc, 0, v8
    v_add_u32 v11, 512, v9
    s_nop 0
    v_cndmask_b32 v11, v10, v11, vcc
    s_lshr_b32 s42, s22, 1
    s_lshl_b32 s42, s42, 11
    s_and_b32 s43, s22, 1
    s_lshl_b32 s43, s43, 7
    s_add_u32 s42, s42, s43
    s_lshl_b32 s43, s41, 8
    s_add_u32 s42, s42, s43
    v_mul_u32_u24 v12, 8448, v8
    v_lshl_add_u32 v12, v7, 4, v12
    v_add_u32 v12, s42, v12
    s_waitcnt vmcnt(18)
    v_mov_b32 v248, 151296
    v_mov_b32 v249, 1
    s_waitcnt lgkmcnt(0)
    s_mov_b64 exec, 1
    ds_add_u32 v248, v249 offset:0
    s_mov_b64 exec, -1
    s_waitcnt vmcnt(8)
    v_mov_b32 v248, 151296
    v_mov_b32 v249, 1
    s_waitcnt lgkmcnt(0)
    s_mov_b64 exec, 1
    ds_add_u32 v248, v249 offset:4
    s_mov_b64 exec, -1
lw1:
    ds_read_b32 v250, v248 offset:4
    s_waitcnt lgkmcnt(0)
    v_readfirstlane_b32 s33, v250
    s_nop 0
    s_cmp_lt_u32 s33, 4
    s_cbranch_scc1 lw1
    ds_read_u16 v16, v11 offset:0
    ds_read_u16 v17, v11 offset:5120
    ds_read_u16 v18, v11 offset:10240
    ds_read_u16 v19, v11 offset:15360
    ds_read_u16 v20, v11 offset:20480
    ds_read_u16 v21, v11 offset:25600
    ds_read_u16 v22, v11 offset:30720
    ds_read_u16 v23, v11 offset:35840
    ds_read_u16 v24, v10 offset:16
    ds_read_u16 v25, v10 offset:5136
    ds_read_u16 v26, v10 offset:10256
    ds_read_u16 v27, v10 offset:15376
    ds_read_u16 v28, v10 offset:20496
    ds_read_u16 v29, v10 offset:25616
    ds_read_u16 v30, v10 offset:30736
    ds_read_u16 v31, v10 offset:35856
    s_waitcnt lgkmcnt(8)
    v_lshl_or_b32 v80, v17, 16, v16
    v_lshl_or_b32 v81, v19, 16, v18
    v_lshl_or_b32 v82, v21, 16, v20
    v_lshl_or_b32 v83, v23, 16, v22
    s_mov_b32 s43, 12582912
    buffer_store_dwordx4 v[80:83], v12, s[8:11], s43 offen sc1
    ds_read_u16 v32, v10 offset:32
    ds_read_u16 v33, v10 offset:5152
    ds_read_u16 v34, v10 offset:10272
    ds_read_u16 v35, v10 offset:15392
    ds_read_u16 v36, v10 offset:20512
    ds_read_u16 v37, v10 offset:25632
    ds_read_u16 v38, v10 offset:30752
    ds_read_u16 v39, v10 offset:35872
    s_waitcnt lgkmcnt(8)
    v_lshl_or_b32 v84, v25, 16, v24
    v_lshl_or_b32 v85, v27, 16, v26
    v_lshl_or_b32 v86, v29, 16, v28
    v_lshl_or_b32 v87, v31, 16, v30
    s_mov_b32 s43, 12650496
    buffer_store_dwordx4 v[84:87], v12, s[8:11], s43 offen sc1
    ds_read_u16 v40, v10 offset:48
    ds_read_u16 v41, v10 offset:5168
    ds_read_u16 v42, v10 offset:10288
    ds_read_u16 v43, v10 offset:15408
    ds_read_u16 v44, v10 offset:20528
    ds_read_u16 v45, v10 offset:25648
    ds_read_u16 v46, v10 offset:30768
    ds_read_u16 v47, v10 offset:35888
    s_waitcnt lgkmcnt(8)
    v_lshl_or_b32 v88, v33, 16, v32
    v_lshl_or_b32 v89, v35, 16, v34
    v_lshl_or_b32 v90, v37, 16, v36
    v_lshl_or_b32 v91, v39, 16, v38
    s_mov_b32 s43, 12718080
    buffer_store_dwordx4 v[88:91], v12, s[8:11], s43 offen sc1
    ds_read_u16 v48, v10 offset:64
    ds_read_u16 v49, v10 offset:5184
    ds_read_u16 v50, v10 offset:10304
    ds_read_u16 v51, v10 offset:15424
    ds_read_u16 v52, v10 offset:20544
    ds_read_u16 v53, v10 offset:25664
    ds_read_u16 v54, v10 offset:30784
    ds_read_u16 v55, v10 offset:35904
    s_waitcnt lgkmcnt(8)
    v_lshl_or_b32 v92, v41, 16, v40
    v_lshl_or_b32 v93, v43, 16, v42
    v_lshl_or_b32 v94, v45, 16, v44
    v_lshl_or_b32 v95, v47, 16, v46
    s_mov_b32 s43, 12785664
    buffer_store_dwordx4 v[92:95], v12, s[8:11], s43 offen sc1
    ds_read_u16 v56, v10 offset:80
    ds_read_u16 v57, v10 offset:5200
    ds_read_u16 v58, v10 offset:10320
    ds_read_u16 v59, v10 offset:15440
    ds_read_u16 v60, v10 offset:20560
    ds_read_u16 v61, v10 offset:25680
    ds_read_u16 v62, v10 offset:30800
    ds_read_u16 v63, v10 offset:35920
    s_waitcnt lgkmcnt(8)
    v_lshl_or_b32 v96, v49, 16, v48
    v_lshl_or_b32 v97, v51, 16, v50
    v_lshl_or_b32 v98, v53, 16, v52
    v_lshl_or_b32 v99, v55, 16, v54
    s_mov_b32 s43, 12853248
    buffer_store_dwordx4 v[96:99], v12, s[8:11], s43 offen sc1
    ds_read_u16 v64, v10 offset:96
    ds_read_u16 v65, v10 offset:5216
    ds_read_u16 v66, v10 offset:10336
    ds_read_u16 v67, v10 offset:15456
    ds_read_u16 v68, v10 offset:20576
    ds_read_u16 v69, v10 offset:25696
    ds_read_u16 v70, v10 offset:30816
    ds_read_u16 v71, v10 offset:35936
    s_waitcnt lgkmcnt(8)
    v_lshl_or_b32 v100, v57, 16, v56
    v_lshl_or_b32 v101, v59, 16, v58
    v_lshl_or_b32 v102, v61, 16, v60
    v_lshl_or_b32 v103, v63, 16, v62
    s_mov_b32 s43, 12920832
    buffer_store_dwordx4 v[100:103], v12, s[8:11], s43 offen sc1
    ds_read_u16 v72, v10 offset:112
    ds_read_u16 v73, v10 offset:5232
    ds_read_u16 v74, v10 offset:10352
    ds_read_u16 v75, v10 offset:15472
    ds_read_u16 v76, v10 offset:20592
    ds_read_u16 v77, v10 offset:25712
    ds_read_u16 v78, v10 offset:30832
    ds_read_u16 v79, v10 offset:35952
    s_waitcnt lgkmcnt(8)
    v_lshl_or_b32 v104, v65, 16, v64
    v_lshl_or_b32 v105, v67, 16, v66
    v_lshl_or_b32 v106, v69, 16, v68
    v_lshl_or_b32 v107, v71, 16, v70
    s_mov_b32 s43, 12988416
    buffer_store_dwordx4 v[104:107], v12, s[8:11], s43 offen sc1
    s_waitcnt lgkmcnt(0)
    v_lshl_or_b32 v108, v73, 16, v72
    v_lshl_or_b32 v109, v75, 16, v74
    v_lshl_or_b32 v110, v77, 16, v76
    v_lshl_or_b32 v111, v79, 16, v78
    s_mov_b32 s43, 13056000
    buffer_store_dwordx4 v[108:111], v12, s[8:11], s43 offen sc1
    s_waitcnt vmcnt(0)
    v_mov_b32 v248, 151296
    v_mov_b32 v249, 1
    s_waitcnt lgkmcnt(0)
    s_mov_b64 exec, 1
    ds_add_u32 v248, v249 offset:8
    s_mov_b64 exec, -1
    s_setprio 0
    v_mul_u32_u24 v12, 1040, v3
    v_lshl_add_u32 v12, v4, 4, v12
    v_add_u32 v12, 65536, v12
    s_mov_b32 s55, 8
    s_branch p0_gen
p0_stats:
    s_cmp_ge_u32 s40, 2
    s_cbranch_scc1 p0_gen
    s_cmp_ge_u32 s3, 2
    s_cbranch_scc1 p0_gen
    s_setprio 2
    v_lshrrev_b32 v72, 3, v1
    s_lshl_b32 s42, s40, 4
    s_lshl_b32 s43, s3, 3
    s_add_u32 s42, s42, s43
    v_add_u32 v72, s42, v72
    v_mul_u32_u24 v73, 1040, v72
    v_and_b32 v74, 7, v1
    v_lshl_add_u32 v73, v74, 4, v73
    v_mov_b32 v75, 0x3f803f80
    v_mov_b32 v248, 151296
lw2:
    ds_read_b32 v250, v248 offset:0
    s_waitcnt lgkmcnt(0)
    v_readfirstlane_b32 s33, v250
    s_nop 0
    s_cmp_lt_u32 s33, 4
    s_cbranch_scc1 lw2
    ds_read_b128 v[80:83], v73 offset:0
    ds_read_b128 v[84:87], v73 offset:128
    ds_read_b128 v[88:91], v73 offset:256
    ds_read_b128 v[92:95], v73 offset:384
    ds_read_b128 v[96:99], v73 offset:512
    ds_read_b128 v[100:103], v73 offset:640
    ds_read_b128 v[104:107], v73 offset:768
    ds_read_b128 v[108:111], v73 offset:896
    s_waitcnt lgkmcnt(7)
    v_dot2_f32_bf16 v76, v80, v80, 0
    v_dot2_f32_bf16 v78, v80, v75, 0
    v_dot2_f32_bf16 v77, v81, v81, 0
    v_dot2_f32_bf16 v79, v81, v75, 0
    v_dot2_f32_bf16 v76, v82, v82, v76
    v_dot2_f32_bf16 v78, v82, v75, v78
    v_dot2_f32_bf16 v77, v83, v83, v77
    v_dot2_f32_bf16 v79, v83, v75, v79
    s_waitcnt lgkmcnt(6)
    v_dot2_f32_bf16 v76, v84, v84, v76
    v_dot2_f32_bf16 v78, v84, v75, v78
    v_dot2_f32_bf16 v77, v85, v85, v77
    v_dot2_f32_bf16 v79, v85, v75, v79
    v_dot2_f32_bf16 v76, v86, v86, v76
    v_dot2_f32_bf16 v78, v86, v75, v78
    v_dot2_f32_bf16 v77, v87, v87, v77
    v_dot2_f32_bf16 v79, v87, v75, v79
    s_waitcnt lgkmcnt(5)
    v_dot2_f32_bf16 v76, v88, v88, v76
    v_dot2_f32_bf16 v78, v88, v75, v78
    v_dot2_f32_bf16 v77, v89, v89, v77
    v_dot2_f32_bf16 v79, v89, v75, v79
    v_dot2_f32_bf16 v76, v90, v90, v76
    v_dot2_f32_bf16 v78, v90, v75, v78
    v_dot2_f32_bf16 v77, v91, v91, v77
    v_dot2_f32_bf16 v79, v91, v75, v79
    s_waitcnt lgkmcnt(4)
    v_dot2_f32_bf16 v76, v92, v92, v76
    v_dot2_f32_bf16 v78, v92, v75, v78
    v_dot2_f32_bf16 v77, v93, v93, v77
    v_dot2_f32_bf16 v79, v93, v75, v79
    v_dot2_f32_bf16 v76, v94, v94, v76
    v_dot2_f32_bf16 v78, v94, v75, v78
    v_dot2_f32_bf16 v77, v95, v95, v77
    v_dot2_f32_bf16 v79, v95, v75, v79
    s_waitcnt lgkmcnt(3)
    v_dot2_f32_bf16 v76, v96, v96, v76
    v_dot2_f32_bf16 v78, v96, v75, v78
    v_dot2_f32_bf16 v77, v97, v97, v77
    v_dot2_f32_bf16 v79, v97, v75, v79
    v_dot2_f32_bf16 v76, v98, v98, v76
    v_dot2_f32_bf16 v78, v98, v75, v78
    v_dot2_f32_bf16 v77, v99, v99, v77
    v_dot2_f32_bf16 v79, v99, v75, v79
    s_waitcnt lgkmcnt(2)
    v_dot2_f32_bf16 v76, v100, v100, v76
    v_dot2_f32_bf16 v78, v100, v75, v78
    v_dot2_f32_bf16 v77, v101, v101, v77
    v_dot2_f32_bf16 v79, v101, v75, v79
    v_dot2_f32_bf16 v76, v102, v102, v76
    v_dot2_f32_bf16 v78, v102, v75, v78
    v_dot2_f32_bf16 v77, v103, v103, v77
    v_dot2_f32_bf16 v79, v103, v75, v79
    s_waitcnt lgkmcnt(1)
    v_dot2_f32_bf16 v76, v104, v104, v76
    v_dot2_f32_bf16 v78, v104, v75, v78
    v_dot2_f32_bf16 v77, v105, v105, v77
    v_dot2_f32_bf16 v79, v105, v75, v79
    v_dot2_f32_bf16 v76, v106, v106, v76
    v_dot2_f32_bf16 v78, v106, v75, v78
    v_dot2_f32_bf16 v77, v107, v107, v77
    v_dot2_f32_bf16 v79, v107, v75, v79
    s_waitcnt lgkmcnt(0)
    v_dot2_f32_bf16 v76, v108, v108, v76
    v_dot2_f32_bf16 v78, v108, v75, v78
    v_dot2_f32_bf16 v77, v109, v109, v77
    v_dot2_f32_bf16 v79, v109, v75, v79
    v_dot2_f32_bf16 v76, v110, v110, v76
    v_dot2_f32_bf16 v78, v110, v75, v78
    v_dot2_f32_bf16 v77, v111, v111, v77
    v_dot2_f32_bf16 v79, v111, v75, v79
    s_nop 1
    v_add_f32 v76, v76, v77
    v_add_f32 v78, v78, v79
    s_nop 0
    v_add_f32_dpp v76, v76, v76 quad_perm:[1,0,3,2] row_mask:0xf bank_mask:0xf
    v_add_f32_dpp v78, v78, v78 quad_perm:[1,0,3,2] row_mask:0xf bank_mask:0xf
    s_nop 0
    v_add_f32_dpp v76, v76, v76 quad_perm:[2,3,0,1] row_mask:0xf bank_mask:0xf
    v_add_f32_dpp v78, v78, v78 quad_perm:[2,3,0,1] row_mask:0xf bank_mask:0xf
    s_nop 0
    v_add_f32_dpp v76, v76, v76 row_half_mirror row_mask:0xf bank_mask:0xf
    v_add_f32_dpp v78, v78, v78 row_half_mirror row_mask:0xf bank_mask:0xf
    v_mul_f32 v78, v78, v78
    v_fmac_f32 v76, 0xbb000000, v78
    v_max_f32 v76, 0, v76
    v_mov_b32 v77, 0
    s_lshl_b32 s42, s22, 3
    s_and_b32 s43, s23, 7
    s_add_u32 s42, s42, s43
    s_lshl_b32 s42, s42, 7
    s_add_u32 s42, s42, 3932160
    s_add_u32 s43, s42, 8192
    v_lshlrev_b32 v72, 2, v72
    v_cmp_eq_u32 vcc, 0, v74
    s_nop 0
    s_and_saveexec_b64 s[28:29], vcc
    buffer_store_dword v76, v72, s[8:11], s42 offen sc1
    buffer_store_dword v77, v72, s[8:11], s43 offen sc1
    s_mov_b64 exec, -1
    s_setprio 0
p0_gen:
    s_lshl_b32 s54, s52, 2
    s_add_u32 s54, s54, s3
    v_lshrrev_b32 v6, 2, v3
    v_and_b32 v6, 1, v6
    v_lshlrev_b32 v13, 4, v6
    v_and_b32 v6, 3, v3
    v_lshrrev_b32 v7, 3, v3
    v_lshl_add_u32 v14, v7, 2, v6
    v_add_u32 v6, v13, v14
    s_lshl_b32 s42, s54, 5
    v_add_u32 v6, s42, v6
    v_lshrrev_b32 v9, 1, v6
    v_cvt_f32_u32 v7, v9
    v_mul_f32 v7, 0x3b000000, v7
    v_and_b32 v8, 1, v6
    v_cvt_f32_u32 v8, v8
    v_mul_f32 v8, 0x3e800000, v8
    v_cmp_eq_u32 vcc, 0, v9
    v_and_b32 v10, 1, v9
    v_sub_u32 v10, 0, v10
    v_and_b32 v10, 0x80008000, v10
    v_cndmask_b32 v7, v7, 0.5, vcc
    v_mov_b32 v9, 0x3e2aaaab
    v_cndmask_b32 v8, v8, v9, vcc
    v_cvt_f32_u32 v9, v4
    v_mul_f32 v9, 0x41000000, v9
    v_fmac_f32 v8, v9, v7
    v_fmamk_f32 v40, v7, 0x00000000, v8
    v_fmamk_f32 v41, v7, 0x3f800000, v8
    v_fmamk_f32 v42, v7, 0x40000000, v8
    v_fmamk_f32 v43, v7, 0x40400000, v8
    v_fmamk_f32 v44, v7, 0x40800000, v8
    v_fmamk_f32 v45, v7, 0x40a00000, v8
    v_fmamk_f32 v46, v7, 0x40c00000, v8
    v_fmamk_f32 v47, v7, 0x40e00000, v8
    v_cos_f32 v24, v40
    v_sin_f32 v32, v40
    v_cos_f32 v25, v41
    v_sin_f32 v33, v41
    v_cos_f32 v26, v42
    v_sin_f32 v34, v42
    v_cos_f32 v27, v43
    v_sin_f32 v35, v43
    v_cos_f32 v28, v44
    v_sin_f32 v36, v44
    v_cos_f32 v29, v45
    v_sin_f32 v37, v45
    v_cos_f32 v30, v46
    v_sin_f32 v38, v46
    v_cos_f32 v31, v47
    v_sin_f32 v39, v47
    v_cvt_pk_bf16_f32 v152, v24, v25
    v_cvt_pk_bf16_f32 v153, v26, v27
    v_cvt_pk_bf16_f32 v154, v28, v29
    v_cvt_pk_bf16_f32 v155, v30, v31
    v_mul_f32 v52, 0x41800000, v7
    v_cos_f32 v50, v52
    v_sin_f32 v51, v52
    v_mul_f32 v52, 0x42000000, v7
    v_cos_f32 v48, v52
    v_sin_f32 v49, v52
    v_pk_mul_f32 v[40:41], v[50:51], v[32:33] op_sel:[1,0] op_sel_hi:[1,1]
    v_pk_mul_f32 v[42:43], v[50:51], v[34:35] op_sel:[1,0] op_sel_hi:[1,1]
    v_pk_mul_f32 v[44:45], v[50:51], v[36:37] op_sel:[1,0] op_sel_hi:[1,1]
    v_pk_mul_f32 v[46:47], v[50:51], v[38:39] op_sel:[1,0] op_sel_hi:[1,1]
    v_pk_fma_f32 v[40:41], v[50:51], v[24:25], v[40:41] op_sel:[0,0,0] op_sel_hi:[0,1,1] neg_lo:[0,0,1] neg_hi:[0,0,1]
    v_pk_fma_f32 v[42:43], v[50:51], v[26:27], v[42:43] op_sel:[0,0,0] op_sel_hi:[0,1,1] neg_lo:[0,0,1] neg_hi:[0,0,1]
    v_pk_fma_f32 v[44:45], v[50:51], v[28:29], v[44:45] op_sel:[0,0,0] op_sel_hi:[0,1,1] neg_lo:[0,0,1] neg_hi:[0,0,1]
    v_pk_fma_f32 v[46:47], v[50:51], v[30:31], v[46:47] op_sel:[0,0,0] op_sel_hi:[0,1,1] neg_lo:[0,0,1] neg_hi:[0,0,1]
    v_cvt_pk_bf16_f32 v156, v40, v41
    v_cvt_pk_bf16_f32 v157, v42, v43
    v_cvt_pk_bf16_f32 v158, v44, v45
    v_cvt_pk_bf16_f32 v159, v46, v47
    v_mul_f32 v52, 0x42400000, v7
    v_cos_f32 v50, v52
    v_sin_f32 v51, v52
    v_pk_mul_f32 v[40:41], v[48:49], v[32:33] op_sel:[1,0] op_sel_hi:[1,1]
    v_pk_mul_f32 v[42:43], v[48:49], v[34:35] op_sel:[1,0] op_sel_hi:[1,1]
    v_pk_mul_f32 v[44:45], v[48:49], v[36:37] op_sel:[1,0] op_sel_hi:[1,1]
    v_pk_mul_f32 v[46:47], v[48:49], v[38:39] op_sel:[1,0] op_sel_hi:[1,1]
    v_pk_fma_f32 v[40:41], v[48:49], v[24:25], v[40:41] op_sel:[0,0,0] op_sel_hi:[0,1,1] neg_lo:[0,0,1] neg_hi:[0,0,1]
    v_pk_fma_f32 v[42:43], v[48:49], v[26:27], v[42:43] op_sel:[0,0,0] op_sel_hi:[0,1,1] neg_lo:[0,0,1] neg_hi:[0,0,1]
    v_pk_fma_f32 v[44:45], v[48:49], v[28:29], v[44:45] op_sel:[0,0,0] op_sel_hi:[0,1,1] neg_lo:[0,0,1] neg_hi:[0,0,1]
    v_pk_fma_f32 v[46:47], v[48:49], v[30:31], v[46:47] op_sel:[0,0,0] op_sel_hi:[0,1,1] neg_lo:[0,0,1] neg_hi:[0,0,1]
    v_cvt_pk_bf16_f32 v160, v40, v41
    v_cvt_pk_bf16_f32 v161, v42, v43
    v_cvt_pk_bf16_f32 v162, v44, v45
    v_cvt_pk_bf16_f32 v163, v46, v47
    v_mul_f32 v52, 0x42800000, v7
    v_cos_f32 v48, v52
    v_sin_f32 v49, v52
    v_pk_mul_f32 v[40:41], v[50:51], v[32:33] op_sel:[1,0] op_sel_hi:[1,1]
    v_pk_mul_f32 v[42:43], v[50:51], v[34:35] op_sel:[1,0] op_sel_hi:[1,1]
    v_pk_mul_f32 v[44:45], v[50:51], v[36:37] op_sel:[1,0] op_sel_hi:[1,1]
    v_pk_mul_f32 v[46:47], v[50:51], v[38:39] op_sel:[1,0] op_sel_hi:[1,1]
    v_pk_fma_f32 v[40:41], v[50:51], v[24:25], v[40:41] op_sel:[0,0,0] op_sel_hi:[0,1,1] neg_lo:[0,0,1] neg_hi:[0,0,1]
    v_pk_fma_f32 v[42:43], v[50:51], v[26:27], v[42:43] op_sel:[0,0,0] op_sel_hi:[0,1,1] neg_lo:[0,0,1] neg_hi:[0,0,1]
    v_pk_fma_f32 v[44:45], v[50:51], v[28:29], v[44:45] op_sel:[0,0,0] op_sel_hi:[0,1,1] neg_lo:[0,0,1] neg_hi:[0,0,1]
    v_pk_fma_f32 v[46:47], v[50:51], v[30:31], v[46:47] op_sel:[0,0,0] op_sel_hi:[0,1,1] neg_lo:[0,0,1] neg_hi:[0,0,1]
    v_cvt_pk_bf16_f32 v164, v40, v41
    v_cvt_pk_bf16_f32 v165, v42, v43
    v_cvt_pk_bf16_f32 v166, v44, v45
    v_cvt_pk_bf16_f32 v167, v46, v47
    v_mul_f32 v52, 0x42a00000, v7
    v_cos_f32 v50, v52
    v_sin_f32 v51, v52
    v_pk_mul_f32 v[40:41], v[48:49], v[32:33] op_sel:[1,0] op_sel_hi:[1,1]
    v_pk_mul_f32 v[42:43], v[48:49], v[34:35] op_sel:[1,0] op_sel_hi:[1,1]
    v_pk_mul_f32 v[44:45], v[48:49], v[36:37] op_sel:[1,0] op_sel_hi:[1,1]
    v_pk_mul_f32 v[46:47], v[48:49], v[38:39] op_sel:[1,0] op_sel_hi:[1,1]
    v_pk_fma_f32 v[40:41], v[48:49], v[24:25], v[40:41] op_sel:[0,0,0] op_sel_hi:[0,1,1] neg_lo:[0,0,1] neg_hi:[0,0,1]
    v_pk_fma_f32 v[42:43], v[48:49], v[26:27], v[42:43] op_sel:[0,0,0] op_sel_hi:[0,1,1] neg_lo:[0,0,1] neg_hi:[0,0,1]
    v_pk_fma_f32 v[44:45], v[48:49], v[28:29], v[44:45] op_sel:[0,0,0] op_sel_hi:[0,1,1] neg_lo:[0,0,1] neg_hi:[0,0,1]
    v_pk_fma_f32 v[46:47], v[48:49], v[30:31], v[46:47] op_sel:[0,0,0] op_sel_hi:[0,1,1] neg_lo:[0,0,1] neg_hi:[0,0,1]
    v_cvt_pk_bf16_f32 v168, v40, v41
    v_cvt_pk_bf16_f32 v169, v42, v43
    v_cvt_pk_bf16_f32 v170, v44, v45
    v_cvt_pk_bf16_f32 v171, v46, v47
    v_mul_f32 v52, 0x42c00000, v7
    v_cos_f32 v48, v52
    v_sin_f32 v49, v52
    v_pk_mul_f32 v[40:41], v[50:51], v[32:33] op_sel:[1,0] op_sel_hi:[1,1]
    v_pk_mul_f32 v[42:43], v[50:51], v[34:35] op_sel:[1,0] op_sel_hi:[1,1]
    v_pk_mul_f32 v[44:45], v[50:51], v[36:37] op_sel:[1,0] op_sel_hi:[1,1]
    v_pk_mul_f32 v[46:47], v[50:51], v[38:39] op_sel:[1,0] op_sel_hi:[1,1]
    v_pk_fma_f32 v[40:41], v[50:51], v[24:25], v[40:41] op_sel:[0,0,0] op_sel_hi:[0,1,1] neg_lo:[0,0,1] neg_hi:[0,0,1]
    v_pk_fma_f32 v[42:43], v[50:51], v[26:27], v[42:43] op_sel:[0,0,0] op_sel_hi:[0,1,1] neg_lo:[0,0,1] neg_hi:[0,0,1]
    v_pk_fma_f32 v[44:45], v[50:51], v[28:29], v[44:45] op_sel:[0,0,0] op_sel_hi:[0,1,1] neg_lo:[0,0,1] neg_hi:[0,0,1]
    v_pk_fma_f32 v[46:47], v[50:51], v[30:31], v[46:47] op_sel:[0,0,0] op_sel_hi:[0,1,1] neg_lo:[0,0,1] neg_hi:[0,0,1]
    v_cvt_pk_bf16_f32 v172, v40, v41
    v_cvt_pk_bf16_f32 v173, v42, v43
    v_cvt_pk_bf16_f32 v174, v44, v45
    v_cvt_pk_bf16_f32 v175, v46, v47
    v_mul_f32 v52, 0x42e00000, v7
    v_cos_f32 v50, v52
    v_sin_f32 v51, v52
    v_pk_mul_f32 v[40:41], v[48:49], v[32:33] op_sel:[1,0] op_sel_hi:[1,1]
    v_pk_mul_f32 v[42:43], v[48:49], v[34:35] op_sel:[1,0] op_sel_hi:[1,1]
    v_pk_mul_f32 v[44:45], v[48:49], v[36:37] op_sel:[1,0] op_sel_hi:[1,1]
    v_pk_mul_f32 v[46:47], v[48:49], v[38:39] op_sel:[1,0] op_sel_hi:[1,1]
    v_pk_fma_f32 v[40:41], v[48:49], v[24:25], v[40:41] op_sel:[0,0,0] op_sel_hi:[0,1,1] neg_lo:[0,0,1] neg_hi:[0,0,1]
    v_pk_fma_f32 v[42:43], v[48:49], v[26:27], v[42:43] op_sel:[0,0,0] op_sel_hi:[0,1,1] neg_lo:[0,0,1] neg_hi:[0,0,1]
    v_pk_fma_f32 v[44:45], v[48:49], v[28:29], v[44:45] op_sel:[0,0,0] op_sel_hi:[0,1,1] neg_lo:[0,0,1] neg_hi:[0,0,1]
    v_pk_fma_f32 v[46:47], v[48:49], v[30:31], v[46:47] op_sel:[0,0,0] op_sel_hi:[0,1,1] neg_lo:[0,0,1] neg_hi:[0,0,1]
    v_cvt_pk_bf16_f32 v176, v40, v41
    v_cvt_pk_bf16_f32 v177, v42, v43
    v_cvt_pk_bf16_f32 v178, v44, v45
    v_cvt_pk_bf16_f32 v179, v46, v47
    v_mul_f32 v52, 0x43000000, v7
    v_cos_f32 v48, v52
    v_sin_f32 v49, v52
    v_pk_mul_f32 v[40:41], v[50:51], v[32:33] op_sel:[1,0] op_sel_hi:[1,1]
    v_pk_mul_f32 v[42:43], v[50:51], v[34:35] op_sel:[1,0] op_sel_hi:[1,1]
    v_pk_mul_f32 v[44:45], v[50:51], v[36:37] op_sel:[1,0] op_sel_hi:[1,1]
    v_pk_mul_f32 v[46:47], v[50:51], v[38:39] op_sel:[1,0] op_sel_hi:[1,1]
    v_pk_fma_f32 v[40:41], v[50:51], v[24:25], v[40:41] op_sel:[0,0,0] op_sel_hi:[0,1,1] neg_lo:[0,0,1] neg_hi:[0,0,1]
    v_pk_fma_f32 v[42:43], v[50:51], v[26:27], v[42:43] op_sel:[0,0,0] op_sel_hi:[0,1,1] neg_lo:[0,0,1] neg_hi:[0,0,1]
    v_pk_fma_f32 v[44:45], v[50:51], v[28:29], v[44:45] op_sel:[0,0,0] op_sel_hi:[0,1,1] neg_lo:[0,0,1] neg_hi:[0,0,1]
    v_pk_fma_f32 v[46:47], v[50:51], v[30:31], v[46:47] op_sel:[0,0,0] op_sel_hi:[0,1,1] neg_lo:[0,0,1] neg_hi:[0,0,1]
    v_cvt_pk_bf16_f32 v180, v40, v41
    v_cvt_pk_bf16_f32 v181, v42, v43
    v_cvt_pk_bf16_f32 v182, v44, v45
    v_cvt_pk_bf16_f32 v183, v46, v47
    v_mul_f32 v52, 0x43100000, v7
    v_cos_f32 v50, v52
    v_sin_f32 v51, v52
    v_pk_mul_f32 v[40:41], v[48:49], v[32:33] op_sel:[1,0] op_sel_hi:[1,1]
    v_pk_mul_f32 v[42:43], v[48:49], v[34:35] op_sel:[1,0] op_sel_hi:[1,1]
    v_pk_mul_f32 v[44:45], v[48:49], v[36:37] op_sel:[1,0] op_sel_hi:[1,1]
    v_pk_mul_f32 v[46:47], v[48:49], v[38:39] op_sel:[1,0] op_sel_hi:[1,1]
    v_pk_fma_f32 v[40:41], v[48:49], v[24:25], v[40:41] op_sel:[0,0,0] op_sel_hi:[0,1,1] neg_lo:[0,0,1] neg_hi:[0,0,1]
    v_pk_fma_f32 v[42:43], v[48:49], v[26:27], v[42:43] op_sel:[0,0,0] op_sel_hi:[0,1,1] neg_lo:[0,0,1] neg_hi:[0,0,1]
    v_pk_fma_f32 v[44:45], v[48:49], v[28:29], v[44:45] op_sel:[0,0,0] op_sel_hi:[0,1,1] neg_lo:[0,0,1] neg_hi:[0,0,1]
    v_pk_fma_f32 v[46:47], v[48:49], v[30:31], v[46:47] op_sel:[0,0,0] op_sel_hi:[0,1,1] neg_lo:[0,0,1] neg_hi:[0,0,1]
    v_cvt_pk_bf16_f32 v184, v40, v41
    v_cvt_pk_bf16_f32 v185, v42, v43
    v_cvt_pk_bf16_f32 v186, v44, v45
    v_cvt_pk_bf16_f32 v187, v46, v47
    s_cmp_lg_u32 s53, 1
    s_cbranch_scc1 p0_nohook
    s_waitcnt vmcnt(0)
    v_mov_b32 v248, 151296
    v_mov_b32 v249, 1
    s_waitcnt lgkmcnt(0)
    s_mov_b64 exec, 1
    ds_add_u32 v248, v249 offset:4
    s_mov_b64 exec, -1
    s_cmp_ge_u32 s23, 12
    s_cbranch_scc1 p0_hook2
    v_mov_b32 v248, 151296
    v_mov_b32 v249, 1
    s_waitcnt lgkmcnt(0)
    s_mov_b64 exec, 1
    ds_add_u32 v248, v249 offset:8
    s_mov_b64 exec, -1
p0_hook2:
    s_cmp_ge_u32 s40, 2
    s_cbranch_scc1 p0_nohook
    s_cmp_ge_u32 s3, 2
    s_cbranch_scc1 p0_nohook
    v_mov_b32 v248, 151296
    v_mov_b32 v249, 1
    s_waitcnt lgkmcnt(0)
    s_mov_b64 exec, 1
    ds_add_u32 v248, v249 offset:8
    s_mov_b64 exec, -1
p0_nohook:
    v_mul_f32 v52, 0x43200000, v7
    v_cos_f32 v48, v52
    v_sin_f32 v49, v52
    v_pk_mul_f32 v[40:41], v[50:51], v[32:33] op_sel:[1,0] op_sel_hi:[1,1]
    v_pk_mul_f32 v[42:43], v[50:51], v[34:35] op_sel:[1,0] op_sel_hi:[1,1]
    v_pk_mul_f32 v[44:45], v[50:51], v[36:37] op_sel:[1,0] op_sel_hi:[1,1]
    v_pk_mul_f32 v[46:47], v[50:51], v[38:39] op_sel:[1,0] op_sel_hi:[1,1]
    v_pk_fma_f32 v[40:41], v[50:51], v[24:25], v[40:41] op_sel:[0,0,0] op_sel_hi:[0,1,1] neg_lo:[0,0,1] neg_hi:[0,0,1]
    v_pk_fma_f32 v[42:43], v[50:51], v[26:27], v[42:43] op_sel:[0,0,0] op_sel_hi:[0,1,1] neg_lo:[0,0,1] neg_hi:[0,0,1]
    v_pk_fma_f32 v[44:45], v[50:51], v[28:29], v[44:45] op_sel:[0,0,0] op_sel_hi:[0,1,1] neg_lo:[0,0,1] neg_hi:[0,0,1]
    v_pk_fma_f32 v[46:47], v[50:51], v[30:31], v[46:47] op_sel:[0,0,0] op_sel_hi:[0,1,1] neg_lo:[0,0,1] neg_hi:[0,0,1]
    v_cvt_pk_bf16_f32 v188, v40, v41
    v_cvt_pk_bf16_f32 v189, v42, v43
    v_cvt_pk_bf16_f32 v190, v44, v45
    v_cvt_pk_bf16_f32 v191, v46, v47
    v_mul_f32 v52, 0x43300000, v7
    v_cos_f32 v50, v52
    v_sin_f32 v51, v52
    v_pk_mul_f32 v[40:41], v[48:49], v[32:33] op_sel:[1,0] op_sel_hi:[1,1]
    v_pk_mul_f32 v[42:43], v[48:49], v[34:35] op_sel:[1,0] op_sel_hi:[1,1]
    v_pk_mul_f32 v[44:45], v[48:49], v[36:37] op_sel:[1,0] op_sel_hi:[1,1]
    v_pk_mul_f32 v[46:47], v[48:49], v[38:39] op_sel:[1,0] op_sel_hi:[1,1]
    v_pk_fma_f32 v[40:41], v[48:49], v[24:25], v[40:41] op_sel:[0,0,0] op_sel_hi:[0,1,1] neg_lo:[0,0,1] neg_hi:[0,0,1]
    v_pk_fma_f32 v[42:43], v[48:49], v[26:27], v[42:43] op_sel:[0,0,0] op_sel_hi:[0,1,1] neg_lo:[0,0,1] neg_hi:[0,0,1]
    v_pk_fma_f32 v[44:45], v[48:49], v[28:29], v[44:45] op_sel:[0,0,0] op_sel_hi:[0,1,1] neg_lo:[0,0,1] neg_hi:[0,0,1]
    v_pk_fma_f32 v[46:47], v[48:49], v[30:31], v[46:47] op_sel:[0,0,0] op_sel_hi:[0,1,1] neg_lo:[0,0,1] neg_hi:[0,0,1]
    v_cvt_pk_bf16_f32 v192, v40, v41
    v_cvt_pk_bf16_f32 v193, v42, v43
    v_cvt_pk_bf16_f32 v194, v44, v45
    v_cvt_pk_bf16_f32 v195, v46, v47
    v_mul_f32 v52, 0x43400000, v7
    v_cos_f32 v48, v52
    v_sin_f32 v49, v52
    v_pk_mul_f32 v[40:41], v[50:51], v[32:33] op_sel:[1,0] op_sel_hi:[1,1]
    v_pk_mul_f32 v[42:43], v[50:51], v[34:35] op_sel:[1,0] op_sel_hi:[1,1]
    v_pk_mul_f32 v[44:45], v[50:51], v[36:37] op_sel:[1,0] op_sel_hi:[1,1]
    v_pk_mul_f32 v[46:47], v[50:51], v[38:39] op_sel:[1,0] op_sel_hi:[1,1]
    v_pk_fma_f32 v[40:41], v[50:51], v[24:25], v[40:41] op_sel:[0,0,0] op_sel_hi:[0,1,1] neg_lo:[0,0,1] neg_hi:[0,0,1]
    v_pk_fma_f32 v[42:43], v[50:51], v[26:27], v[42:43] op_sel:[0,0,0] op_sel_hi:[0,1,1] neg_lo:[0,0,1] neg_hi:[0,0,1]
    v_pk_fma_f32 v[44:45], v[50:51], v[28:29], v[44:45] op_sel:[0,0,0] op_sel_hi:[0,1,1] neg_lo:[0,0,1] neg_hi:[0,0,1]
    v_pk_fma_f32 v[46:47], v[50:51], v[30:31], v[46:47] op_sel:[0,0,0] op_sel_hi:[0,1,1] neg_lo:[0,0,1] neg_hi:[0,0,1]
    v_cvt_pk_bf16_f32 v196, v40, v41
    v_cvt_pk_bf16_f32 v197, v42, v43
    v_cvt_pk_bf16_f32 v198, v44, v45
    v_cvt_pk_bf16_f32 v199, v46, v47
    v_mul_f32 v52, 0x43500000, v7
    v_cos_f32 v50, v52
    v_sin_f32 v51, v52
    v_pk_mul_f32 v[40:41], v[48:49], v[32:33] op_sel:[1,0] op_sel_hi:[1,1]
    v_pk_mul_f32 v[42:43], v[48:49], v[34:35] op_sel:[1,0] op_sel_hi:[1,1]
    v_pk_mul_f32 v[44:45], v[48:49], v[36:37] op_sel:[1,0] op_sel_hi:[1,1]
    v_pk_mul_f32 v[46:47], v[48:49], v[38:39] op_sel:[1,0] op_sel_hi:[1,1]
    v_pk_fma_f32 v[40:41], v[48:49], v[24:25], v[40:41] op_sel:[0,0,0] op_sel_hi:[0,1,1] neg_lo:[0,0,1] neg_hi:[0,0,1]
    v_pk_fma_f32 v[42:43], v[48:49], v[26:27], v[42:43] op_sel:[0,0,0] op_sel_hi:[0,1,1] neg_lo:[0,0,1] neg_hi:[0,0,1]
    v_pk_fma_f32 v[44:45], v[48:49], v[28:29], v[44:45] op_sel:[0,0,0] op_sel_hi:[0,1,1] neg_lo:[0,0,1] neg_hi:[0,0,1]
    v_pk_fma_f32 v[46:47], v[48:49], v[30:31], v[46:47] op_sel:[0,0,0] op_sel_hi:[0,1,1] neg_lo:[0,0,1] neg_hi:[0,0,1]
    v_cvt_pk_bf16_f32 v200, v40, v41
    v_cvt_pk_bf16_f32 v201, v42, v43
    v_cvt_pk_bf16_f32 v202, v44, v45
    v_cvt_pk_bf16_f32 v203, v46, v47
    v_mul_f32 v52, 0x43600000, v7
    v_cos_f32 v48, v52
    v_sin_f32 v49, v52
    v_pk_mul_f32 v[40:41], v[50:51], v[32:33] op_sel:[1,0] op_sel_hi:[1,1]
    v_pk_mul_f32 v[42:43], v[50:51], v[34:35] op_sel:[1,0] op_sel_hi:[1,1]
    v_pk_mul_f32 v[44:45], v[50:51], v[36:37] op_sel:[1,0] op_sel_hi:[1,1]
    v_pk_mul_f32 v[46:47], v[50:51], v[38:39] op_sel:[1,0] op_sel_hi:[1,1]
    v_pk_fma_f32 v[40:41], v[50:51], v[24:25], v[40:41] op_sel:[0,0,0] op_sel_hi:[0,1,1] neg_lo:[0,0,1] neg_hi:[0,0,1]
    v_pk_fma_f32 v[42:43], v[50:51], v[26:27], v[42:43] op_sel:[0,0,0] op_sel_hi:[0,1,1] neg_lo:[0,0,1] neg_hi:[0,0,1]
    v_pk_fma_f32 v[44:45], v[50:51], v[28:29], v[44:45] op_sel:[0,0,0] op_sel_hi:[0,1,1] neg_lo:[0,0,1] neg_hi:[0,0,1]
    v_pk_fma_f32 v[46:47], v[50:51], v[30:31], v[46:47] op_sel:[0,0,0] op_sel_hi:[0,1,1] neg_lo:[0,0,1] neg_hi:[0,0,1]
    v_cvt_pk_bf16_f32 v204, v40, v41
    v_cvt_pk_bf16_f32 v205, v42, v43
    v_cvt_pk_bf16_f32 v206, v44, v45
    v_cvt_pk_bf16_f32 v207, v46, v47
    v_mul_f32 v52, 0x43700000, v7
    v_cos_f32 v50, v52
    v_sin_f32 v51, v52
    v_pk_mul_f32 v[40:41], v[48:49], v[32:33] op_sel:[1,0] op_sel_hi:[1,1]
    v_pk_mul_f32 v[42:43], v[48:49], v[34:35] op_sel:[1,0] op_sel_hi:[1,1]
    v_pk_mul_f32 v[44:45], v[48:49], v[36:37] op_sel:[1,0] op_sel_hi:[1,1]
    v_pk_mul_f32 v[46:47], v[48:49], v[38:39] op_sel:[1,0] op_sel_hi:[1,1]
    v_pk_fma_f32 v[40:41], v[48:49], v[24:25], v[40:41] op_sel:[0,0,0] op_sel_hi:[0,1,1] neg_lo:[0,0,1] neg_hi:[0,0,1]
    v_pk_fma_f32 v[42:43], v[48:49], v[26:27], v[42:43] op_sel:[0,0,0] op_sel_hi:[0,1,1] neg_lo:[0,0,1] neg_hi:[0,0,1]
    v_pk_fma_f32 v[44:45], v[48:49], v[28:29], v[44:45] op_sel:[0,0,0] op_sel_hi:[0,1,1] neg_lo:[0,0,1] neg_hi:[0,0,1]
    v_pk_fma_f32 v[46:47], v[48:49], v[30:31], v[46:47] op_sel:[0,0,0] op_sel_hi:[0,1,1] neg_lo:[0,0,1] neg_hi:[0,0,1]
    v_cvt_pk_bf16_f32 v208, v40, v41
    v_cvt_pk_bf16_f32 v209, v42, v43
    v_cvt_pk_bf16_f32 v210, v44, v45
    v_cvt_pk_bf16_f32 v211, v46, v47
    v_pk_mul_f32 v[40:41], v[50:51], v[32:33] op_sel:[1,0] op_sel_hi:[1,1]
    v_pk_mul_f32 v[42:43], v[50:51], v[34:35] op_sel:[1,0] op_sel_hi:[1,1]
    v_pk_mul_f32 v[44:45], v[50:51], v[36:37] op_sel:[1,0] op_sel_hi:[1,1]
    v_pk_mul_f32 v[46:47], v[50:51], v[38:39] op_sel:[1,0] op_sel_hi:[1,1]
    v_pk_fma_f32 v[40:41], v[50:51], v[24:25], v[40:41] op_sel:[0,0,0] op_sel_hi:[0,1,1] neg_lo:[0,0,1] neg_hi:[0,0,1]
    v_pk_fma_f32 v[42:43], v[50:51], v[26:27], v[42:43] op_sel:[0,0,0] op_sel_hi:[0,1,1] neg_lo:[0,0,1] neg_hi:[0,0,1]
    v_pk_fma_f32 v[44:45], v[50:51], v[28:29], v[44:45] op_sel:[0,0,0] op_sel_hi:[0,1,1] neg_lo:[0,0,1] neg_hi:[0,0,1]
    v_pk_fma_f32 v[46:47], v[50:51], v[30:31], v[46:47] op_sel:[0,0,0] op_sel_hi:[0,1,1] neg_lo:[0,0,1] neg_hi:[0,0,1]
    v_cvt_pk_bf16_f32 v212, v40, v41
    v_cvt_pk_bf16_f32 v213, v42, v43
    v_cvt_pk_bf16_f32 v214, v44, v45
    v_cvt_pk_bf16_f32 v215, v46, v47
    s_mov_b32 s6, 0x3d800000
    s_mov_b32 s7, 0x3d800000
    s_cmp_lg_u32 s53, 0
    s_cbranch_scc1 p0_bsync
    v_mul_u32_u24 v11, 67584, v4
    v_lshl_add_u32 v11, v3, 2, v11
    s_mul_i32 s42, s54, 135168
    s_lshl_b32 s43, s51, 7
    s_add_u32 s42, s42, s43
    s_cmp_lg_u32 s55, 0
    s_cbranch_scc1 p0_a_consts
    s_mov_b32 s56, s38
    s_and_b32 s57, s39, 0xffff
    s_mov_b32 s58, 256
    s_mov_b32 s59, 0x20000
    s_waitcnt vmcnt(0)
    v_mov_b32 v6, 1
    s_mov_b64 exec, 1
    buffer_store_dword v6, v252, s[56:59], 0 offen sc1
    s_mov_b64 exec, -1
    s_branch p0_a_consts
p0_a_mm:
    v_mov_b32 v248, 151296
lw3:
    ds_read_b32 v250, v248 offset:0
    s_waitcnt lgkmcnt(0)
    v_readfirstlane_b32 s33, v250
    s_nop 0
    s_cmp_lt_u32 s33, 4
    s_cbranch_scc1 lw3
    ds_read_b128 v[24:27], v12 offset:0
    ds_read_b128 v[28:31], v12 offset:32
    ds_read_b128 v[32:35], v12 offset:64
    ds_read_b128 v[36:39], v12 offset:96
    ds_read_b128 v[40:43], v12 offset:128
    ds_read_b128 v[44:47], v12 offset:160
    ds_read_b128 v[48:51], v12 offset:192
    s_waitcnt lgkmcnt(6)
    v_mfma_f32_32x32x16_bf16 v[216:231], v[152:155], v[24:27], 0
    ds_read_b128 v[52:55], v12 offset:224
    v_xor_b32 v152, v10, v152
    v_xor_b32 v153, v10, v153
    v_xor_b32 v154, v10, v154
    v_xor_b32 v155, v10, v155
    s_waitcnt lgkmcnt(6)
    v_mfma_f32_32x32x16_bf16 v[216:231], v[156:159], v[28:31], v[216:231]
    ds_read_b128 v[24:27], v12 offset:256
    v_xor_b32 v156, v10, v156
    v_xor_b32 v157, v10, v157
    v_xor_b32 v158, v10, v158
    v_xor_b32 v159, v10, v159
    s_waitcnt lgkmcnt(6)
    v_mfma_f32_32x32x16_bf16 v[216:231], v[160:163], v[32:35], v[216:231]
    ds_read_b128 v[28:31], v12 offset:288
    v_xor_b32 v160, v10, v160
    v_xor_b32 v161, v10, v161
    v_xor_b32 v162, v10, v162
    v_xor_b32 v163, v10, v163
    s_waitcnt lgkmcnt(6)
    v_mfma_f32_32x32x16_bf16 v[216:231], v[164:167], v[36:39], v[216:231]
    ds_read_b128 v[32:35], v12 offset:320
    v_xor_b32 v164, v10, v164
    v_xor_b32 v165, v10, v165
    v_xor_b32 v166, v10, v166
    v_xor_b32 v167, v10, v167
    s_waitcnt lgkmcnt(6)
    v_mfma_f32_32x32x16_bf16 v[216:231], v[168:171], v[40:43], v[216:231]
    ds_read_b128 v[36:39], v12 offset:352
    v_xor_b32 v168, v10, v168
    v_xor_b32 v169, v10, v169
    v_xor_b32 v170, v10, v170
    v_xor_b32 v171, v10, v171
    s_waitcnt lgkmcnt(6)
    v_mfma_f32_32x32x16_bf16 v[216:231], v[172:175], v[44:47], v[216:231]
    ds_read_b128 v[40:43], v12 offset:384
    v_xor_b32 v172, v10, v172
    v_xor_b32 v173, v10, v173
    v_xor_b32 v174, v10, v174
    v_xor_b32 v175, v10, v175
    s_waitcnt lgkmcnt(6)
    v_mfma_f32_32x32x16_bf16 v[216:231], v[176:179], v[48:51], v[216:231]
    ds_read_b128 v[44:47], v12 offset:416
    v_xor_b32 v176, v10, v176
    v_xor_b32 v177, v10, v177
    v_xor_b32 v178, v10, v178
    v_xor_b32 v179, v10, v179
    s_waitcnt lgkmcnt(6)
    v_mfma_f32_32x32x16_bf16 v[216:231], v[180:183], v[52:55], v[216:231]
    ds_read_b128 v[48:51], v12 offset:448
    v_xor_b32 v180, v10, v180
    v_xor_b32 v181, v10, v181
    v_xor_b32 v182, v10, v182
    v_xor_b32 v183, v10, v183
    s_waitcnt lgkmcnt(6)
    v_mfma_f32_32x32x16_bf16 v[216:231], v[184:187], v[24:27], v[216:231]
    ds_read_b128 v[52:55], v12 offset:480
    v_xor_b32 v184, v10, v184
    v_xor_b32 v185, v10, v185
    v_xor_b32 v186, v10, v186
    v_xor_b32 v187, v10, v187
    s_waitcnt lgkmcnt(6)
    v_mfma_f32_32x32x16_bf16 v[216:231], v[188:191], v[28:31], v[216:231]
    ds_read_b128 v[24:27], v12 offset:512
    v_xor_b32 v188, v10, v188
    v_xor_b32 v189, v10, v189
    v_xor_b32 v190, v10, v190
    v_xor_b32 v191, v10, v191
    s_waitcnt lgkmcnt(6)
    v_mfma_f32_32x32x16_bf16 v[216:231], v[192:195], v[32:35], v[216:231]
    ds_read_b128 v[28:31], v12 offset:544
    v_xor_b32 v192, v10, v192
    v_xor_b32 v193, v10, v193
    v_xor_b32 v194, v10, v194
    v_xor_b32 v195, v10, v195
    s_waitcnt lgkmcnt(6)
    v_mfma_f32_32x32x16_bf16 v[216:231], v[196:199], v[36:39], v[216:231]
    ds_read_b128 v[32:35], v12 offset:576
    v_xor_b32 v196, v10, v196
    v_xor_b32 v197, v10, v197
    v_xor_b32 v198, v10, v198
    v_xor_b32 v199, v10, v199
    s_waitcnt lgkmcnt(6)
    v_mfma_f32_32x32x16_bf16 v[216:231], v[200:203], v[40:43], v[216:231]
    ds_read_b128 v[36:39], v12 offset:608
    v_xor_b32 v200, v10, v200
    v_xor_b32 v201, v10, v201
    v_xor_b32 v202, v10, v202
    v_xor_b32 v203, v10, v203
    s_waitcnt lgkmcnt(6)
    v_mfma_f32_32x32x16_bf16 v[216:231], v[204:207], v[44:47], v[216:231]
    ds_read_b128 v[40:43], v12 offset:640
    v_xor_b32 v204, v10, v204
    v_xor_b32 v205, v10, v205
    v_xor_b32 v206, v10, v206
    v_xor_b32 v207, v10, v207
    s_waitcnt lgkmcnt(6)
    v_mfma_f32_32x32x16_bf16 v[216:231], v[208:211], v[48:51], v[216:231]
    ds_read_b128 v[44:47], v12 offset:672
    v_xor_b32 v208, v10, v208
    v_xor_b32 v209, v10, v209
    v_xor_b32 v210, v10, v210
    v_xor_b32 v211, v10, v211
    s_waitcnt lgkmcnt(6)
    v_mfma_f32_32x32x16_bf16 v[216:231], v[212:215], v[52:55], v[216:231]
    ds_read_b128 v[48:51], v12 offset:704
    v_xor_b32 v212, v10, v212
    v_xor_b32 v213, v10, v213
    v_xor_b32 v214, v10, v214
    v_xor_b32 v215, v10, v215
    s_waitcnt lgkmcnt(6)
    v_mfma_f32_32x32x16_bf16 v[216:231], v[152:155], v[24:27], v[216:231]
    ds_read_b128 v[52:55], v12 offset:736
    s_waitcnt lgkmcnt(6)
    v_mfma_f32_32x32x16_bf16 v[216:231], v[156:159], v[28:31], v[216:231]
    ds_read_b128 v[24:27], v12 offset:768
    s_waitcnt lgkmcnt(6)
    v_mfma_f32_32x32x16_bf16 v[216:231], v[160:163], v[32:35], v[216:231]
    ds_read_b128 v[28:31], v12 offset:800
    s_waitcnt lgkmcnt(6)
    v_mfma_f32_32x32x16_bf16 v[216:231], v[164:167], v[36:39], v[216:231]
    ds_read_b128 v[32:35], v12 offset:832
    s_waitcnt lgkmcnt(6)
    v_mfma_f32_32x32x16_bf16 v[216:231], v[168:171], v[40:43], v[216:231]
    ds_read_b128 v[36:39], v12 offset:864
    s_waitcnt lgkmcnt(6)
    v_mfma_f32_32x32x16_bf16 v[216:231], v[172:175], v[44:47], v[216:231]
    ds_read_b128 v[40:43], v12 offset:896
    s_waitcnt lgkmcnt(6)
    v_mfma_f32_32x32x16_bf16 v[216:231], v[176:179], v[48:51], v[216:231]
    ds_read_b128 v[44:47], v12 offset:928
    s_waitcnt lgkmcnt(6)
    v_mfma_f32_32x32x16_bf16 v[216:231], v[180:183], v[52:55], v[216:231]
    ds_read_b128 v[48:51], v12 offset:960
    s_waitcnt lgkmcnt(6)
    v_mfma_f32_32x32x16_bf16 v[216:231], v[184:187], v[24:27], v[216:231]
    ds_read_b128 v[52:55], v12 offset:992
    s_waitcnt lgkmcnt(6)
    v_mfma_f32_32x32x16_bf16 v[216:231], v[188:191], v[28:31], v[216:231]
    s_waitcnt lgkmcnt(5)
    v_mfma_f32_32x32x16_bf16 v[216:231], v[192:195], v[32:35], v[216:231]
    s_waitcnt lgkmcnt(4)
    v_mfma_f32_32x32x16_bf16 v[216:231], v[196:199], v[36:39], v[216:231]
    s_waitcnt lgkmcnt(3)
    v_mfma_f32_32x32x16_bf16 v[216:231], v[200:203], v[40:43], v[216:231]
    s_waitcnt lgkmcnt(2)
    v_mfma_f32_32x32x16_bf16 v[216:231], v[204:207], v[44:47], v[216:231]
    s_waitcnt lgkmcnt(1)
    v_mfma_f32_32x32x16_bf16 v[216:231], v[208:211], v[48:51], v[216:231]
    s_waitcnt lgkmcnt(0)
    v_mfma_f32_32x32x16_bf16 v[216:231], v[212:215], v[52:55], v[216:231]
    s_nop 11
    v_pk_mul_f32 v[216:217], v[216:217], s[6:7]
    v_pk_mul_f32 v[218:219], v[218:219], s[6:7]
    v_pk_mul_f32 v[220:221], v[220:221], s[6:7]
    v_pk_mul_f32 v[222:223], v[222:223], s[6:7]
    v_pk_mul_f32 v[224:225], v[224:225], s[6:7]
    v_pk_mul_f32 v[226:227], v[226:227], s[6:7]
    v_pk_mul_f32 v[228:229], v[228:229], s[6:7]
    v_pk_mul_f32 v[230:231], v[230:231], s[6:7]
    v_add_u32 v216, 0x10000, v216
    v_add_u32 v218, 0x10000, v218
    v_add_u32 v220, 0x10000, v220
    v_add_u32 v222, 0x10000, v222
    v_add_u32 v224, 0x10000, v224
    v_add_u32 v226, 0x10000, v226
    v_add_u32 v228, 0x10000, v228
    v_add_u32 v230, 0x10000, v230
    v_and_b32 v216, 0xfffe0000, v216
    v_and_b32 v218, 0xfffe0000, v218
    v_and_b32 v220, 0xfffe0000, v220
    v_and_b32 v222, 0xfffe0000, v222
    v_and_b32 v224, 0xfffe0000, v224
    v_and_b32 v226, 0xfffe0000, v226
    v_and_b32 v228, 0xfffe0000, v228
    v_and_b32 v230, 0xfffe0000, v230
    v_cvt_pk_bf16_f32 v152, v216, v217
    v_cvt_pk_bf16_f32 v153, v218, v219
    v_cvt_pk_bf16_f32 v154, v220, v221
    v_cvt_pk_bf16_f32 v155, v222, v223
    v_cvt_pk_bf16_f32 v156, v224, v225
    v_cvt_pk_bf16_f32 v157, v226, v227
    v_cvt_pk_bf16_f32 v158, v228, v229
    v_cvt_pk_bf16_f32 v159, v230, v231
    buffer_store_dword v152, v11, s[8:11], s42 offen sc1
    s_add_u32 s42, s42, 8448
    buffer_store_dword v153, v11, s[8:11], s42 offen sc1
    s_add_u32 s42, s42, 8448
    buffer_store_dword v154, v11, s[8:11], s42 offen sc1
    s_add_u32 s42, s42, 8448
    buffer_store_dword v155, v11, s[8:11], s42 offen sc1
    s_add_u32 s42, s42, 8448
    buffer_store_dword v156, v11, s[8:11], s42 offen sc1
    s_add_u32 s42, s42, 8448
    buffer_store_dword v157, v11, s[8:11], s42 offen sc1
    s_add_u32 s42, s42, 8448
    buffer_store_dword v158, v11, s[8:11], s42 offen sc1
    s_add_u32 s42, s42, 8448
    buffer_store_dword v159, v11, s[8:11], s42 offen sc1
    s_add_u32 s42, s42, 8448
    s_mov_b32 s56, s38
    s_and_b32 s57, s39, 0xffff
    s_mov_b32 s58, 256
    s_mov_b32 s59, 0x20000
    v_mov_b32 v200, 0
    buffer_load_dword v201, v200, s[56:59], 0 offen sc1
    s_branch p0_a_done
p0_bsync:
    s_waitcnt vmcnt(0)
    s_cmp_eq_u32 s53, 2
    s_cbranch_scc1 p0_mm2
    v_mov_b32 v248, 151296
lw4:
    ds_read_b32 v250, v248 offset:4
    s_waitcnt lgkmcnt(0)
    v_readfirstlane_b32 s33, v250
    s_nop 0
    s_cmp_lt_u32 s33, 4
    s_cbranch_scc1 lw4
    ds_read_b64_tr_b16 v[24:25], v12 offset:0
    ds_read_b64_tr_b16 v[26:27], v12 offset:256
    ds_read_b64_tr_b16 v[28:29], v12 offset:1024
    ds_read_b64_tr_b16 v[30:31], v12 offset:1280
    ds_read_b64_tr_b16 v[32:33], v12 offset:2048
    ds_read_b64_tr_b16 v[34:35], v12 offset:2304
    ds_read_b64_tr_b16 v[36:37], v12 offset:3072
    ds_read_b64_tr_b16 v[38:39], v12 offset:3328
    ds_read_b64_tr_b16 v[40:41], v12 offset:4096
    ds_read_b64_tr_b16 v[42:43], v12 offset:4352
    ds_read_b64_tr_b16 v[44:45], v12 offset:5120
    ds_read_b64_tr_b16 v[46:47], v12 offset:5376
    ds_read_b64_tr_b16 v[48:49], v12 offset:6144
    ds_read_b64_tr_b16 v[50:51], v12 offset:6400
    s_waitcnt lgkmcnt(12)
    v_mfma_f32_32x32x16_bf16 v[216:231], v[152:155], v[24:27], 0
    ds_read_b64_tr_b16 v[52:53], v12 offset:7168
    ds_read_b64_tr_b16 v[54:55], v12 offset:7424
    v_xor_b32 v152, v10, v152
    v_xor_b32 v153, v10, v153
    v_xor_b32 v154, v10, v154
    v_xor_b32 v155, v10, v155
    s_waitcnt lgkmcnt(12)
    v_mfma_f32_32x32x16_bf16 v[216:231], v[156:159], v[28:31], v[216:231]
    ds_read_b64_tr_b16 v[24:25], v12 offset:8192
    ds_read_b64_tr_b16 v[26:27], v12 offset:8448
    v_xor_b32 v156, v10, v156
    v_xor_b32 v157, v10, v157
    v_xor_b32 v158, v10, v158
    v_xor_b32 v159, v10, v159
    s_waitcnt lgkmcnt(12)
    v_mfma_f32_32x32x16_bf16 v[216:231], v[160:163], v[32:35], v[216:231]
    ds_read_b64_tr_b16 v[28:29], v12 offset:9216
    ds_read_b64_tr_b16 v[30:31], v12 offset:9472
    v_xor_b32 v160, v10, v160
    v_xor_b32 v161, v10, v161
    v_xor_b32 v162, v10, v162
    v_xor_b32 v163, v10, v163
    s_waitcnt lgkmcnt(12)
    v_mfma_f32_32x32x16_bf16 v[216:231], v[164:167], v[36:39], v[216:231]
    ds_read_b64_tr_b16 v[32:33], v12 offset:10240
    ds_read_b64_tr_b16 v[34:35], v12 offset:10496
    v_xor_b32 v164, v10, v164
    v_xor_b32 v165, v10, v165
    v_xor_b32 v166, v10, v166
    v_xor_b32 v167, v10, v167
    s_waitcnt lgkmcnt(12)
    v_mfma_f32_32x32x16_bf16 v[216:231], v[168:171], v[40:43], v[216:231]
    ds_read_b64_tr_b16 v[36:37], v12 offset:11264
    ds_read_b64_tr_b16 v[38:39], v12 offset:11520
    v_xor_b32 v168, v10, v168
    v_xor_b32 v169, v10, v169
    v_xor_b32 v170, v10, v170
    v_xor_b32 v171, v10, v171
    s_waitcnt lgkmcnt(12)
    v_mfma_f32_32x32x16_bf16 v[216:231], v[172:175], v[44:47], v[216:231]
    ds_read_b64_tr_b16 v[40:41], v12 offset:12288
    ds_read_b64_tr_b16 v[42:43], v12 offset:12544
    v_xor_b32 v172, v10, v172
    v_xor_b32 v173, v10, v173
    v_xor_b32 v174, v10, v174
    v_xor_b32 v175, v10, v175
    s_waitcnt lgkmcnt(12)
    v_mfma_f32_32x32x16_bf16 v[216:231], v[176:179], v[48:51], v[216:231]
    ds_read_b64_tr_b16 v[44:45], v12 offset:13312
    ds_read_b64_tr_b16 v[46:47], v12 offset:13568
    v_xor_b32 v176, v10, v176
    v_xor_b32 v177, v10, v177
    v_xor_b32 v178, v10, v178
    v_xor_b32 v179, v10, v179
    s_waitcnt lgkmcnt(12)
    v_mfma_f32_32x32x16_bf16 v[216:231], v[180:183], v[52:55], v[216:231]
    ds_read_b64_tr_b16 v[48:49], v12 offset:14336
    ds_read_b64_tr_b16 v[50:51], v12 offset:14592
    v_xor_b32 v180, v10, v180
    v_xor_b32 v181, v10, v181
    v_xor_b32 v182, v10, v182
    v_xor_b32 v183, v10, v183
    s_waitcnt lgkmcnt(12)
    v_mfma_f32_32x32x16_bf16 v[216:231], v[184:187], v[24:27], v[216:231]
    ds_read_b64_tr_b16 v[52:53], v12 offset:15360
    ds_read_b64_tr_b16 v[54:55], v12 offset:15616
    v_xor_b32 v184, v10, v184
    v_xor_b32 v185, v10, v185
    v_xor_b32 v186, v10, v186
    v_xor_b32 v187, v10, v187
    s_waitcnt lgkmcnt(12)
    v_mfma_f32_32x32x16_bf16 v[216:231], v[188:191], v[28:31], v[216:231]
    ds_read_b64_tr_b16 v[24:25], v12 offset:16384
    ds_read_b64_tr_b16 v[26:27], v12 offset:16640
    v_xor_b32 v188, v10, v188
    v_xor_b32 v189, v10, v189
    v_xor_b32 v190, v10, v190
    v_xor_b32 v191, v10, v191
    s_waitcnt lgkmcnt(12)
    v_mfma_f32_32x32x16_bf16 v[216:231], v[192:195], v[32:35], v[216:231]
    ds_read_b64_tr_b16 v[28:29], v12 offset:17408
    ds_read_b64_tr_b16 v[30:31], v12 offset:17664
    v_xor_b32 v192, v10, v192
    v_xor_b32 v193, v10, v193
    v_xor_b32 v194, v10, v194
    v_xor_b32 v195, v10, v195
    s_waitcnt lgkmcnt(12)
    v_mfma_f32_32x32x16_bf16 v[216:231], v[196:199], v[36:39], v[216:231]
    ds_read_b64_tr_b16 v[32:33], v12 offset:18432
    ds_read_b64_tr_b16 v[34:35], v12 offset:18688
    v_xor_b32 v196, v10, v196
    v_xor_b32 v197, v10, v197
    v_xor_b32 v198, v10, v198
    v_xor_b32 v199, v10, v199
    s_waitcnt lgkmcnt(12)
    v_mfma_f32_32x32x16_bf16 v[216:231], v[200:203], v[40:43], v[216:231]
    ds_read_b64_tr_b16 v[36:37], v12 offset:19456
    ds_read_b64_tr_b16 v[38:39], v12 offset:19712
    v_xor_b32 v200, v10, v200
    v_xor_b32 v201, v10, v201
    v_xor_b32 v202, v10, v202
    v_xor_b32 v203, v10, v203
    s_waitcnt lgkmcnt(12)
    v_mfma_f32_32x32x16_bf16 v[216:231], v[204:207], v[44:47], v[216:231]
    ds_read_b64_tr_b16 v[40:41], v12 offset:20480
    ds_read_b64_tr_b16 v[42:43], v12 offset:20736
    v_xor_b32 v204, v10, v204
    v_xor_b32 v205, v10, v205
    v_xor_b32 v206, v10, v206
    v_xor_b32 v207, v10, v207
    s_waitcnt lgkmcnt(12)
    v_mfma_f32_32x32x16_bf16 v[216:231], v[208:211], v[48:51], v[216:231]
    ds_read_b64_tr_b16 v[44:45], v12 offset:21504
    ds_read_b64_tr_b16 v[46:47], v12 offset:21760
    v_xor_b32 v208, v10, v208
    v_xor_b32 v209, v10, v209
    v_xor_b32 v210, v10, v210
    v_xor_b32 v211, v10, v211
    s_waitcnt lgkmcnt(12)
    v_mfma_f32_32x32x16_bf16 v[216:231], v[212:215], v[52:55], v[216:231]
    ds_read_b64_tr_b16 v[48:49], v12 offset:22528
    ds_read_b64_tr_b16 v[50:51], v12 offset:22784
    v_xor_b32 v212, v10, v212
    v_xor_b32 v213, v10, v213
    v_xor_b32 v214, v10, v214
    v_xor_b32 v215, v10, v215
    s_waitcnt lgkmcnt(12)
    v_mfma_f32_32x32x16_bf16 v[216:231], v[152:155], v[24:27], v[216:231]
    ds_read_b64_tr_b16 v[52:53], v12 offset:23552
    ds_read_b64_tr_b16 v[54:55], v12 offset:23808
    s_waitcnt lgkmcnt(12)
    v_mfma_f32_32x32x16_bf16 v[216:231], v[156:159], v[28:31], v[216:231]
    ds_read_b64_tr_b16 v[24:25], v12 offset:24576
    ds_read_b64_tr_b16 v[26:27], v12 offset:24832
    s_waitcnt lgkmcnt(12)
    v_mfma_f32_32x32x16_bf16 v[216:231], v[160:163], v[32:35], v[216:231]
    ds_read_b64_tr_b16 v[28:29], v12 offset:25600
    ds_read_b64_tr_b16 v[30:31], v12 offset:25856
    s_waitcnt lgkmcnt(12)
    v_mfma_f32_32x32x16_bf16 v[216:231], v[164:167], v[36:39], v[216:231]
    ds_read_b64_tr_b16 v[32:33], v12 offset:26624
    ds_read_b64_tr_b16 v[34:35], v12 offset:26880
    s_waitcnt lgkmcnt(12)
    v_mfma_f32_32x32x16_bf16 v[216:231], v[168:171], v[40:43], v[216:231]
    ds_read_b64_tr_b16 v[36:37], v12 offset:27648
    ds_read_b64_tr_b16 v[38:39], v12 offset:27904
    s_waitcnt lgkmcnt(12)
    v_mfma_f32_32x32x16_bf16 v[216:231], v[172:175], v[44:47], v[216:231]
    ds_read_b64_tr_b16 v[40:41], v12 offset:28672
    ds_read_b64_tr_b16 v[42:43], v12 offset:28928
    s_waitcnt lgkmcnt(12)
    v_mfma_f32_32x32x16_bf16 v[216:231], v[176:179], v[48:51], v[216:231]
    ds_read_b64_tr_b16 v[44:45], v12 offset:29696
    ds_read_b64_tr_b16 v[46:47], v12 offset:29952
    s_waitcnt lgkmcnt(12)
    v_mfma_f32_32x32x16_bf16 v[216:231], v[180:183], v[52:55], v[216:231]
    ds_read_b64_tr_b16 v[48:49], v12 offset:30720
    ds_read_b64_tr_b16 v[50:51], v12 offset:30976
    s_waitcnt lgkmcnt(12)
    v_mfma_f32_32x32x16_bf16 v[216:231], v[184:187], v[24:27], v[216:231]
    ds_read_b64_tr_b16 v[52:53], v12 offset:31744
    ds_read_b64_tr_b16 v[54:55], v12 offset:32000
    s_waitcnt lgkmcnt(12)
    v_mfma_f32_32x32x16_bf16 v[216:231], v[188:191], v[28:31], v[216:231]
    s_waitcnt lgkmcnt(10)
    v_mfma_f32_32x32x16_bf16 v[216:231], v[192:195], v[32:35], v[216:231]
    s_waitcnt lgkmcnt(8)
    v_mfma_f32_32x32x16_bf16 v[216:231], v[196:199], v[36:39], v[216:231]
    s_waitcnt lgkmcnt(6)
    v_mfma_f32_32x32x16_bf16 v[216:231], v[200:203], v[40:43], v[216:231]
    s_waitcnt lgkmcnt(4)
    v_mfma_f32_32x32x16_bf16 v[216:231], v[204:207], v[44:47], v[216:231]
    s_waitcnt lgkmcnt(2)
    v_mfma_f32_32x32x16_bf16 v[216:231], v[208:211], v[48:51], v[216:231]
    s_waitcnt lgkmcnt(0)
    v_mfma_f32_32x32x16_bf16 v[216:231], v[212:215], v[52:55], v[216:231]
    s_nop 11
    v_pk_mul_f32 v[216:217], v[216:217], s[6:7]
    v_pk_mul_f32 v[218:219], v[218:219], s[6:7]
    v_pk_mul_f32 v[220:221], v[220:221], s[6:7]
    v_pk_mul_f32 v[222:223], v[222:223], s[6:7]
    v_pk_mul_f32 v[224:225], v[224:225], s[6:7]
    v_pk_mul_f32 v[226:227], v[226:227], s[6:7]
    v_pk_mul_f32 v[228:229], v[228:229], s[6:7]
    v_pk_mul_f32 v[230:231], v[230:231], s[6:7]
    v_cvt_pk_bf16_f32 v152, v216, v217
    v_cvt_pk_bf16_f32 v153, v218, v219
    v_cvt_pk_bf16_f32 v154, v220, v221
    v_cvt_pk_bf16_f32 v155, v222, v223
    v_cvt_pk_bf16_f32 v156, v224, v225
    v_cvt_pk_bf16_f32 v157, v226, v227
    v_cvt_pk_bf16_f32 v158, v228, v229
    v_cvt_pk_bf16_f32 v159, v230, v231
    buffer_store_dwordx4 v[152:155], v11, s[8:11], s30 offen sc1
    buffer_store_dwordx4 v[156:159], v11, s[8:11], s30 offen offset:512 sc1
    s_waitcnt vmcnt(0)
    v_mov_b32 v248, 151296
    v_mov_b32 v249, 1
    s_waitcnt lgkmcnt(0)
    s_mov_b64 exec, 1
    ds_add_u32 v248, v249 offset:12
    s_mov_b64 exec, -1
    s_cmp_ge_u32 s31, 256
    s_cbranch_scc1 p0_ftf
    s_lshl_b32 s42, s31, 11
    s_add_u32 s42, s42, 15990784
    s_mov_b32 s28, 0x05040100
    s_mov_b32 s29, 0x07060302
    v_perm_b32 v64, v57, v56, s28
    v_perm_b32 v65, v59, v58, s28
    v_perm_b32 v66, v61, v60, s28
    v_perm_b32 v67, v63, v62, s28
    buffer_store_dwordx4 v[64:67], v5, s[8:11], s42 offen offset:0 sc1
    v_perm_b32 v68, v57, v56, s29
    v_perm_b32 v69, v59, v58, s29
    v_perm_b32 v70, v61, v60, s29
    v_perm_b32 v71, v63, v62, s29
    buffer_store_dwordx4 v[68:71], v5, s[8:11], s42 offen offset:1024 sc1
    s_branch p0_fill
p0_ftf:
    s_sub_u32 s31, s31, 256
    s_lshr_b32 s42, s31, 5
    s_lshl_b32 s42, s42, 5
    s_and_b32 s43, s31, 1
    s_add_u32 s42, s42, s43
    v_and_b32 v6, 15, v1
    v_lshl_add_u32 v6, v6, 1, s42
    v_cvt_f32_u32 v7, v6
    v_mul_f32 v7, 0x3b000000, v7
    s_bfe_u32 s42, s31, 0x40001
    s_lshl_b32 s42, s42, 4
    v_lshrrev_b32 v9, 4, v1
    v_add_u32 v9, s42, v9
    v_cmp_eq_u32 vcc, 0, v9
    v_cvt_f32_u32 v9, v9
    v_mul_f32 v8, v9, v7
    s_mul_i32 s43, s43, 0x80008000
    s_or_b32 s43, s43, 0x3d003d00
    v_mov_b32 v10, s43
    s_lshl_b32 s42, s31, 10
    s_add_u32 s42, s42, 15466496
    v_fmamk_f32 v128, v7, 0x00000000, v8
    v_fmamk_f32 v129, v7, 0x40800000, v8
    v_fmamk_f32 v130, v7, 0x41000000, v8
    v_fmamk_f32 v131, v7, 0x41400000, v8
    v_cos_f32 v132, v128
    v_sin_f32 v136, v128
    v_cos_f32 v133, v129
    v_sin_f32 v137, v129
    v_cos_f32 v134, v130
    v_sin_f32 v138, v130
    v_cos_f32 v135, v131
    v_sin_f32 v139, v131
    v_mul_f32 v132, 0x3d800000, v132
    v_mul_f32 v136, 0xbd800000, v136
    v_mul_f32 v133, 0x3d800000, v133
    v_mul_f32 v137, 0xbd800000, v137
    v_mul_f32 v134, 0x3d800000, v134
    v_mul_f32 v138, 0xbd800000, v138
    v_mul_f32 v135, 0x3d800000, v135
    v_mul_f32 v139, 0xbd800000, v139
    v_cvt_pk_bf16_f32 v140, v132, v136
    v_cvt_pk_bf16_f32 v141, v133, v137
    v_cvt_pk_bf16_f32 v142, v134, v138
    v_cvt_pk_bf16_f32 v143, v135, v139
    v_cndmask_b32 v140, v140, v10, vcc
    buffer_store_dwordx4 v[140:143], v5, s[8:11], s42 offen sc1
    s_branch p0_fill
p0_mm2:
    v_mov_b32 v248, 151296
    v_mov_b32 v249, 1
    s_waitcnt lgkmcnt(0)
    s_mov_b64 exec, 1
    ds_add_u32 v248, v249 offset:4
    s_mov_b64 exec, -1
lw5:
    ds_read_b32 v250, v248 offset:4
    s_waitcnt lgkmcnt(0)
    v_readfirstlane_b32 s33, v250
    s_nop 0
    s_cmp_lt_u32 s33, 8
    s_cbranch_scc1 lw5
    v_lshlrev_b32 v11, 6, v13
    v_lshl_add_u32 v11, v4, 8, v11
    v_lshl_add_u32 v11, v14, 4, v11
    s_lshl_b32 s42, s54, 15
    s_lshl_b32 s43, s51, 11
    s_add_u32 s42, s42, s43
    s_add_u32 s42, s42, 14942208
    ds_read_b128 v[24:27], v12 offset:0
    ds_read_b128 v[28:31], v12 offset:32
    ds_read_b128 v[32:35], v12 offset:64
    ds_read_b128 v[36:39], v12 offset:96
    ds_read_b128 v[40:43], v12 offset:128
    ds_read_b128 v[44:47], v12 offset:160
    ds_read_b128 v[48:51], v12 offset:192
    s_waitcnt lgkmcnt(6)
    v_mfma_f32_32x32x16_bf16 v[216:231], v[24:27], v[152:155], 0
    ds_read_b128 v[52:55], v12 offset:224
    v_xor_b32 v152, v10, v152
    v_xor_b32 v153, v10, v153
    v_xor_b32 v154, v10, v154
    v_xor_b32 v155, v10, v155
    s_waitcnt lgkmcnt(6)
    v_mfma_f32_32x32x16_bf16 v[216:231], v[28:31], v[156:159], v[216:231]
    ds_read_b128 v[24:27], v12 offset:256
    v_xor_b32 v156, v10, v156
    v_xor_b32 v157, v10, v157
    v_xor_b32 v158, v10, v158
    v_xor_b32 v159, v10, v159
    s_waitcnt lgkmcnt(6)
    v_mfma_f32_32x32x16_bf16 v[216:231], v[32:35], v[160:163], v[216:231]
    ds_read_b128 v[28:31], v12 offset:288
    v_xor_b32 v160, v10, v160
    v_xor_b32 v161, v10, v161
    v_xor_b32 v162, v10, v162
    v_xor_b32 v163, v10, v163
    s_waitcnt lgkmcnt(6)
    v_mfma_f32_32x32x16_bf16 v[216:231], v[36:39], v[164:167], v[216:231]
    ds_read_b128 v[32:35], v12 offset:320
    v_xor_b32 v164, v10, v164
    v_xor_b32 v165, v10, v165
    v_xor_b32 v166, v10, v166
    v_xor_b32 v167, v10, v167
    s_waitcnt lgkmcnt(6)
    v_mfma_f32_32x32x16_bf16 v[216:231], v[40:43], v[168:171], v[216:231]
    ds_read_b128 v[36:39], v12 offset:352
    v_xor_b32 v168, v10, v168
    v_xor_b32 v169, v10, v169
    v_xor_b32 v170, v10, v170
    v_xor_b32 v171, v10, v171
    s_waitcnt lgkmcnt(6)
    v_mfma_f32_32x32x16_bf16 v[216:231], v[44:47], v[172:175], v[216:231]
    ds_read_b128 v[40:43], v12 offset:384
    v_xor_b32 v172, v10, v172
    v_xor_b32 v173, v10, v173
    v_xor_b32 v174, v10, v174
    v_xor_b32 v175, v10, v175
    s_waitcnt lgkmcnt(6)
    v_mfma_f32_32x32x16_bf16 v[216:231], v[48:51], v[176:179], v[216:231]
    ds_read_b128 v[44:47], v12 offset:416
    v_xor_b32 v176, v10, v176
    v_xor_b32 v177, v10, v177
    v_xor_b32 v178, v10, v178
    v_xor_b32 v179, v10, v179
    s_waitcnt lgkmcnt(6)
    v_mfma_f32_32x32x16_bf16 v[216:231], v[52:55], v[180:183], v[216:231]
    ds_read_b128 v[48:51], v12 offset:448
    v_xor_b32 v180, v10, v180
    v_xor_b32 v181, v10, v181
    v_xor_b32 v182, v10, v182
    v_xor_b32 v183, v10, v183
    s_waitcnt lgkmcnt(6)
    v_mfma_f32_32x32x16_bf16 v[216:231], v[24:27], v[184:187], v[216:231]
    ds_read_b128 v[52:55], v12 offset:480
    v_xor_b32 v184, v10, v184
    v_xor_b32 v185, v10, v185
    v_xor_b32 v186, v10, v186
    v_xor_b32 v187, v10, v187
    s_waitcnt lgkmcnt(6)
    v_mfma_f32_32x32x16_bf16 v[216:231], v[28:31], v[188:191], v[216:231]
    ds_read_b128 v[24:27], v12 offset:512
    v_xor_b32 v188, v10, v188
    v_xor_b32 v189, v10, v189
    v_xor_b32 v190, v10, v190
    v_xor_b32 v191, v10, v191
    s_waitcnt lgkmcnt(6)
    v_mfma_f32_32x32x16_bf16 v[216:231], v[32:35], v[192:195], v[216:231]
    ds_read_b128 v[28:31], v12 offset:544
    v_xor_b32 v192, v10, v192
    v_xor_b32 v193, v10, v193
    v_xor_b32 v194, v10, v194
    v_xor_b32 v195, v10, v195
    s_waitcnt lgkmcnt(6)
    v_mfma_f32_32x32x16_bf16 v[216:231], v[36:39], v[196:199], v[216:231]
    ds_read_b128 v[32:35], v12 offset:576
    v_xor_b32 v196, v10, v196
    v_xor_b32 v197, v10, v197
    v_xor_b32 v198, v10, v198
    v_xor_b32 v199, v10, v199
    s_waitcnt lgkmcnt(6)
    v_mfma_f32_32x32x16_bf16 v[216:231], v[40:43], v[200:203], v[216:231]
    ds_read_b128 v[36:39], v12 offset:608
    v_xor_b32 v200, v10, v200
    v_xor_b32 v201, v10, v201
    v_xor_b32 v202, v10, v202
    v_xor_b32 v203, v10, v203
    s_waitcnt lgkmcnt(6)
    v_mfma_f32_32x32x16_bf16 v[216:231], v[44:47], v[204:207], v[216:231]
    ds_read_b128 v[40:43], v12 offset:640
    v_xor_b32 v204, v10, v204
    v_xor_b32 v205, v10, v205
    v_xor_b32 v206, v10, v206
    v_xor_b32 v207, v10, v207
    s_waitcnt lgkmcnt(6)
    v_mfma_f32_32x32x16_bf16 v[216:231], v[48:51], v[208:211], v[216:231]
    ds_read_b128 v[44:47], v12 offset:672
    v_xor_b32 v208, v10, v208
    v_xor_b32 v209, v10, v209
    v_xor_b32 v210, v10, v210
    v_xor_b32 v211, v10, v211
    s_waitcnt lgkmcnt(6)
    v_mfma_f32_32x32x16_bf16 v[216:231], v[52:55], v[212:215], v[216:231]
    ds_read_b128 v[48:51], v12 offset:704
    v_xor_b32 v212, v10, v212
    v_xor_b32 v213, v10, v213
    v_xor_b32 v214, v10, v214
    v_xor_b32 v215, v10, v215
    s_waitcnt lgkmcnt(6)
    v_mfma_f32_32x32x16_bf16 v[216:231], v[24:27], v[152:155], v[216:231]
    ds_read_b128 v[52:55], v12 offset:736
    s_waitcnt lgkmcnt(6)
    v_mfma_f32_32x32x16_bf16 v[216:231], v[28:31], v[156:159], v[216:231]
    ds_read_b128 v[24:27], v12 offset:768
    s_waitcnt lgkmcnt(6)
    v_mfma_f32_32x32x16_bf16 v[216:231], v[32:35], v[160:163], v[216:231]
    ds_read_b128 v[28:31], v12 offset:800
    s_waitcnt lgkmcnt(6)
    v_mfma_f32_32x32x16_bf16 v[216:231], v[36:39], v[164:167], v[216:231]
    ds_read_b128 v[32:35], v12 offset:832
    s_waitcnt lgkmcnt(6)
    v_mfma_f32_32x32x16_bf16 v[216:231], v[40:43], v[168:171], v[216:231]
    ds_read_b128 v[36:39], v12 offset:864
    s_waitcnt lgkmcnt(6)
    v_mfma_f32_32x32x16_bf16 v[216:231], v[44:47], v[172:175], v[216:231]
    ds_read_b128 v[40:43], v12 offset:896
    s_waitcnt lgkmcnt(6)
    v_mfma_f32_32x32x16_bf16 v[216:231], v[48:51], v[176:179], v[216:231]
    ds_read_b128 v[44:47], v12 offset:928
    s_waitcnt lgkmcnt(6)
    v_mfma_f32_32x32x16_bf16 v[216:231], v[52:55], v[180:183], v[216:231]
    ds_read_b128 v[48:51], v12 offset:960
    s_waitcnt lgkmcnt(6)
    v_mfma_f32_32x32x16_bf16 v[216:231], v[24:27], v[184:187], v[216:231]
    ds_read_b128 v[52:55], v12 offset:992
    s_waitcnt lgkmcnt(6)
    v_mfma_f32_32x32x16_bf16 v[216:231], v[28:31], v[188:191], v[216:231]
    s_waitcnt lgkmcnt(5)
    v_mfma_f32_32x32x16_bf16 v[216:231], v[32:35], v[192:195], v[216:231]
    s_waitcnt lgkmcnt(4)
    v_mfma_f32_32x32x16_bf16 v[216:231], v[36:39], v[196:199], v[216:231]
    s_waitcnt lgkmcnt(3)
    v_mfma_f32_32x32x16_bf16 v[216:231], v[40:43], v[200:203], v[216:231]
    s_waitcnt lgkmcnt(2)
    v_mfma_f32_32x32x16_bf16 v[216:231], v[44:47], v[204:207], v[216:231]
    s_waitcnt lgkmcnt(1)
    v_mfma_f32_32x32x16_bf16 v[216:231], v[48:51], v[208:211], v[216:231]
    s_waitcnt lgkmcnt(0)
    v_mfma_f32_32x32x16_bf16 v[216:231], v[52:55], v[212:215], v[216:231]
    s_nop 11
    v_pk_mul_f32 v[216:217], v[216:217], s[6:7]
    v_pk_mul_f32 v[218:219], v[218:219], s[6:7]
    v_pk_mul_f32 v[220:221], v[220:221], s[6:7]
    v_pk_mul_f32 v[222:223], v[222:223], s[6:7]
    v_pk_mul_f32 v[224:225], v[224:225], s[6:7]
    v_pk_mul_f32 v[226:227], v[226:227], s[6:7]
    v_pk_mul_f32 v[228:229], v[228:229], s[6:7]
    v_pk_mul_f32 v[230:231], v[230:231], s[6:7]
    v_cvt_pk_bf16_f32 v152, v216, v217
    v_cvt_pk_bf16_f32 v153, v218, v219
    v_cvt_pk_bf16_f32 v154, v220, v221
    v_cvt_pk_bf16_f32 v155, v222, v223
    v_cvt_pk_bf16_f32 v156, v224, v225
    v_cvt_pk_bf16_f32 v157, v226, v227
    v_cvt_pk_bf16_f32 v158, v228, v229
    v_cvt_pk_bf16_f32 v159, v230, v231
    buffer_store_dwordx4 v[152:155], v11, s[8:11], s42 offen sc1
    buffer_store_dwordx4 v[156:159], v11, s[8:11], s42 offen offset:512 sc1
    v_mov_b32 v248, 151296
    v_mov_b32 v249, 1
    s_waitcnt lgkmcnt(0)
    s_mov_b64 exec, 1
    ds_add_u32 v248, v249 offset:12
    s_mov_b64 exec, -1
p0_fill:
    s_cmp_lg_u32 s20, 6
    s_cbranch_scc1 p0_na1
    v_mov_b32 v248, 151296
lw6:
    s_sleep 1
    ds_read_b32 v250, v248 offset:12
    s_waitcnt lgkmcnt(0)
    v_readfirstlane_b32 s33, v250
    s_nop 0
    s_cmp_lt_u32 s33, 4
    s_cbranch_scc1 lw6
lw7:
    s_sleep 2
    ds_read_b32 v250, v248 offset:0
    s_waitcnt lgkmcnt(0)
    v_readfirstlane_b32 s33, v250
    s_nop 0
    s_cmp_lt_u32 s33, 5
    s_cbranch_scc1 lw7
    s_mov_b32 s30, 4046848
    s_and_b32 s33, s2, 15
    s_lshl_b32 s34, s33, 8
    s_add_u32 s34, s34, s30
    v_mov_b32 v204, 0
    v_mov_b32 v205, 1
    s_mov_b64 exec, 1
    buffer_atomic_add v205, v204, s[8:11], s34 offen sc0 sc1
    s_lshl_b32 s33, s33, 2
    s_add_u32 s34, s30, 4096
    s_add_u32 s34, s34, s33
    s_waitcnt vmcnt(0)
    v_readfirstlane_b32 s35, v205
    s_mov_b64 exec, -1
    s_cmp_lg_u32 s35, 15
    s_cbranch_scc1 ar8_done
    v_and_b32 v204, 31, v1
    v_lshlrev_b32 v204, 8, v204
    v_mov_b32 v205, 1
    buffer_store_dword v205, v204, s[8:11], s34 offen sc1
ar8_done:
p0_na1:
    v_mov_b32 v248, 151296
lw9:
    s_sleep 2
    ds_read_b32 v250, v248 offset:0
    s_waitcnt lgkmcnt(0)
    v_readfirstlane_b32 s33, v250
    s_nop 0
    s_cmp_lt_u32 s33, 9
    s_cbranch_scc1 lw9
    s_branch fft_b_go
fft_l2:
    s_cmp_ge_u32 s20, 4
    s_cbranch_scc1 fft_b2
p0_a_consts:
    s_and_b32 s24, s2, 7
    s_lshl_b32 s24, s24, 5
    s_lshr_b32 s25, s2, 3
    s_add_u32 s24, s24, s25
    s_mul_i32 s24, s24, 8448
    v_lshlrev_b32 v3, 4, v0
    v_and_b32 v4, 15, v1
    v_lshrrev_b32 v5, 4, v1
    v_lshlrev_b32 v6, 4, v1
    s_lshl_b32 s26, s20, 4
    v_add_u32 v7, s26, v4
    v_lshlrev_b32 v2, 10, v5
    v_lshl_add_u32 v2, v7, 2, v2
    s_add_u32 s22, s44, s24
    s_add_u32 s23, s22, 4096
    s_add_u32 s27, s46, 4096
    s_add_u32 s28, s46, 8192
    s_add_u32 s29, s46, 12288
    v_add_u32 v247, 139776, v3
    v_lshrrev_b32 v240, 4, v0
    v_mul_u32_u24 v240, 272, v240
    v_lshl_add_u32 v240, v4, 4, v240
    v_add_u32 v240, 36864, v240
    v_mul_u32_u24 v241, 272, v4
    v_lshl_add_u32 v241, v5, 4, v241
    v_add_u32 v241, 36864, v241
    v_mul_u32_u24 v242, 1088, v5
    v_lshl_add_u32 v242, v7, 2, v242
    v_add_u32 v242, 36864, v242
    s_lshl_b32 s30, s20, 10
    s_add_u32 s30, s30, 45568
    v_add_u32 v243, s30, v6
    v_add_u32 v244, 45568, v6
    v_mov_b32 v245, 0x3727c5ac
    v_add_u32 v246, 155648, v3
    s_cmp_eq_u32 s21, 0
    s_cbranch_scc1 fft_now
    ds_read_b128 v[48:51], v246
    ds_read_b128 v[52:55], v246 offset:4096
    ds_read_b128 v[32:35], v247
    ds_read_b128 v[36:39], v247 offset:4096
fft_now:
    v_cvt_f32_u32 v224, v7
    v_mul_f32 v224, 0xbc800000, v224
    v_cvt_f32_u32 v225, v5
    v_mul_f32 v225, 4.0, v225
    v_mul_f32 v226, v225, v224
    v_fmamk_f32 v228, v224, 0x00000000, v226
    v_fmamk_f32 v229, v224, 0x3f800000, v226
    v_fmamk_f32 v230, v224, 0x40000000, v226
    v_fmamk_f32 v231, v224, 0x40400000, v226
    v_cos_f32 v232, v228
    v_sin_f32 v236, v228
    v_cos_f32 v233, v229
    v_sin_f32 v237, v229
    v_cos_f32 v234, v230
    v_sin_f32 v238, v230
    v_cos_f32 v235, v231
    v_sin_f32 v239, v231
    v_cvt_pk_bf16_f32 v56, v232, -v236
    v_cvt_pk_bf16_f32 v72, v236, v232
    v_cvt_pk_bf16_f32 v57, v233, -v237
    v_cvt_pk_bf16_f32 v73, v237, v233
    v_cvt_pk_bf16_f32 v58, v234, -v238
    v_cvt_pk_bf16_f32 v74, v238, v234
    v_cvt_pk_bf16_f32 v59, v235, -v239
    v_cvt_pk_bf16_f32 v75, v239, v235
    v_fmamk_f32 v228, v224, 0x41800000, v226
    v_fmamk_f32 v229, v224, 0x41880000, v226
    v_fmamk_f32 v230, v224, 0x41900000, v226
    v_fmamk_f32 v231, v224, 0x41980000, v226
    v_cos_f32 v232, v228
    v_sin_f32 v236, v228
    v_cos_f32 v233, v229
    v_sin_f32 v237, v229
    v_cos_f32 v234, v230
    v_sin_f32 v238, v230
    v_cos_f32 v235, v231
    v_sin_f32 v239, v231
    v_cvt_pk_bf16_f32 v60, v232, -v236
    v_cvt_pk_bf16_f32 v76, v236, v232
    v_cvt_pk_bf16_f32 v61, v233, -v237
    v_cvt_pk_bf16_f32 v77, v237, v233
    v_cvt_pk_bf16_f32 v62, v234, -v238
    v_cvt_pk_bf16_f32 v78, v238, v234
    v_cvt_pk_bf16_f32 v63, v235, -v239
    v_cvt_pk_bf16_f32 v79, v239, v235
    v_fmamk_f32 v228, v224, 0x42000000, v226
    v_fmamk_f32 v229, v224, 0x42040000, v226
    v_fmamk_f32 v230, v224, 0x42080000, v226
    v_fmamk_f32 v231, v224, 0x420c0000, v226
    v_cos_f32 v232, v228
    v_sin_f32 v236, v228
    v_cos_f32 v233, v229
    v_sin_f32 v237, v229
    v_cos_f32 v234, v230
    v_sin_f32 v238, v230
    v_cos_f32 v235, v231
    v_sin_f32 v239, v231
    v_cvt_pk_bf16_f32 v64, v232, -v236
    v_cvt_pk_bf16_f32 v80, v236, v232
    v_cvt_pk_bf16_f32 v65, v233, -v237
    v_cvt_pk_bf16_f32 v81, v237, v233
    v_cvt_pk_bf16_f32 v66, v234, -v238
    v_cvt_pk_bf16_f32 v82, v238, v234
    v_cvt_pk_bf16_f32 v67, v235, -v239
    v_cvt_pk_bf16_f32 v83, v239, v235
    v_fmamk_f32 v228, v224, 0x42400000, v226
    v_fmamk_f32 v229, v224, 0x42440000, v226
    v_fmamk_f32 v230, v224, 0x42480000, v226
    v_fmamk_f32 v231, v224, 0x424c0000, v226
    v_cos_f32 v232, v228
    v_sin_f32 v236, v228
    v_cos_f32 v233, v229
    v_sin_f32 v237, v229
    v_cos_f32 v234, v230
    v_sin_f32 v238, v230
    v_cos_f32 v235, v231
    v_sin_f32 v239, v231
    v_cvt_pk_bf16_f32 v68, v232, -v236
    v_cvt_pk_bf16_f32 v84, v236, v232
    v_cvt_pk_bf16_f32 v69, v233, -v237
    v_cvt_pk_bf16_f32 v85, v237, v233
    v_cvt_pk_bf16_f32 v70, v234, -v238
    v_cvt_pk_bf16_f32 v86, v238, v234
    v_cvt_pk_bf16_f32 v71, v235, -v239
    v_cvt_pk_bf16_f32 v87, v239, v235
    v_mul_f32 v227, 0x3d000000, v224
    v_mul_f32 v226, v225, v227
    v_fmamk_f32 v228, v227, 0x00000000, v226
    v_fmamk_f32 v229, v227, 0x3f800000, v226
    v_fmamk_f32 v230, v227, 0x40000000, v226
    v_fmamk_f32 v231, v227, 0x40400000, v226
    v_cos_f32 v120, v228
    v_sin_f32 v128, v228
    v_cos_f32 v121, v229
    v_sin_f32 v129, v229
    v_cos_f32 v122, v230
    v_sin_f32 v130, v230
    v_cos_f32 v123, v231
    v_sin_f32 v131, v231
    v_fmamk_f32 v228, v227, 0x41800000, v226
    v_fmamk_f32 v229, v227, 0x41880000, v226
    v_fmamk_f32 v230, v227, 0x41900000, v226
    v_fmamk_f32 v231, v227, 0x41980000, v226
    v_cos_f32 v124, v228
    v_sin_f32 v132, v228
    v_cos_f32 v125, v229
    v_sin_f32 v133, v229
    v_cos_f32 v126, v230
    v_sin_f32 v134, v230
    v_cos_f32 v127, v231
    v_sin_f32 v135, v231
    v_add_u32 v227, 0, v4
    v_cvt_f32_u32 v227, v227
    v_mul_f32 v227, 0xbd000000, v227
    v_mul_f32 v226, v225, v227
    v_fmamk_f32 v228, v227, 0x00000000, v226
    v_fmamk_f32 v229, v227, 0x3f800000, v226
    v_fmamk_f32 v230, v227, 0x40000000, v226
    v_fmamk_f32 v231, v227, 0x40400000, v226
    v_cos_f32 v232, v228
    v_sin_f32 v236, v228
    v_cos_f32 v233, v229
    v_sin_f32 v237, v229
    v_cos_f32 v234, v230
    v_sin_f32 v238, v230
    v_cos_f32 v235, v231
    v_sin_f32 v239, v231
    v_cvt_pk_bf16_f32 v88, v232, -v236
    v_cvt_pk_bf16_f32 v104, v236, v232
    v_cvt_pk_bf16_f32 v89, v233, -v237
    v_cvt_pk_bf16_f32 v105, v237, v233
    v_cvt_pk_bf16_f32 v90, v234, -v238
    v_cvt_pk_bf16_f32 v106, v238, v234
    v_cvt_pk_bf16_f32 v91, v235, -v239
    v_cvt_pk_bf16_f32 v107, v239, v235
    v_fmamk_f32 v228, v227, 0x41800000, v226
    v_fmamk_f32 v229, v227, 0x41880000, v226
    v_fmamk_f32 v230, v227, 0x41900000, v226
    v_fmamk_f32 v231, v227, 0x41980000, v226
    v_cos_f32 v232, v228
    v_sin_f32 v236, v228
    v_cos_f32 v233, v229
    v_sin_f32 v237, v229
    v_cos_f32 v234, v230
    v_sin_f32 v238, v230
    v_cos_f32 v235, v231
    v_sin_f32 v239, v231
    v_cvt_pk_bf16_f32 v92, v232, -v236
    v_cvt_pk_bf16_f32 v108, v236, v232
    v_cvt_pk_bf16_f32 v93, v233, -v237
    v_cvt_pk_bf16_f32 v109, v237, v233
    v_cvt_pk_bf16_f32 v94, v234, -v238
    v_cvt_pk_bf16_f32 v110, v238, v234
    v_cvt_pk_bf16_f32 v95, v235, -v239
    v_cvt_pk_bf16_f32 v111, v239, v235
    v_add_u32 v227, 16, v4
    v_cvt_f32_u32 v227, v227
    v_mul_f32 v227, 0xbd000000, v227
    v_mul_f32 v226, v225, v227
    v_fmamk_f32 v228, v227, 0x00000000, v226
    v_fmamk_f32 v229, v227, 0x3f800000, v226
    v_fmamk_f32 v230, v227, 0x40000000, v226
    v_fmamk_f32 v231, v227, 0x40400000, v226
    v_cos_f32 v232, v228
    v_sin_f32 v236, v228
    v_cos_f32 v233, v229
    v_sin_f32 v237, v229
    v_cos_f32 v234, v230
    v_sin_f32 v238, v230
    v_cos_f32 v235, v231
    v_sin_f32 v239, v231
    v_cvt_pk_bf16_f32 v96, v232, -v236
    v_cvt_pk_bf16_f32 v112, v236, v232
    v_cvt_pk_bf16_f32 v97, v233, -v237
    v_cvt_pk_bf16_f32 v113, v237, v233
    v_cvt_pk_bf16_f32 v98, v234, -v238
    v_cvt_pk_bf16_f32 v114, v238, v234
    v_cvt_pk_bf16_f32 v99, v235, -v239
    v_cvt_pk_bf16_f32 v115, v239, v235
    v_fmamk_f32 v228, v227, 0x41800000, v226
    v_fmamk_f32 v229, v227, 0x41880000, v226
    v_fmamk_f32 v230, v227, 0x41900000, v226
    v_fmamk_f32 v231, v227, 0x41980000, v226
    v_cos_f32 v232, v228
    v_sin_f32 v236, v228
    v_cos_f32 v233, v229
    v_sin_f32 v237, v229
    v_cos_f32 v234, v230
    v_sin_f32 v238, v230
    v_cos_f32 v235, v231
    v_sin_f32 v239, v231
    v_cvt_pk_bf16_f32 v100, v232, -v236
    v_cvt_pk_bf16_f32 v116, v236, v232
    v_cvt_pk_bf16_f32 v101, v233, -v237
    v_cvt_pk_bf16_f32 v117, v237, v233
    v_cvt_pk_bf16_f32 v102, v234, -v238
    v_cvt_pk_bf16_f32 v118, v238, v234
    v_cvt_pk_bf16_f32 v103, v235, -v239
    v_cvt_pk_bf16_f32 v119, v239, v235
    v_lshl_add_u32 v224, v5, 2, s26
    v_cvt_f32_u32 v224, v224
    v_add_u32 v227, 0, v4
    v_cvt_f32_u32 v227, v227
    v_mul_f32 v227, 0x3a000000, v227
    v_mul_f32 v226, v224, v227
    v_fmamk_f32 v228, v227, 0x00000000, v226
    v_fmamk_f32 v229, v227, 0x3f800000, v226
    v_fmamk_f32 v230, v227, 0x40000000, v226
    v_fmamk_f32 v231, v227, 0x40400000, v226
    v_cos_f32 v136, v228
    v_sin_f32 v144, v228
    v_cos_f32 v137, v229
    v_sin_f32 v145, v229
    v_cos_f32 v138, v230
    v_sin_f32 v146, v230
    v_cos_f32 v139, v231
    v_sin_f32 v147, v231
    v_add_u32 v227, 16, v4
    v_cvt_f32_u32 v227, v227
    v_mul_f32 v227, 0x3a000000, v227
    v_mul_f32 v226, v224, v227
    v_fmamk_f32 v228, v227, 0x00000000, v226
    v_fmamk_f32 v229, v227, 0x3f800000, v226
    v_fmamk_f32 v230, v227, 0x40000000, v226
    v_fmamk_f32 v231, v227, 0x40400000, v226
    v_cos_f32 v140, v228
    v_sin_f32 v148, v228
    v_cos_f32 v141, v229
    v_sin_f32 v149, v229
    v_cos_f32 v142, v230
    v_sin_f32 v150, v230
    v_cos_f32 v143, v231
    v_sin_f32 v151, v231
    v_mul_f32 v136, 0x3a000000, v136
    v_mul_f32 v137, 0x3a000000, v137
    v_mul_f32 v138, 0x3a000000, v138
    v_mul_f32 v139, 0x3a000000, v139
    v_mul_f32 v140, 0x3a000000, v140
    v_mul_f32 v141, 0x3a000000, v141
    v_mul_f32 v142, 0x3a000000, v142
    v_mul_f32 v143, 0x3a000000, v143
    v_mul_f32 v144, 0x3a000000, v144
    v_mul_f32 v145, 0x3a000000, v145
    v_mul_f32 v146, 0x3a000000, v146
    v_mul_f32 v147, 0x3a000000, v147
    v_mul_f32 v148, 0x3a000000, v148
    v_mul_f32 v149, 0x3a000000, v149
    v_mul_f32 v150, 0x3a000000, v150
    v_mul_f32 v151, 0x3a000000, v151
    s_cmp_lg_u32 s21, 0
    s_cbranch_scc1 fft_poll0
    s_branch p0_a_mm
p0_a_done:
    v_mov_b32 v48, 0
    v_mov_b32 v49, 0
    v_mov_b32 v50, 0
    v_mov_b32 v51, 0
    v_mov_b32 v52, 0
    v_mov_b32 v53, 0
    v_mov_b32 v54, 0
    v_mov_b32 v55, 0
    v_mov_b32 v252, -1
    v_mov_b32 v253, -1
    v_mov_b32 v254, -1
    v_mov_b32 v255, -1
    s_waitcnt vmcnt(0)
    v_mov_b32 v248, 151296
    v_mov_b32 v249, 1
    s_waitcnt lgkmcnt(0)
    s_mov_b64 exec, 1
    ds_add_u32 v248, v249 offset:8
    s_mov_b64 exec, -1
    s_cmp_lg_u32 s20, 1
    s_cbranch_scc1 p0_notouch
    v_lshlrev_b32 v224, 21, v1
    buffer_load_dword v225, v224, s[8:11], 0 offen sc1
    buffer_load_dword v226, v224, s[16:19], 0 offen sc1
p0_notouch:
    s_mov_b32 s32, 5
    s_cmp_lg_u32 s20, 0
    s_cbranch_scc1 seam0_other
    s_mov_b32 s56, s38
    s_and_b32 s57, s39, 0xffff
    s_mov_b32 s58, 256
    s_mov_b32 s59, 0x20000
    s_mov_b32 s35, 0
    v_cmp_ne_u32 vcc, 1, v201
    s_nop 4
    s_cbranch_vccz flag_ok
flag_poll:
    buffer_load_dword v201, v200, s[56:59], 0 offen sc1
    s_waitcnt vmcnt(0)
    v_cmp_ne_u32 vcc, 1, v201
    s_add_u32 s35, s35, 1
    s_cmp_gt_u32 s35, 262144
    s_cbranch_scc1 flag_ok
    s_nop 1
    s_cbranch_vccz flag_ok
    s_sleep 4
    s_branch flag_poll
flag_ok:
lw10:
    ds_read_b32 v250, v248 offset:8
    s_waitcnt lgkmcnt(0)
    v_readfirstlane_b32 s33, v250
    s_nop 0
    s_cmp_lt_u32 s33, s47
    s_cbranch_scc1 lw10
    s_mov_b32 s30, 4030464
    s_and_b32 s33, s2, 15
    s_lshl_b32 s34, s33, 8
    s_add_u32 s34, s34, s30
    v_mov_b32 v224, 0
    v_mov_b32 v225, 1
    s_mov_b64 exec, 1
    buffer_atomic_add v225, v224, s[8:11], s34 offen sc0 sc1
    s_lshl_b32 s33, s33, 2
    s_add_u32 s34, s30, 4096
    s_add_u32 s34, s34, s33
    s_waitcnt vmcnt(0)
    v_readfirstlane_b32 s35, v225
    s_mov_b64 exec, -1
    s_cmp_lg_u32 s35, 15
    s_cbranch_scc1 ar11_done
    v_and_b32 v224, 31, v1
    v_lshlrev_b32 v224, 8, v224
    v_mov_b32 v225, 1
    buffer_store_dword v225, v224, s[8:11], s34 offen sc1
ar11_done:
    s_lshl_b32 s30, s20, 11
    s_lshl_b32 s31, s2, 13
    s_add_u32 s30, s30, s31
    s_add_u32 s30, s30, 4194304
    s_lshr_b32 s31, s2, 3
    s_lshl_b32 s31, s31, 16
    s_and_b32 s34, s2, 7
    s_lshl_b32 s34, s34, 11
    s_add_u32 s31, s31, s34
    s_and_b32 s34, s20, 1
    s_lshl_b32 s34, s34, 10
    s_add_u32 s31, s31, s34
    s_lshr_b32 s34, s20, 1
    s_lshl_b32 s34, s34, 21
    s_add_u32 s31, s31, s34
    s_add_u32 s31, s31, 6291456
    buffer_store_dwordx4 v[252:255], v6, s[8:11], s30 offen sc1
    buffer_store_dwordx4 v[252:255], v6, s[8:11], s30 offen offset:1024 sc1
    buffer_store_dwordx4 v[252:255], v6, s[8:11], s31 offen sc1
    s_mov_b32 s30, 4030464
    s_and_b32 s34, s2, 31
    s_lshl_b32 s34, s34, 8
    s_add_u32 s34, s34, 4096
    s_add_u32 s34, s34, s30
    s_mov_b32 s35, 0
    v_and_b32 v224, 15, v1
    v_lshlrev_b32 v224, 2, v224
gw12_poll:
    buffer_load_dword v225, v224, s[8:11], s34 offen sc1
    s_waitcnt vmcnt(0)
    v_cmp_ne_u32 vcc, 1, v225
    s_add_u32 s35, s35, 1
    s_cmp_gt_u32 s35, 262144
    s_cbranch_scc1 gw12_ok
    s_nop 1
    s_cbranch_vccz gw12_ok
    s_sleep 4
    s_branch gw12_poll
gw12_ok:
    v_mov_b32 v248, 151296
    v_mov_b32 v249, 1
    s_waitcnt lgkmcnt(0)
    s_mov_b64 exec, 1
    ds_add_u32 v248, v249 offset:0
    s_mov_b64 exec, -1
    s_branch seam0_w
seam0_other:
lw13:
    ds_read_b32 v250, v248 offset:8
    s_waitcnt lgkmcnt(0)
    v_readfirstlane_b32 s33, v250
    s_nop 0
    s_cmp_lt_u32 s33, s47
    s_cbranch_scc1 lw13
    s_sleep 32
    s_lshl_b32 s30, s20, 11
    s_lshl_b32 s31, s2, 13
    s_add_u32 s30, s30, s31
    s_add_u32 s30, s30, 4194304
    s_lshr_b32 s31, s2, 3
    s_lshl_b32 s31, s31, 16
    s_and_b32 s34, s2, 7
    s_lshl_b32 s34, s34, 11
    s_add_u32 s31, s31, s34
    s_and_b32 s34, s20, 1
    s_lshl_b32 s34, s34, 10
    s_add_u32 s31, s31, s34
    s_lshr_b32 s34, s20, 1
    s_lshl_b32 s34, s34, 21
    s_add_u32 s31, s31, s34
    s_add_u32 s31, s31, 6291456
    buffer_store_dwordx4 v[252:255], v6, s[8:11], s30 offen sc1
    buffer_store_dwordx4 v[252:255], v6, s[8:11], s30 offen offset:1024 sc1
    buffer_store_dwordx4 v[252:255], v6, s[8:11], s31 offen sc1
seam0_w:
lw14:
    ds_read_b32 v250, v248 offset:0
    s_waitcnt lgkmcnt(0)
    v_readfirstlane_b32 s33, v250
    s_nop 0
    s_cmp_lt_u32 s33, s32
    s_cbranch_scc1 lw14
    buffer_load_dwordx4 v[8:11], v3, s[8:11], s22 offen sc1
    buffer_load_dwordx4 v[12:15], v3, s[8:11], s23 offen sc1
    buffer_load_dwordx4 v[16:19], v3, s[8:11], s46 offen sc1
    buffer_load_dwordx4 v[20:23], v3, s[8:11], s27 offen sc1
    buffer_load_dwordx4 v[24:27], v3, s[8:11], s28 offen sc1
    buffer_load_dwordx4 v[28:31], v3, s[8:11], s29 offen sc1
    s_lshl_b32 s25, s20, 11
    s_add_u32 s25, s25, s24
    s_add_u32 s25, s25, 12582912
    buffer_load_dwordx4 v[32:35], v6, s[8:11], s25 offen sc1
    buffer_load_dwordx4 v[36:39], v6, s[8:11], s25 offen offset:1024 sc1
    s_waitcnt vmcnt(0)
    s_branch fft_go
fft_poll0:
    s_mov_b32 s35, 0
fft_poll:
    buffer_load_dwordx4 v[8:11], v3, s[8:11], s22 offen sc1
    buffer_load_dwordx4 v[12:15], v3, s[8:11], s23 offen sc1
    buffer_load_dwordx4 v[16:19], v3, s[8:11], s46 offen sc1
    buffer_load_dwordx4 v[20:23], v3, s[8:11], s27 offen sc1
    buffer_load_dwordx4 v[24:27], v3, s[8:11], s28 offen sc1
    buffer_load_dwordx4 v[28:31], v3, s[8:11], s29 offen sc1
    s_waitcnt vmcnt(0)
    v_or3_b32 v225, v8, v9, v10
    v_or3_b32 v225, v225, v11, v12
    v_or3_b32 v225, v225, v13, v14
    v_or_b32 v225, v225, v15
    v_bfe_i32 v225, v225, 0, 1
    v_max3_u32 v224, v225, v16, v17
    v_max3_u32 v224, v224, v18, v19
    v_max3_u32 v224, v224, v20, v21
    v_max3_u32 v224, v224, v22, v23
    v_max3_u32 v224, v224, v24, v25
    v_max3_u32 v224, v224, v26, v27
    v_max3_u32 v224, v224, v28, v29
    v_max3_u32 v224, v224, v30, v31
    v_cmp_eq_u32 vcc, -1, v224
    s_add_u32 s35, s35, 1
    s_cmp_gt_u32 s35, 262144
    s_cbranch_scc1 fft_go
    s_nop 1
    s_cbranch_vccz fft_go
    s_sleep 4
    s_branch fft_poll
fft_go:
    ds_write_b128 v240, v[8:11] offset:16896
    ds_write_b128 v240, v[12:15] offset:21248
    v_pk_add_f32 v[16:17], v[16:17], v[24:25]
    v_pk_add_f32 v[18:19], v[18:19], v[26:27]
    v_pk_add_f32 v[20:21], v[20:21], v[28:29]
    v_pk_add_f32 v[22:23], v[22:23], v[30:31]
    v_fmamk_f32 v16, v16, 0x3b000000, v245
    v_fmamk_f32 v17, v17, 0x3b000000, v245
    v_fmamk_f32 v18, v18, 0x3b000000, v245
    v_fmamk_f32 v19, v19, 0x3b000000, v245
    v_fmamk_f32 v20, v20, 0x3b000000, v245
    v_fmamk_f32 v21, v21, 0x3b000000, v245
    v_fmamk_f32 v22, v22, 0x3b000000, v245
    v_fmamk_f32 v23, v23, 0x3b000000, v245
    v_rsq_f32 v16, v16
    v_rsq_f32 v17, v17
    v_rsq_f32 v18, v18
    v_rsq_f32 v19, v19
    v_rsq_f32 v20, v20
    v_rsq_f32 v21, v21
    v_rsq_f32 v22, v22
    v_rsq_f32 v23, v23
    v_lshlrev_b32 v24, 16, v8
    v_and_b32 v8, 0xffff0000, v8
    v_lshlrev_b32 v25, 16, v9
    v_and_b32 v9, 0xffff0000, v9
    v_lshlrev_b32 v26, 16, v10
    v_and_b32 v10, 0xffff0000, v10
    v_lshlrev_b32 v27, 16, v11
    v_and_b32 v11, 0xffff0000, v11
    v_lshlrev_b32 v28, 16, v12
    v_and_b32 v12, 0xffff0000, v12
    v_lshlrev_b32 v29, 16, v13
    v_and_b32 v13, 0xffff0000, v13
    v_lshlrev_b32 v30, 16, v14
    v_and_b32 v14, 0xffff0000, v14
    v_lshlrev_b32 v31, 16, v15
    v_and_b32 v15, 0xffff0000, v15
    v_pk_mul_f32 v[24:25], v[24:25], v[16:17]
    v_pk_mul_f32 v[8:9], v[8:9], v[16:17]
    v_pk_mul_f32 v[26:27], v[26:27], v[18:19]
    v_pk_mul_f32 v[10:11], v[10:11], v[18:19]
    v_pk_mul_f32 v[28:29], v[28:29], v[20:21]
    v_pk_mul_f32 v[12:13], v[12:13], v[20:21]
    v_pk_mul_f32 v[30:31], v[30:31], v[22:23]
    v_pk_mul_f32 v[14:15], v[14:15], v[22:23]
    v_cvt_pk_bf16_f32 v8, v24, v8
    v_cvt_pk_bf16_f32 v9, v25, v9
    v_cvt_pk_bf16_f32 v10, v26, v10
    v_cvt_pk_bf16_f32 v11, v27, v11
    v_cvt_pk_bf16_f32 v12, v28, v12
    v_cvt_pk_bf16_f32 v13, v29, v13
    v_cvt_pk_bf16_f32 v14, v30, v14
    v_cvt_pk_bf16_f32 v15, v31, v15
    ds_write_b128 v240, v[8:11]
    ds_write_b128 v240, v[12:15] offset:4352
    s_cmp_eq_u32 s21, 0
    s_cbranch_scc1 sf15a
    s_waitcnt lgkmcnt(0)
    s_barrier
    s_branch sf15b
sf15a:
    s_add_u32 s32, s32, 4
    v_mov_b32 v248, 151296
    v_mov_b32 v249, 1
    s_waitcnt lgkmcnt(0)
    s_mov_b64 exec, 1
    ds_add_u32 v248, v249 offset:0
    s_mov_b64 exec, -1
lw16:
    ds_read_b32 v250, v248 offset:0
    s_waitcnt lgkmcnt(0)
    v_readfirstlane_b32 s33, v250
    s_nop 0
    s_cmp_lt_u32 s33, s32
    s_cbranch_scc1 lw16
sf15b:
    ds_read_b128 v[168:171], v241 offset:0
    ds_read_b128 v[184:187], v241 offset:4352
    ds_read_b128 v[172:175], v241 offset:64
    ds_read_b128 v[188:191], v241 offset:4416
    ds_read_b128 v[176:179], v241 offset:128
    ds_read_b128 v[192:195], v241 offset:4480
    ds_read_b128 v[180:183], v241 offset:192
    ds_read_b128 v[196:199], v241 offset:4544
    s_waitcnt lgkmcnt(6)
    v_mfma_f32_16x16x32_bf16 v[200:203], v[168:171], v[56:59], 0
    v_lshlrev_b32 v152, 16, v32
    v_mfma_f32_16x16x32_bf16 v[204:207], v[168:171], v[72:75], 0
    v_and_b32 v160, 0xffff0000, v32
    v_mfma_f32_16x16x32_bf16 v[208:211], v[184:187], v[56:59], 0
    v_lshlrev_b32 v153, 16, v33
    v_mfma_f32_16x16x32_bf16 v[212:215], v[184:187], v[72:75], 0
    v_and_b32 v161, 0xffff0000, v33
    s_waitcnt lgkmcnt(4)
    v_mfma_f32_16x16x32_bf16 v[200:203], v[172:175], v[60:63], v[200:203]
    v_lshlrev_b32 v154, 16, v34
    v_mfma_f32_16x16x32_bf16 v[204:207], v[172:175], v[76:79], v[204:207]
    v_and_b32 v162, 0xffff0000, v34
    v_mfma_f32_16x16x32_bf16 v[208:211], v[188:191], v[60:63], v[208:211]
    v_lshlrev_b32 v155, 16, v35
    v_mfma_f32_16x16x32_bf16 v[212:215], v[188:191], v[76:79], v[212:215]
    v_and_b32 v163, 0xffff0000, v35
    s_waitcnt lgkmcnt(2)
    v_mfma_f32_16x16x32_bf16 v[200:203], v[176:179], v[64:67], v[200:203]
    v_lshlrev_b32 v156, 16, v36
    v_mfma_f32_16x16x32_bf16 v[204:207], v[176:179], v[80:83], v[204:207]
    v_and_b32 v164, 0xffff0000, v36
    v_mfma_f32_16x16x32_bf16 v[208:211], v[192:195], v[64:67], v[208:211]
    v_lshlrev_b32 v157, 16, v37
    v_mfma_f32_16x16x32_bf16 v[212:215], v[192:195], v[80:83], v[212:215]
    v_and_b32 v165, 0xffff0000, v37
    s_waitcnt lgkmcnt(0)
    v_mfma_f32_16x16x32_bf16 v[200:203], v[180:183], v[68:71], v[200:203]
    v_lshlrev_b32 v158, 16, v38
    v_mfma_f32_16x16x32_bf16 v[204:207], v[180:183], v[84:87], v[204:207]
    v_and_b32 v166, 0xffff0000, v38
    v_mfma_f32_16x16x32_bf16 v[208:211], v[196:199], v[68:71], v[208:211]
    v_lshlrev_b32 v159, 16, v39
    v_mfma_f32_16x16x32_bf16 v[212:215], v[196:199], v[84:87], v[212:215]
    v_and_b32 v167, 0xffff0000, v39
    ds_read_b32 v40, v242 offset:16896
    ds_read_b32 v41, v242 offset:17168
    ds_read_b32 v42, v242 offset:17440
    ds_read_b32 v43, v242 offset:17712
    ds_read_b32 v44, v242 offset:21248
    ds_read_b32 v45, v242 offset:21520
    ds_read_b32 v46, v242 offset:21792
    ds_read_b32 v47, v242 offset:22064
    ds_write_b128 v247, v[32:35]
    ds_write_b128 v247, v[36:39] offset:4096
    v_pk_mul_f32 v[224:225], v[204:205], v[128:129]
    v_pk_mul_f32 v[226:227], v[200:201], v[128:129]
    v_pk_mul_f32 v[228:229], v[206:207], v[130:131]
    v_pk_mul_f32 v[230:231], v[202:203], v[130:131]
    v_pk_mul_f32 v[232:233], v[212:213], v[132:133]
    v_pk_mul_f32 v[234:235], v[208:209], v[132:133]
    v_pk_mul_f32 v[236:237], v[214:215], v[134:135]
    v_pk_mul_f32 v[238:239], v[210:211], v[134:135]
    v_pk_fma_f32 v[224:225], v[200:201], v[120:121], v[224:225] neg_lo:[0,0,1] neg_hi:[0,0,1]
    v_pk_fma_f32 v[226:227], v[204:205], v[120:121], v[226:227]
    v_pk_fma_f32 v[228:229], v[202:203], v[122:123], v[228:229] neg_lo:[0,0,1] neg_hi:[0,0,1]
    v_pk_fma_f32 v[230:231], v[206:207], v[122:123], v[230:231]
    v_pk_fma_f32 v[232:233], v[208:209], v[124:125], v[232:233] neg_lo:[0,0,1] neg_hi:[0,0,1]
    v_pk_fma_f32 v[234:235], v[212:213], v[124:125], v[234:235]
    v_pk_fma_f32 v[236:237], v[210:211], v[126:127], v[236:237] neg_lo:[0,0,1] neg_hi:[0,0,1]
    v_pk_fma_f32 v[238:239], v[214:215], v[126:127], v[238:239]
    v_cvt_pk_bf16_f32 v216, v224, v226
    v_cvt_pk_bf16_f32 v217, v225, v227
    v_cvt_pk_bf16_f32 v218, v228, v230
    v_cvt_pk_bf16_f32 v219, v229, v231
    v_cvt_pk_bf16_f32 v220, v232, v234
    v_cvt_pk_bf16_f32 v221, v233, v235
    v_cvt_pk_bf16_f32 v222, v236, v238
    v_cvt_pk_bf16_f32 v223, v237, v239
    v_mfma_f32_16x16x32_bf16 v[200:203], v[88:91], v[216:219], 0
    v_mfma_f32_16x16x32_bf16 v[204:207], v[104:107], v[216:219], 0
    v_mfma_f32_16x16x32_bf16 v[208:211], v[96:99], v[216:219], 0
    v_mfma_f32_16x16x32_bf16 v[212:215], v[112:115], v[216:219], 0
    v_mfma_f32_16x16x32_bf16 v[200:203], v[92:95], v[220:223], v[200:203]
    v_mfma_f32_16x16x32_bf16 v[204:207], v[108:111], v[220:223], v[204:207]
    v_mfma_f32_16x16x32_bf16 v[208:211], v[100:103], v[220:223], v[208:211]
    v_mfma_f32_16x16x32_bf16 v[212:215], v[116:119], v[220:223], v[212:215]
    v_lshlrev_b32 v24, 16, v48
    v_and_b32 v32, 0xffff0000, v48
    v_lshlrev_b32 v25, 16, v49
    v_and_b32 v33, 0xffff0000, v49
    v_lshlrev_b32 v26, 16, v50
    v_and_b32 v34, 0xffff0000, v50
    v_lshlrev_b32 v27, 16, v51
    v_and_b32 v35, 0xffff0000, v51
    v_pk_mul_f32 v[224:225], v[204:205], v[160:161]
    v_pk_mul_f32 v[226:227], v[200:201], v[160:161]
    v_pk_mul_f32 v[228:229], v[206:207], v[162:163]
    v_pk_mul_f32 v[230:231], v[202:203], v[162:163]
    v_pk_mul_f32 v[232:233], v[212:213], v[164:165]
    v_pk_mul_f32 v[234:235], v[208:209], v[164:165]
    v_pk_mul_f32 v[236:237], v[214:215], v[166:167]
    v_pk_mul_f32 v[238:239], v[210:211], v[166:167]
    v_pk_fma_f32 v[224:225], v[200:201], v[152:153], v[224:225] neg_lo:[0,0,1] neg_hi:[0,0,1]
    v_pk_fma_f32 v[226:227], v[204:205], v[152:153], v[226:227]
    v_pk_fma_f32 v[228:229], v[202:203], v[154:155], v[228:229] neg_lo:[0,0,1] neg_hi:[0,0,1]
    v_pk_fma_f32 v[230:231], v[206:207], v[154:155], v[230:231]
    v_pk_fma_f32 v[232:233], v[208:209], v[156:157], v[232:233] neg_lo:[0,0,1] neg_hi:[0,0,1]
    v_pk_fma_f32 v[234:235], v[212:213], v[156:157], v[234:235]
    v_pk_fma_f32 v[236:237], v[210:211], v[158:159], v[236:237] neg_lo:[0,0,1] neg_hi:[0,0,1]
    v_pk_fma_f32 v[238:239], v[214:215], v[158:159], v[238:239]
    v_cvt_pk_bf16_f32 v216, v226, v224
    v_cvt_pk_bf16_f32 v217, v227, v225
    v_cvt_pk_bf16_f32 v218, v230, v228
    v_cvt_pk_bf16_f32 v219, v231, v229
    v_cvt_pk_bf16_f32 v220, v234, v232
    v_cvt_pk_bf16_f32 v221, v235, v233
    v_cvt_pk_bf16_f32 v222, v238, v236
    v_cvt_pk_bf16_f32 v223, v239, v237
    v_mfma_f32_16x16x32_bf16 v[200:203], v[216:219], v[104:107], 0
    v_mfma_f32_16x16x32_bf16 v[204:207], v[216:219], v[88:91], 0
    v_mfma_f32_16x16x32_bf16 v[208:211], v[216:219], v[112:115], 0
    v_mfma_f32_16x16x32_bf16 v[212:215], v[216:219], v[96:99], 0
    v_mfma_f32_16x16x32_bf16 v[200:203], v[220:223], v[108:111], v[200:203]
    v_mfma_f32_16x16x32_bf16 v[204:207], v[220:223], v[92:95], v[204:207]
    v_mfma_f32_16x16x32_bf16 v[208:211], v[220:223], v[116:119], v[208:211]
    v_mfma_f32_16x16x32_bf16 v[212:215], v[220:223], v[100:103], v[212:215]
    v_lshlrev_b32 v28, 16, v52
    v_and_b32 v36, 0xffff0000, v52
    v_lshlrev_b32 v29, 16, v53
    v_and_b32 v37, 0xffff0000, v53
    v_lshlrev_b32 v30, 16, v54
    v_and_b32 v38, 0xffff0000, v54
    v_lshlrev_b32 v31, 16, v55
    v_and_b32 v39, 0xffff0000, v55
    v_pk_mul_f32 v[224:225], v[204:205], v[144:145]
    v_pk_mul_f32 v[226:227], v[200:201], v[144:145]
    v_pk_mul_f32 v[228:229], v[206:207], v[146:147]
    v_pk_mul_f32 v[230:231], v[202:203], v[146:147]
    v_pk_mul_f32 v[232:233], v[212:213], v[148:149]
    v_pk_mul_f32 v[234:235], v[208:209], v[148:149]
    v_pk_mul_f32 v[236:237], v[214:215], v[150:151]
    v_pk_mul_f32 v[238:239], v[210:211], v[150:151]
    v_pk_fma_f32 v[224:225], v[200:201], v[136:137], v[224:225] neg_lo:[0,0,1] neg_hi:[0,0,1]
    v_pk_fma_f32 v[226:227], v[204:205], v[136:137], v[226:227]
    v_pk_fma_f32 v[228:229], v[202:203], v[138:139], v[228:229] neg_lo:[0,0,1] neg_hi:[0,0,1]
    v_pk_fma_f32 v[230:231], v[206:207], v[138:139], v[230:231]
    v_pk_fma_f32 v[232:233], v[208:209], v[140:141], v[232:233] neg_lo:[0,0,1] neg_hi:[0,0,1]
    v_pk_fma_f32 v[234:235], v[212:213], v[140:141], v[234:235]
    v_pk_fma_f32 v[236:237], v[210:211], v[142:143], v[236:237] neg_lo:[0,0,1] neg_hi:[0,0,1]
    v_pk_fma_f32 v[238:239], v[214:215], v[142:143], v[238:239]
    v_cvt_pk_bf16_f32 v216, v226, v224
    v_cvt_pk_bf16_f32 v217, v227, v225
    v_cvt_pk_bf16_f32 v218, v230, v228
    v_cvt_pk_bf16_f32 v219, v231, v229
    v_cvt_pk_bf16_f32 v220, v234, v232
    v_cvt_pk_bf16_f32 v221, v235, v233
    v_cvt_pk_bf16_f32 v222, v238, v236
    v_cvt_pk_bf16_f32 v223, v239, v237
    ds_write_b128 v243, v[216:219]
    ds_write_b128 v243, v[220:223] offset:4096
    s_cmp_eq_u32 s21, 0
    s_cbranch_scc1 sf17a
    s_waitcnt lgkmcnt(0)
    s_barrier
    s_branch sf17b
sf17a:
    s_add_u32 s32, s32, 4
    v_mov_b32 v248, 151296
    v_mov_b32 v249, 1
    s_waitcnt lgkmcnt(0)
    s_mov_b64 exec, 1
    ds_add_u32 v248, v249 offset:0
    s_mov_b64 exec, -1
lw18:
    ds_read_b32 v250, v248 offset:0
    s_waitcnt lgkmcnt(0)
    v_readfirstlane_b32 s33, v250
    s_nop 0
    s_cmp_lt_u32 s33, s32
    s_cbranch_scc1 lw18
sf17b:
    ds_read_b128 v[168:171], v244 offset:0
    ds_read_b128 v[172:175], v244 offset:1024
    ds_read_b128 v[176:179], v244 offset:2048
    ds_read_b128 v[180:183], v244 offset:3072
    ds_read_b128 v[184:187], v244 offset:4096
    ds_read_b128 v[188:191], v244 offset:5120
    ds_read_b128 v[192:195], v244 offset:6144
    ds_read_b128 v[196:199], v244 offset:7168
    s_add_u32 s22, s45, s24
    s_add_u32 s23, s22, 4096
    s_add_u32 s30, s24, 25165824
    s_add_u32 s31, s30, 4096
    v_lshlrev_b32 v8, 16, v40
    v_and_b32 v16, 0xffff0000, v40
    v_lshlrev_b32 v9, 16, v41
    v_and_b32 v17, 0xffff0000, v41
    v_lshlrev_b32 v10, 16, v42
    v_and_b32 v18, 0xffff0000, v42
    v_lshlrev_b32 v11, 16, v43
    v_and_b32 v19, 0xffff0000, v43
    v_lshlrev_b32 v12, 16, v44
    v_and_b32 v20, 0xffff0000, v44
    v_lshlrev_b32 v13, 16, v45
    v_and_b32 v21, 0xffff0000, v45
    v_lshlrev_b32 v14, 16, v46
    v_and_b32 v22, 0xffff0000, v46
    v_lshlrev_b32 v15, 16, v47
    v_and_b32 v23, 0xffff0000, v47
    s_waitcnt vmcnt(0)
    s_waitcnt lgkmcnt(7)
    v_mfma_f32_16x16x32_bf16 v[200:203], v[168:171], v[72:75], 0
    v_mfma_f32_16x16x32_bf16 v[204:207], v[168:171], v[56:59], 0
    s_waitcnt lgkmcnt(6)
    v_mfma_f32_16x16x32_bf16 v[200:203], v[172:175], v[76:79], v[200:203]
    v_mfma_f32_16x16x32_bf16 v[204:207], v[172:175], v[60:63], v[204:207]
    s_waitcnt lgkmcnt(5)
    v_mfma_f32_16x16x32_bf16 v[200:203], v[176:179], v[80:83], v[200:203]
    v_mfma_f32_16x16x32_bf16 v[204:207], v[176:179], v[64:67], v[204:207]
    s_waitcnt lgkmcnt(4)
    v_mfma_f32_16x16x32_bf16 v[200:203], v[180:183], v[84:87], v[200:203]
    v_mfma_f32_16x16x32_bf16 v[204:207], v[180:183], v[68:71], v[204:207]
    s_waitcnt lgkmcnt(3)
    v_mfma_f32_16x16x32_bf16 v[208:211], v[184:187], v[72:75], 0
    v_mfma_f32_16x16x32_bf16 v[212:215], v[184:187], v[56:59], 0
    s_waitcnt lgkmcnt(2)
    v_mfma_f32_16x16x32_bf16 v[208:211], v[188:191], v[76:79], v[208:211]
    v_mfma_f32_16x16x32_bf16 v[212:215], v[188:191], v[60:63], v[212:215]
    s_waitcnt lgkmcnt(1)
    v_mfma_f32_16x16x32_bf16 v[208:211], v[192:195], v[80:83], v[208:211]
    v_mfma_f32_16x16x32_bf16 v[212:215], v[192:195], v[64:67], v[212:215]
    s_waitcnt lgkmcnt(0)
    v_mfma_f32_16x16x32_bf16 v[208:211], v[196:199], v[84:87], v[208:211]
    v_mfma_f32_16x16x32_bf16 v[212:215], v[196:199], v[68:71], v[212:215]
    s_cmp_lg_u32 s2, 0
    s_cbranch_scc1 fft_nofix
    v_add_f32 v200, v200, v204
    v_mul_f32 v200, 0.5, v200
    v_mov_b32 v204, v200
    v_add_f32 v201, v201, v205
    v_mul_f32 v201, 0.5, v201
    v_mov_b32 v205, v201
    v_add_f32 v202, v202, v206
    v_mul_f32 v202, 0.5, v202
    v_mov_b32 v206, v202
    v_add_f32 v203, v203, v207
    v_mul_f32 v203, 0.5, v203
    v_mov_b32 v207, v203
    v_add_f32 v208, v208, v212
    v_mul_f32 v208, 0.5, v208
    v_mov_b32 v212, v208
    v_add_f32 v209, v209, v213
    v_mul_f32 v209, 0.5, v209
    v_mov_b32 v213, v209
    v_add_f32 v210, v210, v214
    v_mul_f32 v210, 0.5, v210
    v_mov_b32 v214, v210
    v_add_f32 v211, v211, v215
    v_mul_f32 v211, 0.5, v211
    v_mov_b32 v215, v211
fft_nofix:
    v_add_f32 v8, v8, v200
    v_add_f32 v16, v16, v204
    v_add_f32 v9, v9, v201
    v_add_f32 v17, v17, v205
    v_add_f32 v10, v10, v202
    v_add_f32 v18, v18, v206
    v_add_f32 v11, v11, v203
    v_add_f32 v19, v19, v207
    v_and_b32 v8, 0xffff0000, v8
    v_and_b32 v9, 0xffff0000, v9
    v_and_b32 v10, 0xffff0000, v10
    v_and_b32 v11, 0xffff0000, v11
    v_cvt_pk_bf16_f32 v40, v8, v16
    v_cvt_pk_bf16_f32 v41, v9, v17
    v_cvt_pk_bf16_f32 v42, v10, v18
    v_cvt_pk_bf16_f32 v43, v11, v19
    v_or_b32 v40, 1, v40
    buffer_store_dword v40, v2, s[8:11], s22 offen offset:0 sc1
    v_or_b32 v41, 1, v41
    buffer_store_dword v41, v2, s[8:11], s22 offen offset:256 sc1
    v_or_b32 v42, 1, v42
    buffer_store_dword v42, v2, s[8:11], s22 offen offset:512 sc1
    v_or_b32 v43, 1, v43
    buffer_store_dword v43, v2, s[8:11], s22 offen offset:768 sc1
    v_pk_add_f32 v[12:13], v[12:13], v[208:209]
    v_pk_add_f32 v[20:21], v[20:21], v[212:213]
    v_pk_add_f32 v[14:15], v[14:15], v[210:211]
    v_pk_add_f32 v[22:23], v[22:23], v[214:215]
    v_and_b32 v12, 0xffff0000, v12
    v_and_b32 v13, 0xffff0000, v13
    v_and_b32 v14, 0xffff0000, v14
    v_and_b32 v15, 0xffff0000, v15
    v_cvt_pk_bf16_f32 v44, v12, v20
    v_cvt_pk_bf16_f32 v45, v13, v21
    v_cvt_pk_bf16_f32 v46, v14, v22
    v_cvt_pk_bf16_f32 v47, v15, v23
    v_or_b32 v44, 1, v44
    buffer_store_dword v44, v2, s[8:11], s23 offen offset:0 sc1
    v_or_b32 v45, 1, v45
    buffer_store_dword v45, v2, s[8:11], s23 offen offset:256 sc1
    v_or_b32 v46, 1, v46
    buffer_store_dword v46, v2, s[8:11], s23 offen offset:512 sc1
    v_or_b32 v47, 1, v47
    buffer_store_dword v47, v2, s[8:11], s23 offen offset:768 sc1
    v_pk_add_f32 v[24:25], v[24:25], v[200:201]
    v_pk_add_f32 v[32:33], v[32:33], v[204:205]
    v_pk_add_f32 v[26:27], v[26:27], v[202:203]
    v_pk_add_f32 v[34:35], v[34:35], v[206:207]
    v_pk_add_f32 v[28:29], v[28:29], v[208:209]
    v_pk_add_f32 v[36:37], v[36:37], v[212:213]
    v_pk_add_f32 v[30:31], v[30:31], v[210:211]
    v_pk_add_f32 v[38:39], v[38:39], v[214:215]
    v_cvt_pk_bf16_f32 v48, v24, v32
    v_cvt_pk_bf16_f32 v49, v25, v33
    v_cvt_pk_bf16_f32 v50, v26, v34
    v_cvt_pk_bf16_f32 v51, v27, v35
    v_cvt_pk_bf16_f32 v52, v28, v36
    v_cvt_pk_bf16_f32 v53, v29, v37
    v_cvt_pk_bf16_f32 v54, v30, v38
    v_cvt_pk_bf16_f32 v55, v31, v39
    s_cmp_eq_u32 s21, 0
    s_cbranch_scc1 fft_y1
    buffer_store_dword v48, v2, s[8:11], s30 offen offset:0 sc1
    buffer_store_dword v49, v2, s[8:11], s30 offen offset:256 sc1
    buffer_store_dword v50, v2, s[8:11], s30 offen offset:512 sc1
    buffer_store_dword v51, v2, s[8:11], s30 offen offset:768 sc1
    buffer_store_dword v52, v2, s[8:11], s31 offen offset:0 sc1
    buffer_store_dword v53, v2, s[8:11], s31 offen offset:256 sc1
    buffer_store_dword v54, v2, s[8:11], s31 offen offset:512 sc1
    buffer_store_dword v55, v2, s[8:11], s31 offen offset:768 sc1
    s_branch qkv_a
fft_y1:
    ds_write_b128 v246, v[48:51]
    ds_write_b128 v246, v[52:55] offset:4096
qkv_a:
    s_and_b32 s36, s2, 7
    s_lshl_b32 s36, s36, 2
    s_lshr_b32 s37, s2, 3
    s_and_b32 s38, s37, 3
    s_add_u32 s36, s36, s38
    s_lshr_b32 s37, s37, 2
    s_setprio 0
    v_mul_u32_u24 v100, 8448, v5
    v_lshl_add_u32 v100, v4, 4, v100
    s_lshl_b32 s40, s36, 8
    s_add_u32 s40, s40, s45
    s_mul_i32 s41, s20, 135168
    s_add_u32 s40, s40, s41
    s_lshl_b32 s42, s20, 12
    v_add_u32 v102, s42, v6
    s_lshl_b32 s41, s20, 8
    s_add_u32 s41, s41, 151808
    v_lshl_add_u32 v101, v4, 4, s41
    s_add_u32 s32, s32, 4
    v_mov_b32 v248, 151296
    v_mov_b32 v249, 1
    s_waitcnt lgkmcnt(0)
    s_mov_b64 exec, 1
    ds_add_u32 v248, v249 offset:0
    s_mov_b64 exec, -1
lw19:
    ds_read_b32 v250, v248 offset:0
    s_waitcnt lgkmcnt(0)
    v_readfirstlane_b32 s33, v250
    s_nop 0
    s_cmp_lt_u32 s33, s32
    s_cbranch_scc1 lw19
    s_sleep 20
qkv_nos:
    s_mov_b32 s34, 0
    s_mov_b32 s35, 0
qkv_issue0:
    s_add_u32 m0, s42, 0
    s_add_u32 s41, s40, 0
    buffer_load_dwordx4 v100, s[8:11], s41 offen sc1 lds
    s_add_u32 m0, s42, 1024
    s_add_u32 s41, s40, 33792
    buffer_load_dwordx4 v100, s[8:11], s41 offen sc1 lds
    s_add_u32 m0, s42, 2048
    s_add_u32 s41, s40, 67584
    buffer_load_dwordx4 v100, s[8:11], s41 offen sc1 lds
    s_add_u32 m0, s42, 3072
    s_add_u32 s41, s40, 101376
    buffer_load_dwordx4 v100, s[8:11], s41 offen sc1 lds
qkv_issue1:
    s_add_u32 m0, s42, 16384
    s_add_u32 s41, s40, 540672
    buffer_load_dwordx4 v100, s[8:11], s41 offen sc1 lds
    s_add_u32 m0, s42, 17408
    s_add_u32 s41, s40, 574464
    buffer_load_dwordx4 v100, s[8:11], s41 offen sc1 lds
    s_add_u32 m0, s42, 18432
    s_add_u32 s41, s40, 608256
    buffer_load_dwordx4 v100, s[8:11], s41 offen sc1 lds
    s_add_u32 m0, s42, 19456
    s_add_u32 s41, s40, 642048
    buffer_load_dwordx4 v100, s[8:11], s41 offen sc1 lds
    s_add_u32 m0, s42, 32768
    s_add_u32 s41, s40, 1081344
    buffer_load_dwordx4 v100, s[8:11], s41 offen sc1 lds
    s_add_u32 m0, s42, 33792
    s_add_u32 s41, s40, 1115136
    buffer_load_dwordx4 v100, s[8:11], s41 offen sc1 lds
    s_add_u32 m0, s42, 34816
    s_add_u32 s41, s40, 1148928
    buffer_load_dwordx4 v100, s[8:11], s41 offen sc1 lds
    s_add_u32 m0, s42, 35840
    s_add_u32 s41, s40, 1182720
    buffer_load_dwordx4 v100, s[8:11], s41 offen sc1 lds
    s_add_u32 m0, s42, 49152
    s_add_u32 s41, s40, 1622016
    buffer_load_dwordx4 v100, s[8:11], s41 offen sc1 lds
    s_add_u32 m0, s42, 50176
    s_add_u32 s41, s40, 1655808
    buffer_load_dwordx4 v100, s[8:11], s41 offen sc1 lds
    s_add_u32 m0, s42, 51200
    s_add_u32 s41, s40, 1689600
    buffer_load_dwordx4 v100, s[8:11], s41 offen sc1 lds
    s_add_u32 m0, s42, 52224
    s_add_u32 s41, s40, 1723392
    buffer_load_dwordx4 v100, s[8:11], s41 offen sc1 lds
    s_cmp_eq_u32 s34, 1
    s_cbranch_scc1 qkv_check1
qkv_check0:
    s_waitcnt vmcnt(12)
    ds_read_b128 v[16:19], v102 offset:0
    ds_read_b128 v[20:23], v102 offset:1024
    ds_read_b128 v[24:27], v102 offset:2048
    ds_read_b128 v[28:31], v102 offset:3072
    s_mov_b32 s34, 0
    s_waitcnt lgkmcnt(0)
    v_and_b32 v88, v16, v17
    v_bitop3_b32 v88, v88, v18, v19 bitop3:0x80
    v_and_b32 v89, v20, v21
    v_bitop3_b32 v89, v89, v22, v23 bitop3:0x80
    v_and_b32 v90, v24, v25
    v_bitop3_b32 v90, v90, v26, v27 bitop3:0x80
    v_and_b32 v91, v28, v29
    v_bitop3_b32 v91, v91, v30, v31 bitop3:0x80
    v_bitop3_b32 v88, v88, v89, v90 bitop3:0x80
    v_bitop3_b32 v88, v88, v91, 1 bitop3:0x80
    v_cmp_eq_u32 vcc, 0, v88
    s_add_u32 s35, s35, 1
    s_cmp_gt_u32 s35, 262144
    s_cbranch_scc1 qkv_ok0
    s_nop 1
    s_cbranch_vccz qkv_ok0
    s_sleep 4
    s_branch qkv_issue0
qkv_ok0:
    s_barrier
qkv_check1:
    s_waitcnt vmcnt(8)
    ds_read_b128 v[32:35], v102 offset:16384
    ds_read_b128 v[36:39], v102 offset:17408
    ds_read_b128 v[40:43], v102 offset:18432
    ds_read_b128 v[44:47], v102 offset:19456
    s_waitcnt vmcnt(4)
    ds_read_b128 v[48:51], v102 offset:32768
    ds_read_b128 v[52:55], v102 offset:33792
    ds_read_b128 v[56:59], v102 offset:34816
    ds_read_b128 v[60:63], v102 offset:35840
    s_waitcnt vmcnt(0)
    ds_read_b128 v[64:67], v102 offset:49152
    ds_read_b128 v[68:71], v102 offset:50176
    ds_read_b128 v[72:75], v102 offset:51200
    ds_read_b128 v[76:79], v102 offset:52224
    s_mov_b32 s34, 1
    s_waitcnt lgkmcnt(8)
    v_and_b32 v88, v32, v33
    v_bitop3_b32 v88, v88, v34, v35 bitop3:0x80
    v_and_b32 v89, v36, v37
    v_bitop3_b32 v89, v89, v38, v39 bitop3:0x80
    v_and_b32 v90, v40, v41
    v_bitop3_b32 v90, v90, v42, v43 bitop3:0x80
    v_and_b32 v91, v44, v45
    v_bitop3_b32 v91, v91, v46, v47 bitop3:0x80
    s_waitcnt lgkmcnt(4)
    v_bitop3_b32 v88, v88, v48, v49 bitop3:0x80
    v_bitop3_b32 v88, v88, v50, v51 bitop3:0x80
    v_bitop3_b32 v89, v89, v52, v53 bitop3:0x80
    v_bitop3_b32 v89, v89, v54, v55 bitop3:0x80
    v_bitop3_b32 v90, v90, v56, v57 bitop3:0x80
    v_bitop3_b32 v90, v90, v58, v59 bitop3:0x80
    v_bitop3_b32 v91, v91, v60, v61 bitop3:0x80
    v_bitop3_b32 v91, v91, v62, v63 bitop3:0x80
    s_waitcnt lgkmcnt(0)
    v_bitop3_b32 v88, v88, v64, v65 bitop3:0x80
    v_bitop3_b32 v88, v88, v66, v67 bitop3:0x80
    v_bitop3_b32 v89, v89, v68, v69 bitop3:0x80
    v_bitop3_b32 v89, v89, v70, v71 bitop3:0x80
    v_bitop3_b32 v90, v90, v72, v73 bitop3:0x80
    v_bitop3_b32 v90, v90, v74, v75 bitop3:0x80
    v_bitop3_b32 v91, v91, v76, v77 bitop3:0x80
    v_bitop3_b32 v91, v91, v78, v79 bitop3:0x80
    v_bitop3_b32 v88, v88, v89, v90 bitop3:0x80
    v_bitop3_b32 v88, v88, v91, 1 bitop3:0x80
    v_cmp_eq_u32 vcc, 0, v88
    s_add_u32 s35, s35, 1
    s_cmp_gt_u32 s35, 262144
    s_cbranch_scc1 qkv_ok1
    s_nop 1
    s_cbranch_vccz qkv_ok1
    s_sleep 4
    s_branch qkv_issue1
qkv_ok1:
    s_barrier
    v_lshlrev_b32 v88, 16, v16
    v_and_b32 v16, 0xffff0000, v16
    v_lshlrev_b32 v89, 16, v17
    v_and_b32 v17, 0xffff0000, v17
    v_lshlrev_b32 v90, 16, v18
    v_and_b32 v18, 0xffff0000, v18
    v_lshlrev_b32 v91, 16, v19
    v_and_b32 v19, 0xffff0000, v19
    v_mul_f32 v80, v88, v88
    v_mul_f32 v84, v16, v16
    v_mul_f32 v81, v89, v89
    v_mul_f32 v85, v17, v17
    v_mul_f32 v82, v90, v90
    v_mul_f32 v86, v18, v18
    v_mul_f32 v83, v91, v91
    v_mul_f32 v87, v19, v19
    v_lshlrev_b32 v88, 16, v20
    v_and_b32 v20, 0xffff0000, v20
    v_lshlrev_b32 v89, 16, v21
    v_and_b32 v21, 0xffff0000, v21
    v_lshlrev_b32 v90, 16, v22
    v_and_b32 v22, 0xffff0000, v22
    v_lshlrev_b32 v91, 16, v23
    v_and_b32 v23, 0xffff0000, v23
    v_fmac_f32 v80, v88, v88
    v_fmac_f32 v84, v20, v20
    v_fmac_f32 v81, v89, v89
    v_fmac_f32 v85, v21, v21
    v_fmac_f32 v82, v90, v90
    v_fmac_f32 v86, v22, v22
    v_fmac_f32 v83, v91, v91
    v_fmac_f32 v87, v23, v23
    v_lshlrev_b32 v88, 16, v24
    v_and_b32 v24, 0xffff0000, v24
    v_lshlrev_b32 v89, 16, v25
    v_and_b32 v25, 0xffff0000, v25
    v_lshlrev_b32 v90, 16, v26
    v_and_b32 v26, 0xffff0000, v26
    v_lshlrev_b32 v91, 16, v27
    v_and_b32 v27, 0xffff0000, v27
    v_fmac_f32 v80, v88, v88
    v_fmac_f32 v84, v24, v24
    v_fmac_f32 v81, v89, v89
    v_fmac_f32 v85, v25, v25
    v_fmac_f32 v82, v90, v90
    v_fmac_f32 v86, v26, v26
    v_fmac_f32 v83, v91, v91
    v_fmac_f32 v87, v27, v27
    v_lshlrev_b32 v88, 16, v28
    v_and_b32 v28, 0xffff0000, v28
    v_lshlrev_b32 v89, 16, v29
    v_and_b32 v29, 0xffff0000, v29
    v_lshlrev_b32 v90, 16, v30
    v_and_b32 v30, 0xffff0000, v30
    v_lshlrev_b32 v91, 16, v31
    v_and_b32 v31, 0xffff0000, v31
    v_fmac_f32 v80, v88, v88
    v_fmac_f32 v84, v28, v28
    v_fmac_f32 v81, v89, v89
    v_fmac_f32 v85, v29, v29
    v_fmac_f32 v82, v90, v90
    v_fmac_f32 v86, v30, v30
    v_fmac_f32 v83, v91, v91
    v_fmac_f32 v87, v31, v31
    v_lshlrev_b32 v88, 16, v32
    v_and_b32 v32, 0xffff0000, v32
    v_lshlrev_b32 v89, 16, v33
    v_and_b32 v33, 0xffff0000, v33
    v_lshlrev_b32 v90, 16, v34
    v_and_b32 v34, 0xffff0000, v34
    v_lshlrev_b32 v91, 16, v35
    v_and_b32 v35, 0xffff0000, v35
    v_fmac_f32 v80, v88, v88
    v_fmac_f32 v84, v32, v32
    v_fmac_f32 v81, v89, v89
    v_fmac_f32 v85, v33, v33
    v_fmac_f32 v82, v90, v90
    v_fmac_f32 v86, v34, v34
    v_fmac_f32 v83, v91, v91
    v_fmac_f32 v87, v35, v35
    v_lshlrev_b32 v88, 16, v36
    v_and_b32 v36, 0xffff0000, v36
    v_lshlrev_b32 v89, 16, v37
    v_and_b32 v37, 0xffff0000, v37
    v_lshlrev_b32 v90, 16, v38
    v_and_b32 v38, 0xffff0000, v38
    v_lshlrev_b32 v91, 16, v39
    v_and_b32 v39, 0xffff0000, v39
    v_fmac_f32 v80, v88, v88
    v_fmac_f32 v84, v36, v36
    v_fmac_f32 v81, v89, v89
    v_fmac_f32 v85, v37, v37
    v_fmac_f32 v82, v90, v90
    v_fmac_f32 v86, v38, v38
    v_fmac_f32 v83, v91, v91
    v_fmac_f32 v87, v39, v39
    v_lshlrev_b32 v88, 16, v40
    v_and_b32 v40, 0xffff0000, v40
    v_lshlrev_b32 v89, 16, v41
    v_and_b32 v41, 0xffff0000, v41
    v_lshlrev_b32 v90, 16, v42
    v_and_b32 v42, 0xffff0000, v42
    v_lshlrev_b32 v91, 16, v43
    v_and_b32 v43, 0xffff0000, v43
    v_fmac_f32 v80, v88, v88
    v_fmac_f32 v84, v40, v40
    v_fmac_f32 v81, v89, v89
    v_fmac_f32 v85, v41, v41
    v_fmac_f32 v82, v90, v90
    v_fmac_f32 v86, v42, v42
    v_fmac_f32 v83, v91, v91
    v_fmac_f32 v87, v43, v43
    v_lshlrev_b32 v88, 16, v44
    v_and_b32 v44, 0xffff0000, v44
    v_lshlrev_b32 v89, 16, v45
    v_and_b32 v45, 0xffff0000, v45
    v_lshlrev_b32 v90, 16, v46
    v_and_b32 v46, 0xffff0000, v46
    v_lshlrev_b32 v91, 16, v47
    v_and_b32 v47, 0xffff0000, v47
    v_fmac_f32 v80, v88, v88
    v_fmac_f32 v84, v44, v44
    v_fmac_f32 v81, v89, v89
    v_fmac_f32 v85, v45, v45
    v_fmac_f32 v82, v90, v90
    v_fmac_f32 v86, v46, v46
    v_fmac_f32 v83, v91, v91
    v_fmac_f32 v87, v47, v47
    v_lshlrev_b32 v88, 16, v48
    v_and_b32 v48, 0xffff0000, v48
    v_lshlrev_b32 v89, 16, v49
    v_and_b32 v49, 0xffff0000, v49
    v_lshlrev_b32 v90, 16, v50
    v_and_b32 v50, 0xffff0000, v50
    v_lshlrev_b32 v91, 16, v51
    v_and_b32 v51, 0xffff0000, v51
    v_fmac_f32 v80, v88, v88
    v_fmac_f32 v84, v48, v48
    v_fmac_f32 v81, v89, v89
    v_fmac_f32 v85, v49, v49
    v_fmac_f32 v82, v90, v90
    v_fmac_f32 v86, v50, v50
    v_fmac_f32 v83, v91, v91
    v_fmac_f32 v87, v51, v51
    v_lshlrev_b32 v88, 16, v52
    v_and_b32 v52, 0xffff0000, v52
    v_lshlrev_b32 v89, 16, v53
    v_and_b32 v53, 0xffff0000, v53
    v_lshlrev_b32 v90, 16, v54
    v_and_b32 v54, 0xffff0000, v54
    v_lshlrev_b32 v91, 16, v55
    v_and_b32 v55, 0xffff0000, v55
    v_fmac_f32 v80, v88, v88
    v_fmac_f32 v84, v52, v52
    v_fmac_f32 v81, v89, v89
    v_fmac_f32 v85, v53, v53
    v_fmac_f32 v82, v90, v90
    v_fmac_f32 v86, v54, v54
    v_fmac_f32 v83, v91, v91
    v_fmac_f32 v87, v55, v55
    v_lshlrev_b32 v88, 16, v56
    v_and_b32 v56, 0xffff0000, v56
    v_lshlrev_b32 v89, 16, v57
    v_and_b32 v57, 0xffff0000, v57
    v_lshlrev_b32 v90, 16, v58
    v_and_b32 v58, 0xffff0000, v58
    v_lshlrev_b32 v91, 16, v59
    v_and_b32 v59, 0xffff0000, v59
    v_fmac_f32 v80, v88, v88
    v_fmac_f32 v84, v56, v56
    v_fmac_f32 v81, v89, v89
    v_fmac_f32 v85, v57, v57
    v_fmac_f32 v82, v90, v90
    v_fmac_f32 v86, v58, v58
    v_fmac_f32 v83, v91, v91
    v_fmac_f32 v87, v59, v59
    v_lshlrev_b32 v88, 16, v60
    v_and_b32 v60, 0xffff0000, v60
    v_lshlrev_b32 v89, 16, v61
    v_and_b32 v61, 0xffff0000, v61
    v_lshlrev_b32 v90, 16, v62
    v_and_b32 v62, 0xffff0000, v62
    v_lshlrev_b32 v91, 16, v63
    v_and_b32 v63, 0xffff0000, v63
    v_fmac_f32 v80, v88, v88
    v_fmac_f32 v84, v60, v60
    v_fmac_f32 v81, v89, v89
    v_fmac_f32 v85, v61, v61
    v_fmac_f32 v82, v90, v90
    v_fmac_f32 v86, v62, v62
    v_fmac_f32 v83, v91, v91
    v_fmac_f32 v87, v63, v63
    v_lshlrev_b32 v88, 16, v64
    v_and_b32 v64, 0xffff0000, v64
    v_lshlrev_b32 v89, 16, v65
    v_and_b32 v65, 0xffff0000, v65
    v_lshlrev_b32 v90, 16, v66
    v_and_b32 v66, 0xffff0000, v66
    v_lshlrev_b32 v91, 16, v67
    v_and_b32 v67, 0xffff0000, v67
    v_fmac_f32 v80, v88, v88
    v_fmac_f32 v84, v64, v64
    v_fmac_f32 v81, v89, v89
    v_fmac_f32 v85, v65, v65
    v_fmac_f32 v82, v90, v90
    v_fmac_f32 v86, v66, v66
    v_fmac_f32 v83, v91, v91
    v_fmac_f32 v87, v67, v67
    v_lshlrev_b32 v88, 16, v68
    v_and_b32 v68, 0xffff0000, v68
    v_lshlrev_b32 v89, 16, v69
    v_and_b32 v69, 0xffff0000, v69
    v_lshlrev_b32 v90, 16, v70
    v_and_b32 v70, 0xffff0000, v70
    v_lshlrev_b32 v91, 16, v71
    v_and_b32 v71, 0xffff0000, v71
    v_fmac_f32 v80, v88, v88
    v_fmac_f32 v84, v68, v68
    v_fmac_f32 v81, v89, v89
    v_fmac_f32 v85, v69, v69
    v_fmac_f32 v82, v90, v90
    v_fmac_f32 v86, v70, v70
    v_fmac_f32 v83, v91, v91
    v_fmac_f32 v87, v71, v71
    v_lshlrev_b32 v88, 16, v72
    v_and_b32 v72, 0xffff0000, v72
    v_lshlrev_b32 v89, 16, v73
    v_and_b32 v73, 0xffff0000, v73
    v_lshlrev_b32 v90, 16, v74
    v_and_b32 v74, 0xffff0000, v74
    v_lshlrev_b32 v91, 16, v75
    v_and_b32 v75, 0xffff0000, v75
    v_fmac_f32 v80, v88, v88
    v_fmac_f32 v84, v72, v72
    v_fmac_f32 v81, v89, v89
    v_fmac_f32 v85, v73, v73
    v_fmac_f32 v82, v90, v90
    v_fmac_f32 v86, v74, v74
    v_fmac_f32 v83, v91, v91
    v_fmac_f32 v87, v75, v75
    v_lshlrev_b32 v88, 16, v76
    v_and_b32 v76, 0xffff0000, v76
    v_lshlrev_b32 v89, 16, v77
    v_and_b32 v77, 0xffff0000, v77
    v_lshlrev_b32 v90, 16, v78
    v_and_b32 v78, 0xffff0000, v78
    v_lshlrev_b32 v91, 16, v79
    v_and_b32 v79, 0xffff0000, v79
    v_fmac_f32 v80, v88, v88
    v_fmac_f32 v84, v76, v76
    v_fmac_f32 v81, v89, v89
    v_fmac_f32 v85, v77, v77
    v_fmac_f32 v82, v90, v90
    v_fmac_f32 v86, v78, v78
    v_fmac_f32 v83, v91, v91
    v_fmac_f32 v87, v79, v79
    v_add_f32 v80, v80, v84
    v_add_f32 v81, v81, v85
    v_add_f32 v82, v82, v86
    v_add_f32 v83, v83, v87
    v_mov_b32 v88, v80
    v_mov_b32 v89, v81
    v_mov_b32 v90, v82
    v_mov_b32 v91, v83
    v_permlane32_swap_b32 v80, v88
    v_permlane32_swap_b32 v81, v89
    v_permlane32_swap_b32 v82, v90
    v_permlane32_swap_b32 v83, v91
    v_add_f32 v80, v80, v88
    v_add_f32 v81, v81, v89
    v_add_f32 v82, v82, v90
    v_add_f32 v83, v83, v91
    v_mov_b32 v88, v80
    v_mov_b32 v89, v81
    v_mov_b32 v90, v82
    v_mov_b32 v91, v83
    v_permlane16_swap_b32 v80, v88
    v_permlane16_swap_b32 v81, v89
    v_permlane16_swap_b32 v82, v90
    v_permlane16_swap_b32 v83, v91
    v_add_f32 v80, v80, v88
    v_add_f32 v81, v81, v89
    v_add_f32 v82, v82, v90
    v_add_f32 v83, v83, v91
    ds_write_b128 v101, v[80:83]
    s_add_u32 s32, s32, 4
    v_mov_b32 v248, 151296
    v_mov_b32 v249, 1
    s_waitcnt lgkmcnt(0)
    s_mov_b64 exec, 1
    ds_add_u32 v248, v249 offset:0
    s_mov_b64 exec, -1
lw20:
    ds_read_b32 v250, v248 offset:0
    s_waitcnt lgkmcnt(0)
    v_readfirstlane_b32 s33, v250
    s_nop 0
    s_cmp_lt_u32 s33, s32
    s_cbranch_scc1 lw20
    s_cmp_lg_u32 s20, 0
    s_cbranch_scc1 qkv_nor
    v_lshlrev_b32 v12, 2, v1
    v_add_u32 v12, 151552, v12
    ds_read2st64_b32 v[16:17], v12 offset0:1 offset1:2
    ds_read2st64_b32 v[18:19], v12 offset0:3 offset1:4
    v_mov_b32 v13, 0x3727c5ac
    s_waitcnt lgkmcnt(0)
    v_add_f32 v16, v16, v17
    v_add_f32 v18, v18, v19
    v_add_f32 v16, v16, v18
    v_fmamk_f32 v16, v16, 0x3b000000, v13
    v_rsq_f32 v16, v16
    ds_write_b32 v12, v16
    s_waitcnt lgkmcnt(0)
qkv_nor:
    s_barrier
    s_cmp_lg_u32 s21, 0
    s_cbranch_scc1 qkv_end
    v_mov_b32 v84, -1
    v_mov_b32 v85, -1
    v_mov_b32 v86, -1
    v_mov_b32 v87, -1
    s_lshl_b32 s23, s2, 13
    s_lshl_b32 s24, s20, 11
    s_add_u32 s23, s23, s24
    s_add_u32 s24, s23, 10485760
    buffer_store_dwordx4 v[84:87], v6, s[8:11], s24 offen sc1
    buffer_store_dwordx4 v[84:87], v6, s[8:11], s24 offen offset:1024 sc1
    s_lshl_b32 s23, s2, 6
    s_add_u32 s23, s23, 3948544
    s_mov_b64 exec, 15
    buffer_store_dwordx4 v[84:87], v6, s[8:11], s23 offen sc1
    s_mov_b64 exec, -1
    s_branch qkv_end
fft_b2:
fft_b_go:
    s_and_b32 s36, s2, 7
    s_lshl_b32 s36, s36, 2
    s_lshr_b32 s37, s2, 3
    s_and_b32 s38, s37, 3
    s_add_u32 s36, s36, s38
    s_lshr_b32 s37, s37, 2
    v_lshlrev_b32 v6, 4, v1
    s_lshl_b32 s24, s37, 1
    s_lshr_b32 s25, s3, 1
    s_add_u32 s24, s24, s25
    s_and_b32 s25, s3, 1
    s_mul_i32 s30, s24, 98304
    s_add_u32 s30, s30, 2359296
    s_add_u32 s31, s30, 65536
    s_lshl_b32 s26, s25, 15
    s_add_u32 s30, s30, s26
    s_mov_b32 s35, 0
qw_poll:
    s_mov_b32 s39, s30
    s_mov_b32 s38, s31
    buffer_load_dwordx4 v[8:11], v6, s[8:11], s39 offen offset:0 sc1
    buffer_load_dwordx4 v[12:15], v6, s[8:11], s38 offen offset:0 sc1
    buffer_load_dwordx4 v[16:19], v6, s[8:11], s39 offen offset:1024 sc1
    buffer_load_dwordx4 v[20:23], v6, s[8:11], s38 offen offset:1024 sc1
    buffer_load_dwordx4 v[24:27], v6, s[8:11], s39 offen offset:2048 sc1
    buffer_load_dwordx4 v[28:31], v6, s[8:11], s38 offen offset:2048 sc1
    buffer_load_dwordx4 v[32:35], v6, s[8:11], s39 offen offset:3072 sc1
    buffer_load_dwordx4 v[36:39], v6, s[8:11], s38 offen offset:3072 sc1
    s_add_u32 s39, s39, 4096
    s_add_u32 s38, s38, 4096
    buffer_load_dwordx4 v[40:43], v6, s[8:11], s39 offen offset:0 sc1
    buffer_load_dwordx4 v[44:47], v6, s[8:11], s38 offen offset:0 sc1
    buffer_load_dwordx4 v[48:51], v6, s[8:11], s39 offen offset:1024 sc1
    buffer_load_dwordx4 v[52:55], v6, s[8:11], s38 offen offset:1024 sc1
    buffer_load_dwordx4 v[56:59], v6, s[8:11], s39 offen offset:2048 sc1
    buffer_load_dwordx4 v[60:63], v6, s[8:11], s38 offen offset:2048 sc1
    buffer_load_dwordx4 v[64:67], v6, s[8:11], s39 offen offset:3072 sc1
    buffer_load_dwordx4 v[68:71], v6, s[8:11], s38 offen offset:3072 sc1
    s_add_u32 s39, s39, 4096
    s_add_u32 s38, s38, 4096
    buffer_load_dwordx4 v[72:75], v6, s[8:11], s39 offen offset:0 sc1
    buffer_load_dwordx4 v[76:79], v6, s[8:11], s38 offen offset:0 sc1
    buffer_load_dwordx4 v[80:83], v6, s[8:11], s39 offen offset:1024 sc1
    buffer_load_dwordx4 v[84:87], v6, s[8:11], s38 offen offset:1024 sc1
    buffer_load_dwordx4 v[88:91], v6, s[8:11], s39 offen offset:2048 sc1
    buffer_load_dwordx4 v[92:95], v6, s[8:11], s38 offen offset:2048 sc1
    buffer_load_dwordx4 v[96:99], v6, s[8:11], s39 offen offset:3072 sc1
    buffer_load_dwordx4 v[100:103], v6, s[8:11], s38 offen offset:3072 sc1
    s_add_u32 s39, s39, 4096
    s_add_u32 s38, s38, 4096
    buffer_load_dwordx4 v[104:107], v6, s[8:11], s39 offen offset:0 sc1
    buffer_load_dwordx4 v[108:111], v6, s[8:11], s38 offen offset:0 sc1
    buffer_load_dwordx4 v[112:115], v6, s[8:11], s39 offen offset:1024 sc1
    buffer_load_dwordx4 v[116:119], v6, s[8:11], s38 offen offset:1024 sc1
    buffer_load_dwordx4 v[120:123], v6, s[8:11], s39 offen offset:2048 sc1
    buffer_load_dwordx4 v[124:127], v6, s[8:11], s38 offen offset:2048 sc1
    buffer_load_dwordx4 v[128:131], v6, s[8:11], s39 offen offset:3072 sc1
    buffer_load_dwordx4 v[132:135], v6, s[8:11], s38 offen offset:3072 sc1
    s_add_u32 s39, s39, 4096
    s_add_u32 s38, s38, 4096
    s_cmp_eq_u32 s21, 0
    s_cbranch_scc1 qw_l1
    s_barrier
    s_barrier
    s_branch qw_ok
qw_l1:
    s_waitcnt vmcnt(0)
    v_max3_u32 v204, v8, v9, v10
    v_max3_u32 v204, v204, v11, v12
    v_max3_u32 v204, v204, v13, v14
    v_max3_u32 v204, v204, v15, v16
    v_max3_u32 v204, v204, v17, v18
    v_max3_u32 v204, v204, v19, v20
    v_max3_u32 v204, v204, v21, v22
    v_max3_u32 v204, v204, v23, v24
    v_max3_u32 v204, v204, v25, v26
    v_max3_u32 v204, v204, v27, v28
    v_max3_u32 v204, v204, v29, v30
    v_max3_u32 v204, v204, v31, v32
    v_max3_u32 v204, v204, v33, v34
    v_max3_u32 v204, v204, v35, v36
    v_max3_u32 v204, v204, v37, v38
    v_max3_u32 v204, v204, v39, v40
    v_max3_u32 v204, v204, v41, v42
    v_max3_u32 v204, v204, v43, v44
    v_max3_u32 v204, v204, v45, v46
    v_max3_u32 v204, v204, v47, v48
    v_max3_u32 v204, v204, v49, v50
    v_max3_u32 v204, v204, v51, v52
    v_max3_u32 v204, v204, v53, v54
    v_max3_u32 v204, v204, v55, v56
    v_max3_u32 v204, v204, v57, v58
    v_max3_u32 v204, v204, v59, v60
    v_max3_u32 v204, v204, v61, v62
    v_max3_u32 v204, v204, v63, v64
    v_max3_u32 v204, v204, v65, v66
    v_max3_u32 v204, v204, v67, v68
    v_max3_u32 v204, v204, v69, v70
    v_max3_u32 v204, v204, v71, v72
    v_max3_u32 v204, v204, v73, v74
    v_max3_u32 v204, v204, v75, v76
    v_max3_u32 v204, v204, v77, v78
    v_max3_u32 v204, v204, v79, v80
    v_max3_u32 v204, v204, v81, v82
    v_max3_u32 v204, v204, v83, v84
    v_max3_u32 v204, v204, v85, v86
    v_max3_u32 v204, v204, v87, v88
    v_max3_u32 v204, v204, v89, v90
    v_max3_u32 v204, v204, v91, v92
    v_max3_u32 v204, v204, v93, v94
    v_max3_u32 v204, v204, v95, v96
    v_max3_u32 v204, v204, v97, v98
    v_max3_u32 v204, v204, v99, v100
    v_max3_u32 v204, v204, v101, v102
    v_max3_u32 v204, v204, v103, v104
    v_max3_u32 v204, v204, v105, v106
    v_max3_u32 v204, v204, v107, v108
    v_max3_u32 v204, v204, v109, v110
    v_max3_u32 v204, v204, v111, v112
    v_max3_u32 v204, v204, v113, v114
    v_max3_u32 v204, v204, v115, v116
    v_max3_u32 v204, v204, v117, v118
    v_max3_u32 v204, v204, v119, v120
    v_max3_u32 v204, v204, v121, v122
    v_max3_u32 v204, v204, v123, v124
    v_max3_u32 v204, v204, v125, v126
    v_max3_u32 v204, v204, v127, v128
    v_max3_u32 v204, v204, v129, v130
    v_max3_u32 v204, v204, v131, v132
    v_max3_u32 v204, v204, v133, v134
    v_max_u32 v204, v204, v135
    v_cmp_eq_u32 vcc, -1, v204
    s_add_u32 s35, s35, 1
    s_cmp_gt_u32 s35, 262144
    s_cbranch_scc1 qw_ok1
    s_nop 1
    s_cbranch_vccz qw_ok1
    s_sleep 4
    s_branch qw_poll
qw_ok1:
    s_cmp_lg_u32 s20, 6
    s_cbranch_scc1 qw_ok
    s_and_b32 s34, s2, 31
    s_lshl_b32 s34, s34, 8
    s_add_u32 s34, s34, 4096
    s_add_u32 s34, s34, 4046848
    s_mov_b32 s35, 0
    v_and_b32 v204, 15, v1
    v_lshlrev_b32 v204, 2, v204
gw21_poll:
    buffer_load_dword v205, v204, s[8:11], s34 offen sc1
    s_waitcnt vmcnt(0)
    v_cmp_ne_u32 vcc, 1, v205
    s_add_u32 s35, s35, 1
    s_cmp_gt_u32 s35, 262144
    s_cbranch_scc1 gw21_ok
    s_nop 1
    s_cbranch_vccz gw21_ok
    s_sleep 4
    s_branch gw21_poll
gw21_ok:
qw_ok:
    v_and_b32 v4, 15, v1
    v_lshrrev_b32 v5, 5, v1
    v_and_b32 v7, 31, v1
    v_lshlrev_b32 v2, 2, v7
    v_lshl_add_u32 v2, v5, 10, v2
    s_lshl_b32 s26, s25, 7
    v_add_u32 v3, s26, v2
    s_xor_b32 s26, s26, 128
    v_add_u32 v2, s26, v2
    s_lshl_b32 s26, s25, 7
    s_add_u32 s26, s26, 151552
    v_and_b32 v7, 31, v1
    v_lshl_add_u32 v248, v7, 2, s26
    v_xor_b32 v249, 128, v248
    v_lshl_add_u32 v250, v5, 4, s26
    v_and_b32 v7, 16, v1
    v_lshlrev_b32 v7, 12, v7
    v_lshl_add_u32 v7, v5, 8, v7
    v_lshl_add_u32 v7, v4, 4, v7
    s_lshl_b32 s22, s24, 17
    s_lshl_b32 s23, s36, 11
    s_add_u32 s22, s22, s23
    s_add_u32 s22, s22, s48
    s_lshl_b32 s23, s25, 10
    s_add_u32 s27, s22, s23
    s_add_u32 s27, s27, 4194304
    s_lshl_b32 s26, s25, 21
    s_add_u32 s22, s22, s26
    s_add_u32 s28, s22, s23
    s_xor_b32 s23, s23, 1024
    s_add_u32 s29, s22, s23
    s_add_u32 s22, s28, 65536
    s_add_u32 s23, s29, 65536
    s_cmp_eq_u32 s25, 0
    s_cselect_b32 s26, 0x3eb8aa3b, 1.0
    s_waitcnt vmcnt(0)
    s_barrier
    ds_read2st64_b32 v[216:217], v3 offset0:0 offset1:1
    ds_read2st64_b32 v[218:219], v3 offset0:2 offset1:3
    ds_read2st64_b32 v[220:221], v2 offset0:0 offset1:1
    ds_read2st64_b32 v[222:223], v2 offset0:2 offset1:3
    ds_read2st64_b32 v[224:225], v3 offset0:8 offset1:9
    ds_read2st64_b32 v[226:227], v3 offset0:10 offset1:11
    ds_read2st64_b32 v[228:229], v2 offset0:8 offset1:9
    ds_read2st64_b32 v[230:231], v2 offset0:10 offset1:11
    ds_read2st64_b32 v[232:233], v3 offset0:16 offset1:17
    ds_read2st64_b32 v[234:235], v3 offset0:18 offset1:19
    ds_read2st64_b32 v[236:237], v2 offset0:16 offset1:17
    ds_read2st64_b32 v[238:239], v2 offset0:18 offset1:19
    s_waitcnt lgkmcnt(8)
    v_mfma_f32_32x32x16_bf16 v[168:183], v[8:11], v[216:219], 0
    ds_read2st64_b32 v[240:241], v3 offset0:24 offset1:25
    ds_read2st64_b32 v[242:243], v3 offset0:26 offset1:27
    ds_read2st64_b32 v[244:245], v2 offset0:24 offset1:25
    ds_read2st64_b32 v[246:247], v2 offset0:26 offset1:27
    v_mfma_f32_32x32x16_bf16 v[184:199], v[8:11], v[220:223], 0
    v_mfma_f32_32x32x16_bf16 v[200:215], v[216:219], v[12:15], 0
    s_waitcnt lgkmcnt(8)
    v_mfma_f32_32x32x16_bf16 v[168:183], v[16:19], v[224:227], v[168:183]
    ds_read2st64_b32 v[216:217], v3 offset0:32 offset1:33
    ds_read2st64_b32 v[218:219], v3 offset0:34 offset1:35
    ds_read2st64_b32 v[220:221], v2 offset0:32 offset1:33
    ds_read2st64_b32 v[222:223], v2 offset0:34 offset1:35
    v_mfma_f32_32x32x16_bf16 v[184:199], v[16:19], v[228:231], v[184:199]
    v_mfma_f32_32x32x16_bf16 v[200:215], v[224:227], v[20:23], v[200:215]
    s_waitcnt lgkmcnt(8)
    v_mfma_f32_32x32x16_bf16 v[168:183], v[24:27], v[232:235], v[168:183]
    ds_read2st64_b32 v[224:225], v3 offset0:40 offset1:41
    ds_read2st64_b32 v[226:227], v3 offset0:42 offset1:43
    ds_read2st64_b32 v[228:229], v2 offset0:40 offset1:41
    ds_read2st64_b32 v[230:231], v2 offset0:42 offset1:43
    v_mfma_f32_32x32x16_bf16 v[184:199], v[24:27], v[236:239], v[184:199]
    v_mfma_f32_32x32x16_bf16 v[200:215], v[232:235], v[28:31], v[200:215]
    s_waitcnt lgkmcnt(8)
    v_mfma_f32_32x32x16_bf16 v[168:183], v[32:35], v[240:243], v[168:183]
    ds_read2st64_b32 v[232:233], v3 offset0:48 offset1:49
    ds_read2st64_b32 v[234:235], v3 offset0:50 offset1:51
    ds_read2st64_b32 v[236:237], v2 offset0:48 offset1:49
    ds_read2st64_b32 v[238:239], v2 offset0:50 offset1:51
    v_mfma_f32_32x32x16_bf16 v[184:199], v[32:35], v[244:247], v[184:199]
    v_mfma_f32_32x32x16_bf16 v[200:215], v[240:243], v[36:39], v[200:215]
    s_waitcnt lgkmcnt(8)
    v_mfma_f32_32x32x16_bf16 v[168:183], v[40:43], v[216:219], v[168:183]
    ds_read2st64_b32 v[240:241], v3 offset0:56 offset1:57
    ds_read2st64_b32 v[242:243], v3 offset0:58 offset1:59
    ds_read2st64_b32 v[244:245], v2 offset0:56 offset1:57
    ds_read2st64_b32 v[246:247], v2 offset0:58 offset1:59
    v_mfma_f32_32x32x16_bf16 v[184:199], v[40:43], v[220:223], v[184:199]
    buffer_load_dwordx4 v[8:11], v6, s[8:11], s39 offen offset:0 sc1
    v_mfma_f32_32x32x16_bf16 v[200:215], v[216:219], v[44:47], v[200:215]
    s_barrier
    s_waitcnt lgkmcnt(8)
    v_mfma_f32_32x32x16_bf16 v[168:183], v[48:51], v[224:227], v[168:183]
    ds_read2st64_b32 v[216:217], v3 offset0:64 offset1:65
    ds_read2st64_b32 v[218:219], v3 offset0:66 offset1:67
    ds_read2st64_b32 v[220:221], v2 offset0:64 offset1:65
    ds_read2st64_b32 v[222:223], v2 offset0:66 offset1:67
    v_mfma_f32_32x32x16_bf16 v[184:199], v[48:51], v[228:231], v[184:199]
    buffer_load_dwordx4 v[12:15], v6, s[8:11], s38 offen offset:0 sc1
    v_mfma_f32_32x32x16_bf16 v[200:215], v[224:227], v[52:55], v[200:215]
    buffer_load_dwordx4 v[16:19], v6, s[8:11], s39 offen offset:1024 sc1
    s_waitcnt lgkmcnt(8)
    v_mfma_f32_32x32x16_bf16 v[168:183], v[56:59], v[232:235], v[168:183]
    ds_read2st64_b32 v[224:225], v3 offset0:72 offset1:73
    ds_read2st64_b32 v[226:227], v3 offset0:74 offset1:75
    ds_read2st64_b32 v[228:229], v2 offset0:72 offset1:73
    ds_read2st64_b32 v[230:231], v2 offset0:74 offset1:75
    v_mfma_f32_32x32x16_bf16 v[184:199], v[56:59], v[236:239], v[184:199]
    buffer_load_dwordx4 v[20:23], v6, s[8:11], s38 offen offset:1024 sc1
    v_mfma_f32_32x32x16_bf16 v[200:215], v[232:235], v[60:63], v[200:215]
    s_waitcnt lgkmcnt(8)
    v_mfma_f32_32x32x16_bf16 v[168:183], v[64:67], v[240:243], v[168:183]
    ds_read2st64_b32 v[232:233], v3 offset0:80 offset1:81
    ds_read2st64_b32 v[234:235], v3 offset0:82 offset1:83
    ds_read2st64_b32 v[236:237], v2 offset0:80 offset1:81
    ds_read2st64_b32 v[238:239], v2 offset0:82 offset1:83
    v_mfma_f32_32x32x16_bf16 v[184:199], v[64:67], v[244:247], v[184:199]
    buffer_load_dwordx4 v[24:27], v6, s[8:11], s39 offen offset:2048 sc1
    v_mfma_f32_32x32x16_bf16 v[200:215], v[240:243], v[68:71], v[200:215]
    buffer_load_dwordx4 v[28:31], v6, s[8:11], s38 offen offset:2048 sc1
    s_waitcnt lgkmcnt(8)
    v_mfma_f32_32x32x16_bf16 v[168:183], v[72:75], v[216:219], v[168:183]
    ds_read2st64_b32 v[240:241], v3 offset0:88 offset1:89
    ds_read2st64_b32 v[242:243], v3 offset0:90 offset1:91
    ds_read2st64_b32 v[244:245], v2 offset0:88 offset1:89
    ds_read2st64_b32 v[246:247], v2 offset0:90 offset1:91
    v_mfma_f32_32x32x16_bf16 v[184:199], v[72:75], v[220:223], v[184:199]
    buffer_load_dwordx4 v[32:35], v6, s[8:11], s39 offen offset:3072 sc1
    s_add_u32 s39, s39, 4096
    v_mfma_f32_32x32x16_bf16 v[200:215], v[216:219], v[76:79], v[200:215]
    s_waitcnt lgkmcnt(8)
    v_mfma_f32_32x32x16_bf16 v[168:183], v[80:83], v[224:227], v[168:183]
    ds_read2st64_b32 v[216:217], v3 offset0:96 offset1:97
    ds_read2st64_b32 v[218:219], v3 offset0:98 offset1:99
    ds_read2st64_b32 v[220:221], v2 offset0:96 offset1:97
    ds_read2st64_b32 v[222:223], v2 offset0:98 offset1:99
    v_mfma_f32_32x32x16_bf16 v[184:199], v[80:83], v[228:231], v[184:199]
    buffer_load_dwordx4 v[36:39], v6, s[8:11], s38 offen offset:3072 sc1
    s_add_u32 s38, s38, 4096
    v_mfma_f32_32x32x16_bf16 v[200:215], v[224:227], v[84:87], v[200:215]
    buffer_load_dwordx4 v[40:43], v6, s[8:11], s39 offen offset:0 sc1
    s_waitcnt lgkmcnt(8)
    v_mfma_f32_32x32x16_bf16 v[168:183], v[88:91], v[232:235], v[168:183]
    ds_read2st64_b32 v[224:225], v3 offset0:104 offset1:105
    ds_read2st64_b32 v[226:227], v3 offset0:106 offset1:107
    ds_read2st64_b32 v[228:229], v2 offset0:104 offset1:105
    ds_read2st64_b32 v[230:231], v2 offset0:106 offset1:107
    v_mfma_f32_32x32x16_bf16 v[184:199], v[88:91], v[236:239], v[184:199]
    buffer_load_dwordx4 v[44:47], v6, s[8:11], s38 offen offset:0 sc1
    v_mfma_f32_32x32x16_bf16 v[200:215], v[232:235], v[92:95], v[200:215]
    s_waitcnt lgkmcnt(8)
    v_mfma_f32_32x32x16_bf16 v[168:183], v[96:99], v[240:243], v[168:183]
    ds_read2st64_b32 v[232:233], v3 offset0:112 offset1:113
    ds_read2st64_b32 v[234:235], v3 offset0:114 offset1:115
    ds_read2st64_b32 v[236:237], v2 offset0:112 offset1:113
    ds_read2st64_b32 v[238:239], v2 offset0:114 offset1:115
    v_mfma_f32_32x32x16_bf16 v[184:199], v[96:99], v[244:247], v[184:199]
    buffer_load_dwordx4 v[48:51], v6, s[8:11], s39 offen offset:1024 sc1
    v_mfma_f32_32x32x16_bf16 v[200:215], v[240:243], v[100:103], v[200:215]
    buffer_load_dwordx4 v[52:55], v6, s[8:11], s38 offen offset:1024 sc1
    s_waitcnt lgkmcnt(8)
    v_mfma_f32_32x32x16_bf16 v[168:183], v[104:107], v[216:219], v[168:183]
    ds_read2st64_b32 v[240:241], v3 offset0:120 offset1:121
    ds_read2st64_b32 v[242:243], v3 offset0:122 offset1:123
    ds_read2st64_b32 v[244:245], v2 offset0:120 offset1:121
    ds_read2st64_b32 v[246:247], v2 offset0:122 offset1:123
    v_mfma_f32_32x32x16_bf16 v[184:199], v[104:107], v[220:223], v[184:199]
    buffer_load_dwordx4 v[56:59], v6, s[8:11], s39 offen offset:2048 sc1
    v_mfma_f32_32x32x16_bf16 v[200:215], v[216:219], v[108:111], v[200:215]
    s_waitcnt lgkmcnt(8)
    v_mfma_f32_32x32x16_bf16 v[168:183], v[112:115], v[224:227], v[168:183]
    ds_read2st64_b32 v[216:217], v3 offset0:128 offset1:129
    ds_read2st64_b32 v[218:219], v3 offset0:130 offset1:131
    ds_read2st64_b32 v[220:221], v2 offset0:128 offset1:129
    ds_read2st64_b32 v[222:223], v2 offset0:130 offset1:131
    v_mfma_f32_32x32x16_bf16 v[184:199], v[112:115], v[228:231], v[184:199]
    buffer_load_dwordx4 v[60:63], v6, s[8:11], s38 offen offset:2048 sc1
    v_mfma_f32_32x32x16_bf16 v[200:215], v[224:227], v[116:119], v[200:215]
    buffer_load_dwordx4 v[64:67], v6, s[8:11], s39 offen offset:3072 sc1
    s_add_u32 s39, s39, 4096
    s_waitcnt lgkmcnt(8)
    v_mfma_f32_32x32x16_bf16 v[168:183], v[120:123], v[232:235], v[168:183]
    ds_read2st64_b32 v[224:225], v3 offset0:136 offset1:137
    ds_read2st64_b32 v[226:227], v3 offset0:138 offset1:139
    ds_read2st64_b32 v[228:229], v2 offset0:136 offset1:137
    ds_read2st64_b32 v[230:231], v2 offset0:138 offset1:139
    v_mfma_f32_32x32x16_bf16 v[184:199], v[120:123], v[236:239], v[184:199]
    buffer_load_dwordx4 v[68:71], v6, s[8:11], s38 offen offset:3072 sc1
    s_add_u32 s38, s38, 4096
    v_mfma_f32_32x32x16_bf16 v[200:215], v[232:235], v[124:127], v[200:215]
    s_waitcnt lgkmcnt(8)
    v_mfma_f32_32x32x16_bf16 v[168:183], v[128:131], v[240:243], v[168:183]
    ds_read2st64_b32 v[232:233], v3 offset0:144 offset1:145
    ds_read2st64_b32 v[234:235], v3 offset0:146 offset1:147
    ds_read2st64_b32 v[236:237], v2 offset0:144 offset1:145
    ds_read2st64_b32 v[238:239], v2 offset0:146 offset1:147
    v_mfma_f32_32x32x16_bf16 v[184:199], v[128:131], v[244:247], v[184:199]
    buffer_load_dwordx4 v[72:75], v6, s[8:11], s39 offen offset:0 sc1
    v_mfma_f32_32x32x16_bf16 v[200:215], v[240:243], v[132:135], v[200:215]
    buffer_load_dwordx4 v[76:79], v6, s[8:11], s38 offen offset:0 sc1
    s_waitcnt vmcnt(16)
    s_waitcnt lgkmcnt(8)
    v_mfma_f32_32x32x16_bf16 v[168:183], v[8:11], v[216:219], v[168:183]
    ds_read2st64_b32 v[240:241], v3 offset0:152 offset1:153
    ds_read2st64_b32 v[242:243], v3 offset0:154 offset1:155
    ds_read2st64_b32 v[244:245], v2 offset0:152 offset1:153
    ds_read2st64_b32 v[246:247], v2 offset0:154 offset1:155
    v_mfma_f32_32x32x16_bf16 v[184:199], v[8:11], v[220:223], v[184:199]
    buffer_load_dwordx4 v[80:83], v6, s[8:11], s39 offen offset:1024 sc1
    v_mfma_f32_32x32x16_bf16 v[200:215], v[216:219], v[12:15], v[200:215]
    s_waitcnt vmcnt(15)
    s_waitcnt lgkmcnt(8)
    v_mfma_f32_32x32x16_bf16 v[168:183], v[16:19], v[224:227], v[168:183]
    ds_read2st64_b32 v[216:217], v3 offset0:160 offset1:161
    ds_read2st64_b32 v[218:219], v3 offset0:162 offset1:163
    ds_read2st64_b32 v[220:221], v2 offset0:160 offset1:161
    ds_read2st64_b32 v[222:223], v2 offset0:162 offset1:163
    v_mfma_f32_32x32x16_bf16 v[184:199], v[16:19], v[228:231], v[184:199]
    buffer_load_dwordx4 v[84:87], v6, s[8:11], s38 offen offset:1024 sc1
    v_mfma_f32_32x32x16_bf16 v[200:215], v[224:227], v[20:23], v[200:215]
    buffer_load_dwordx4 v[88:91], v6, s[8:11], s39 offen offset:2048 sc1
    s_waitcnt vmcnt(15)
    s_waitcnt lgkmcnt(8)
    v_mfma_f32_32x32x16_bf16 v[168:183], v[24:27], v[232:235], v[168:183]
    ds_read2st64_b32 v[224:225], v3 offset0:168 offset1:169
    ds_read2st64_b32 v[226:227], v3 offset0:170 offset1:171
    ds_read2st64_b32 v[228:229], v2 offset0:168 offset1:169
    ds_read2st64_b32 v[230:231], v2 offset0:170 offset1:171
    v_mfma_f32_32x32x16_bf16 v[184:199], v[24:27], v[236:239], v[184:199]
    buffer_load_dwordx4 v[92:95], v6, s[8:11], s38 offen offset:2048 sc1
    v_mfma_f32_32x32x16_bf16 v[200:215], v[232:235], v[28:31], v[200:215]
    s_waitcnt vmcnt(14)
    s_waitcnt lgkmcnt(8)
    v_mfma_f32_32x32x16_bf16 v[168:183], v[32:35], v[240:243], v[168:183]
    ds_read2st64_b32 v[232:233], v3 offset0:176 offset1:177
    ds_read2st64_b32 v[234:235], v3 offset0:178 offset1:179
    ds_read2st64_b32 v[236:237], v2 offset0:176 offset1:177
    ds_read2st64_b32 v[238:239], v2 offset0:178 offset1:179
    v_mfma_f32_32x32x16_bf16 v[184:199], v[32:35], v[244:247], v[184:199]
    buffer_load_dwordx4 v[96:99], v6, s[8:11], s39 offen offset:3072 sc1
    s_add_u32 s39, s39, 4096
    v_mfma_f32_32x32x16_bf16 v[200:215], v[240:243], v[36:39], v[200:215]
    buffer_load_dwordx4 v[100:103], v6, s[8:11], s38 offen offset:3072 sc1
    s_add_u32 s38, s38, 4096
    s_waitcnt vmcnt(14)
    s_waitcnt lgkmcnt(8)
    v_mfma_f32_32x32x16_bf16 v[168:183], v[40:43], v[216:219], v[168:183]
    ds_read2st64_b32 v[240:241], v3 offset0:184 offset1:185
    ds_read2st64_b32 v[242:243], v3 offset0:186 offset1:187
    ds_read2st64_b32 v[244:245], v2 offset0:184 offset1:185
    ds_read2st64_b32 v[246:247], v2 offset0:186 offset1:187
    v_mfma_f32_32x32x16_bf16 v[184:199], v[40:43], v[220:223], v[184:199]
    buffer_load_dwordx4 v[104:107], v6, s[8:11], s39 offen offset:0 sc1
    v_mfma_f32_32x32x16_bf16 v[200:215], v[216:219], v[44:47], v[200:215]
    s_waitcnt vmcnt(13)
    s_waitcnt lgkmcnt(8)
    v_mfma_f32_32x32x16_bf16 v[168:183], v[48:51], v[224:227], v[168:183]
    ds_read2st64_b32 v[216:217], v3 offset0:192 offset1:193
    ds_read2st64_b32 v[218:219], v3 offset0:194 offset1:195
    ds_read2st64_b32 v[220:221], v2 offset0:192 offset1:193
    ds_read2st64_b32 v[222:223], v2 offset0:194 offset1:195
    v_mfma_f32_32x32x16_bf16 v[184:199], v[48:51], v[228:231], v[184:199]
    buffer_load_dwordx4 v[108:111], v6, s[8:11], s38 offen offset:0 sc1
    v_mfma_f32_32x32x16_bf16 v[200:215], v[224:227], v[52:55], v[200:215]
    buffer_load_dwordx4 v[112:115], v6, s[8:11], s39 offen offset:1024 sc1
    s_waitcnt vmcnt(13)
    s_waitcnt lgkmcnt(8)
    v_mfma_f32_32x32x16_bf16 v[168:183], v[56:59], v[232:235], v[168:183]
    ds_read2st64_b32 v[224:225], v3 offset0:200 offset1:201
    ds_read2st64_b32 v[226:227], v3 offset0:202 offset1:203
    ds_read2st64_b32 v[228:229], v2 offset0:200 offset1:201
    ds_read2st64_b32 v[230:231], v2 offset0:202 offset1:203
    v_mfma_f32_32x32x16_bf16 v[184:199], v[56:59], v[236:239], v[184:199]
    buffer_load_dwordx4 v[116:119], v6, s[8:11], s38 offen offset:1024 sc1
    v_mfma_f32_32x32x16_bf16 v[200:215], v[232:235], v[60:63], v[200:215]
    s_waitcnt vmcnt(12)
    s_waitcnt lgkmcnt(8)
    v_mfma_f32_32x32x16_bf16 v[168:183], v[64:67], v[240:243], v[168:183]
    ds_read2st64_b32 v[232:233], v3 offset0:208 offset1:209
    ds_read2st64_b32 v[234:235], v3 offset0:210 offset1:211
    ds_read2st64_b32 v[236:237], v2 offset0:208 offset1:209
    ds_read2st64_b32 v[238:239], v2 offset0:210 offset1:211
    v_mfma_f32_32x32x16_bf16 v[184:199], v[64:67], v[244:247], v[184:199]
    buffer_load_dwordx4 v[120:123], v6, s[8:11], s39 offen offset:2048 sc1
    v_mfma_f32_32x32x16_bf16 v[200:215], v[240:243], v[68:71], v[200:215]
    buffer_load_dwordx4 v[124:127], v6, s[8:11], s38 offen offset:2048 sc1
    s_waitcnt vmcnt(12)
    s_waitcnt lgkmcnt(8)
    v_mfma_f32_32x32x16_bf16 v[168:183], v[72:75], v[216:219], v[168:183]
    ds_read2st64_b32 v[240:241], v3 offset0:216 offset1:217
    ds_read2st64_b32 v[242:243], v3 offset0:218 offset1:219
    ds_read2st64_b32 v[244:245], v2 offset0:216 offset1:217
    ds_read2st64_b32 v[246:247], v2 offset0:218 offset1:219
    v_mfma_f32_32x32x16_bf16 v[184:199], v[72:75], v[220:223], v[184:199]
    buffer_load_dwordx4 v[128:131], v6, s[8:11], s39 offen offset:3072 sc1
    s_add_u32 s39, s39, 4096
    v_mfma_f32_32x32x16_bf16 v[200:215], v[216:219], v[76:79], v[200:215]
    s_waitcnt vmcnt(11)
    s_waitcnt lgkmcnt(8)
    v_mfma_f32_32x32x16_bf16 v[168:183], v[80:83], v[224:227], v[168:183]
    ds_read2st64_b32 v[216:217], v3 offset0:224 offset1:225
    ds_read2st64_b32 v[218:219], v3 offset0:226 offset1:227
    ds_read2st64_b32 v[220:221], v2 offset0:224 offset1:225
    ds_read2st64_b32 v[222:223], v2 offset0:226 offset1:227
    v_mfma_f32_32x32x16_bf16 v[184:199], v[80:83], v[228:231], v[184:199]
    buffer_load_dwordx4 v[132:135], v6, s[8:11], s38 offen offset:3072 sc1
    s_add_u32 s38, s38, 4096
    v_mfma_f32_32x32x16_bf16 v[200:215], v[224:227], v[84:87], v[200:215]
    s_waitcnt vmcnt(10)
    s_waitcnt lgkmcnt(8)
    v_mfma_f32_32x32x16_bf16 v[168:183], v[88:91], v[232:235], v[168:183]
    ds_read2st64_b32 v[224:225], v3 offset0:232 offset1:233
    ds_read2st64_b32 v[226:227], v3 offset0:234 offset1:235
    ds_read2st64_b32 v[228:229], v2 offset0:232 offset1:233
    ds_read2st64_b32 v[230:231], v2 offset0:234 offset1:235
    v_mfma_f32_32x32x16_bf16 v[184:199], v[88:91], v[236:239], v[184:199]
    v_mfma_f32_32x32x16_bf16 v[200:215], v[232:235], v[92:95], v[200:215]
    s_waitcnt vmcnt(8)
    s_waitcnt lgkmcnt(8)
    v_mfma_f32_32x32x16_bf16 v[168:183], v[96:99], v[240:243], v[168:183]
    ds_read2st64_b32 v[232:233], v3 offset0:240 offset1:241
    ds_read2st64_b32 v[234:235], v3 offset0:242 offset1:243
    ds_read2st64_b32 v[236:237], v2 offset0:240 offset1:241
    ds_read2st64_b32 v[238:239], v2 offset0:242 offset1:243
    v_mfma_f32_32x32x16_bf16 v[184:199], v[96:99], v[244:247], v[184:199]
    v_mfma_f32_32x32x16_bf16 v[200:215], v[240:243], v[100:103], v[200:215]
    s_waitcnt vmcnt(6)
    s_waitcnt lgkmcnt(8)
    v_mfma_f32_32x32x16_bf16 v[168:183], v[104:107], v[216:219], v[168:183]
    ds_read2st64_b32 v[240:241], v3 offset0:248 offset1:249
    ds_read2st64_b32 v[242:243], v3 offset0:250 offset1:251
    ds_read2st64_b32 v[244:245], v2 offset0:248 offset1:249
    ds_read2st64_b32 v[246:247], v2 offset0:250 offset1:251
    v_mfma_f32_32x32x16_bf16 v[184:199], v[104:107], v[220:223], v[184:199]
    v_mfma_f32_32x32x16_bf16 v[200:215], v[216:219], v[108:111], v[200:215]
    s_waitcnt vmcnt(4)
    s_waitcnt lgkmcnt(8)
    v_mfma_f32_32x32x16_bf16 v[168:183], v[112:115], v[224:227], v[168:183]
    v_mfma_f32_32x32x16_bf16 v[184:199], v[112:115], v[228:231], v[184:199]
    v_mfma_f32_32x32x16_bf16 v[200:215], v[224:227], v[116:119], v[200:215]
    s_barrier
    s_waitcnt vmcnt(2)
    s_waitcnt lgkmcnt(4)
    v_mfma_f32_32x32x16_bf16 v[168:183], v[120:123], v[232:235], v[168:183]
    v_mfma_f32_32x32x16_bf16 v[184:199], v[120:123], v[236:239], v[184:199]
    v_mfma_f32_32x32x16_bf16 v[200:215], v[232:235], v[124:127], v[200:215]
    ds_read_b32 v252, v248
    ds_read_b32 v254, v249
    ds_read_b128 v[8:11], v250 offset:0
    ds_read_b128 v[12:15], v250 offset:32
    ds_read_b128 v[16:19], v250 offset:64
    ds_read_b128 v[20:23], v250 offset:96
    s_waitcnt vmcnt(0)
    s_waitcnt lgkmcnt(6)
    v_mfma_f32_32x32x16_bf16 v[168:183], v[128:131], v[240:243], v[168:183]
    v_mfma_f32_32x32x16_bf16 v[184:199], v[128:131], v[244:247], v[184:199]
    v_mfma_f32_32x32x16_bf16 v[200:215], v[240:243], v[132:135], v[200:215]
    s_cmp_ge_u32 s36, 8
    s_cselect_b32 s33, 16, 0
    s_add_u32 s33, s33, s25
    s_waitcnt lgkmcnt(0)
    v_mul_f32 v252, s26, v252
    v_mul_f32 v254, s26, v254
    s_nop 3
    v_pk_mul_f32 v[168:169], v[168:169], v[252:253] op_sel_hi:[1,0]
    v_pk_mul_f32 v[170:171], v[170:171], v[252:253] op_sel_hi:[1,0]
    v_pk_mul_f32 v[172:173], v[172:173], v[252:253] op_sel_hi:[1,0]
    v_pk_mul_f32 v[174:175], v[174:175], v[252:253] op_sel_hi:[1,0]
    v_pk_mul_f32 v[176:177], v[176:177], v[252:253] op_sel_hi:[1,0]
    v_pk_mul_f32 v[178:179], v[178:179], v[252:253] op_sel_hi:[1,0]
    v_pk_mul_f32 v[180:181], v[180:181], v[252:253] op_sel_hi:[1,0]
    v_pk_mul_f32 v[182:183], v[182:183], v[252:253] op_sel_hi:[1,0]
    v_cvt_pk_bf16_f32 v24, v168, v169
    v_cvt_pk_bf16_f32 v25, v170, v171
    v_cvt_pk_bf16_f32 v26, v172, v173
    v_cvt_pk_bf16_f32 v27, v174, v175
    v_cvt_pk_bf16_f32 v28, v176, v177
    v_cvt_pk_bf16_f32 v29, v178, v179
    v_cvt_pk_bf16_f32 v30, v180, v181
    v_cvt_pk_bf16_f32 v31, v182, v183
    s_cmp_ge_u32 s33, 17
    s_cbranch_scc1 qkv_def0
    buffer_store_dwordx4 v[24:27], v6, s[8:11], s28 offen sc1
    buffer_store_dwordx4 v[28:31], v6, s[8:11], s22 offen sc1
qkv_def0:
    v_pk_mul_f32 v[184:185], v[184:185], v[254:255] op_sel_hi:[1,0]
    v_pk_mul_f32 v[186:187], v[186:187], v[254:255] op_sel_hi:[1,0]
    v_pk_mul_f32 v[188:189], v[188:189], v[254:255] op_sel_hi:[1,0]
    v_pk_mul_f32 v[190:191], v[190:191], v[254:255] op_sel_hi:[1,0]
    v_pk_mul_f32 v[192:193], v[192:193], v[254:255] op_sel_hi:[1,0]
    v_pk_mul_f32 v[194:195], v[194:195], v[254:255] op_sel_hi:[1,0]
    v_pk_mul_f32 v[196:197], v[196:197], v[254:255] op_sel_hi:[1,0]
    v_pk_mul_f32 v[198:199], v[198:199], v[254:255] op_sel_hi:[1,0]
    v_cvt_pk_bf16_f32 v32, v184, v185
    v_cvt_pk_bf16_f32 v33, v186, v187
    v_cvt_pk_bf16_f32 v34, v188, v189
    v_cvt_pk_bf16_f32 v35, v190, v191
    v_cvt_pk_bf16_f32 v36, v192, v193
    v_cvt_pk_bf16_f32 v37, v194, v195
    v_cvt_pk_bf16_f32 v38, v196, v197
    v_cvt_pk_bf16_f32 v39, v198, v199
    s_cmp_ge_u32 s33, 17
    s_cbranch_scc1 qkv_def1
    buffer_store_dwordx4 v[32:35], v6, s[8:11], s29 offen sc1
    buffer_store_dwordx4 v[36:39], v6, s[8:11], s23 offen sc1
qkv_def1:
    v_pk_mul_f32 v[200:201], v[200:201], v[8:9]
    v_pk_mul_f32 v[202:203], v[202:203], v[10:11]
    v_pk_mul_f32 v[204:205], v[204:205], v[12:13]
    v_pk_mul_f32 v[206:207], v[206:207], v[14:15]
    v_pk_mul_f32 v[208:209], v[208:209], v[16:17]
    v_pk_mul_f32 v[210:211], v[210:211], v[18:19]
    v_pk_mul_f32 v[212:213], v[212:213], v[20:21]
    v_pk_mul_f32 v[214:215], v[214:215], v[22:23]
    v_cvt_pk_bf16_f32 v40, v200, v201
    v_cvt_pk_bf16_f32 v41, v202, v203
    v_cvt_pk_bf16_f32 v42, v204, v205
    v_cvt_pk_bf16_f32 v43, v206, v207
    v_cvt_pk_bf16_f32 v44, v208, v209
    v_cvt_pk_bf16_f32 v45, v210, v211
    v_cvt_pk_bf16_f32 v46, v212, v213
    v_cvt_pk_bf16_f32 v47, v214, v215
    s_cmp_lt_u32 s36, 8
    s_cbranch_scc1 qkv_nod
    s_sleep 10
    s_cmp_lt_u32 s33, 17
    s_cbranch_scc1 qkv_nod
    buffer_store_dwordx4 v[24:27], v6, s[8:11], s28 offen sc1
    buffer_store_dwordx4 v[28:31], v6, s[8:11], s22 offen sc1
    buffer_store_dwordx4 v[32:35], v6, s[8:11], s29 offen sc1
    buffer_store_dwordx4 v[36:39], v6, s[8:11], s23 offen sc1
qkv_nod:
    buffer_store_dwordx4 v[40:43], v7, s[8:11], s27 offen sc1
    buffer_store_dwordx4 v[44:47], v7, s[8:11], s27 offen offset:512 sc1
    s_setprio 0
qkv_end:
    s_barrier
    s_mov_b32 s58, s36
    s_and_b32 s36, s2, 31
    s_lshr_b32 s37, s2, 5
    s_lshl_b32 s37, s37, 3
    s_add_u32 s37, s37, s20
    s_lshl_b32 s38, s36, 16
    s_add_u32 s38, s38, s48
    s_lshl_b32 s39, s37, 10
    s_add_u32 s39, s39, s38
    s_lshl_b32 s40, s20, 10
    s_add_u32 s41, s38, s40
    s_add_u32 s41, s41, 2097152
    s_add_u32 s42, s41, 2097152
    v_lshlrev_b32 v118, 4, v1
    v_and_b32 v5, 0x33, v1
    v_and_b32 v6, 4, v1
    v_lshl_or_b32 v5, v6, 1, v5
    v_and_b32 v6, 8, v1
    v_lshrrev_b32 v6, 1, v6
    v_or_b32 v5, v5, v6
    v_lshlrev_b32 v5, 4, v5
    v_mov_b32 v112, 0xdddd
    s_mov_b32 s56, 0xffff
    s_mov_b32 s57, 0xffff
    s_add_u32 s47, s40, 0x10000
    v_lshrrev_b32 v6, 5, v1
    v_lshlrev_b32 v119, 8, v6
    v_and_b32 v6, 15, v1
    v_lshl_add_u32 v119, v6, 4, v119
    v_add_u32 v119, 0x10000, v119
    v_mov_b32 v64, 0x3f803f80
    v_and_b32 v6, 27, v1
    v_cmp_eq_u32 vcc, 16, v6
    s_nop 1
    v_cndmask_b32 v96, 0, v64, vcc
    v_cndmask_b32 v97, 0, v64, vcc
    v_cndmask_b32 v98, 0, v64, vcc
    v_cndmask_b32 v99, 0, v64, vcc
    v_cndmask_b32 v100, 0, v64, vcc
    v_cndmask_b32 v101, 0, v64, vcc
    v_cndmask_b32 v102, 0, v64, vcc
    v_cndmask_b32 v103, 0, v64, vcc
    v_cndmask_b32 v104, 0, v64, vcc
    v_cndmask_b32 v105, 0, v64, vcc
    v_cndmask_b32 v106, 0, v64, vcc
    v_cndmask_b32 v107, 0, v64, vcc
    v_mov_b32 v32, 0
    v_mov_b32 v33, 0
    v_mov_b32 v34, 0
    v_mov_b32 v35, 0
    v_mov_b32 v36, 0
    v_mov_b32 v37, 0
    v_mov_b32 v38, 0
    v_mov_b32 v39, 0
    v_mov_b32 v40, 0
    v_mov_b32 v41, 0
    v_mov_b32 v42, 0
    v_mov_b32 v43, 0
    v_mov_b32 v44, 0
    v_mov_b32 v45, 0
    v_mov_b32 v46, 0
    v_mov_b32 v47, 0
    v_mov_b32 v114, -1
    v_mov_b32 v115, -1
    v_mov_b32 v116, -1
    v_mov_b32 v117, -1
    s_and_b32 s51, s2, 7
    s_lshl_b32 s51, s51, 4
    s_lshr_b32 s52, s2, 3
    s_and_b32 s53, s52, 15
    s_add_u32 s51, s51, s53
    s_lshr_b32 s52, s52, 4
    s_lshl_b32 s52, s52, 3
    s_add_u32 s52, s52, s20
    v_and_b32 v6, 16, v1
    v_lshlrev_b32 v7, 10, v6
    v_lshrrev_b32 v6, 5, v1
    v_lshl_add_u32 v7, v6, 8, v7
    v_and_b32 v4, 15, v1
    v_lshl_add_u32 v7, v4, 4, v7
    s_lshl_b32 s43, s37, 15
    s_lshr_b32 s22, s36, 1
    s_lshl_b32 s22, s22, 10
    s_add_u32 s43, s43, s22
    s_and_b32 s22, s36, 1
    s_lshl_b32 s22, s22, 9
    s_add_u32 s43, s43, s22
    v_lshrrev_b32 v3, 4, v1
    s_cmp_lg_u32 s21, 0
    s_cbranch_scc1 att_l2addr
    v_mul_u32_u24 v6, 16896, v3
    v_lshl_add_u32 v6, v4, 2, v6
    s_mul_i32 s60, s52, 135168
    s_lshl_b32 s22, s51, 6
    s_add_u32 s60, s60, s22
    s_add_u32 s60, s60, 0
    s_add_u32 s61, s60, 8448
    s_add_u32 s62, s60, 67584
    s_add_u32 s63, s60, 76032
    s_lshl_b32 s54, s52, 15
    s_add_u32 s54, s54, 14942208
    s_branch att_addr_done
att_l2addr:
    s_and_b32 s51, s2, 7
    s_lshl_b32 s51, s51, 3
    s_bfe_u32 s22, s2, 0x30003
    s_add_u32 s51, s51, s22
    s_lshr_b32 s52, s2, 6
    v_lshlrev_b32 v6, 15, v3
    v_lshl_add_u32 v6, v4, 4, v6
    s_and_b32 s60, s51, 1
    s_lshl_b32 s60, s60, 20
    s_lshl_b32 s22, s20, 17
    s_add_u32 s60, s60, s22
    s_lshr_b32 s22, s51, 1
    s_lshl_b32 s22, s22, 10
    s_add_u32 s60, s60, s22
    s_lshl_b32 s22, s52, 8
    s_add_u32 s60, s60, s22
    s_lshl_b32 s54, s52, 2
    s_add_u32 s54, s54, s3
    s_lshl_b32 s54, s54, 15
    s_lshr_b32 s22, s20, 2
    s_lshl_b32 s22, s22, 14
    s_add_u32 s54, s54, s22
    v_and_b32 v3, 16, v1
    v_lshlrev_b32 v3, 6, v3
    v_lshrrev_b32 v2, 5, v1
    v_lshl_add_u32 v3, v2, 8, v3
    v_lshl_add_u32 v3, v4, 4, v3
    s_add_u32 s53, s54, 15466496
    s_add_u32 s54, s54, 15990784
    v_lshrrev_b32 v2, 3, v1
    v_and_b32 v64, 7, v1
    v_mul_u32_u24 v2, 8448, v2
    v_lshl_add_u32 v2, v64, 4, v2
    s_lshl_b32 s55, s51, 7
    s_mul_i32 s22, s20, 270336
    s_add_u32 s55, s55, s22
    s_add_u32 s55, s55, 25165824
att_addr_done:
    v_add_u32 v4, s40, v118
    s_add_u32 s22, s41, 8192
    s_add_u32 s23, s42, 8192
    s_mov_b32 s35, 0
    s_sleep 4
    s_cmp_ge_u32 s58, 8
    s_cbranch_scc1 att_poll
    s_sleep 10
att_poll:
    buffer_load_dwordx4 v[8:11], v118, s[8:11], s39 offen sc1
    buffer_load_dwordx4 v[88:91], v118, s[8:11], s41 offen sc1
    buffer_load_dwordx4 v[80:83], v118, s[8:11], s42 offen sc1
    buffer_load_dwordx4 v[92:95], v118, s[8:11], s22 offen sc1
    buffer_load_dwordx4 v[84:87], v118, s[8:11], s23 offen sc1
    s_waitcnt vmcnt(0)
    v_max3_u32 v108, v8, v9, v10
    v_max3_u32 v108, v108, v11, v80
    v_max3_u32 v108, v108, v81, v82
    v_max3_u32 v108, v108, v83, v84
    v_max3_u32 v108, v108, v85, v86
    v_max3_u32 v108, v108, v87, v88
    v_max3_u32 v108, v108, v89, v90
    v_max3_u32 v108, v108, v91, v92
    v_max3_u32 v108, v108, v93, v94
    v_max_u32 v108, v108, v95
    v_cmp_eq_u32 vcc, -1, v108
    s_add_u32 s35, s35, 1
    s_cmp_gt_u32 s35, 262144
    s_cbranch_scc1 att_ok
    s_nop 1
    s_cbranch_vccz att_ok
    s_sleep 4
    s_branch att_poll
att_ok:
    v_mfma_f32_32x32x16_bf16 v[64:79], v[88:91], v[8:11], 0
    ds_write_b128 v4, v[88:91]
    ds_write_b128 v4, v[92:95] offset:8192
    v_add_u32 v4, s47, v118
    ds_write_b128 v4, v[80:83]
    ds_write_b128 v4, v[84:87] offset:8192
    s_nop 6
    v_max3_f32 v108, v64, v65, v66
    v_max_f32 v108, v108, v67
    v_max3_f32 v108, v108, v68, v69
    v_max3_f32 v108, v108, v70, v71
    v_max3_f32 v108, v108, v72, v73
    v_max3_f32 v108, v108, v74, v75
    v_max3_f32 v108, v108, v76, v77
    v_max3_f32 v108, v108, v78, v79
    v_mov_b32 v109, v108
    s_nop 1
    v_permlane32_swap_b32 v108, v109
    v_max_f32 v108, v108, v109
    v_sub_f32 v16, 0, v108
    v_sub_f32 v17, 0, v108
    v_sub_f32 v18, 0, v108
    v_sub_f32 v19, 0, v108
    v_sub_f32 v20, 0, v108
    v_sub_f32 v21, 0, v108
    v_sub_f32 v22, 0, v108
    v_sub_f32 v23, 0, v108
    v_sub_f32 v24, 0, v108
    v_sub_f32 v25, 0, v108
    v_sub_f32 v26, 0, v108
    v_sub_f32 v27, 0, v108
    v_sub_f32 v28, 0, v108
    v_sub_f32 v29, 0, v108
    v_sub_f32 v30, 0, v108
    v_sub_f32 v31, 0, v108
    s_waitcnt lgkmcnt(0)
    s_barrier
    ds_read_b128 v[88:91], v5
    ds_read_b128 v[92:95], v5 offset:1024
    s_mov_b64 exec, s[56:57]
    ds_read_b128 v[96:99], v119
    s_mov_b64 exec, -1
    s_cmp_lg_u32 s20, 7
    s_cbranch_scc1 att_noarr
    s_and_b32 s33, s2, 15
    s_lshl_b32 s34, s33, 8
    s_add_u32 s34, s34, s50
    v_mov_b32 v80, 0
    v_mov_b32 v81, 1
    s_mov_b64 exec, 1
    buffer_atomic_add v81, v80, s[8:11], s34 offen sc0 sc1
    s_lshl_b32 s33, s33, 2
    s_add_u32 s34, s50, 4096
    s_add_u32 s34, s34, s33
    s_waitcnt vmcnt(0)
    v_readfirstlane_b32 s35, v81
    s_mov_b64 exec, -1
    s_cmp_lg_u32 s35, 15
    s_cbranch_scc1 ar22_done
    v_and_b32 v80, 31, v1
    v_lshlrev_b32 v80, 8, v80
    v_mov_b32 v81, 1
    buffer_store_dword v81, v80, s[8:11], s34 offen sc1
ar22_done:
att_noarr:
    s_waitcnt lgkmcnt(2)
    v_mfma_f32_32x32x16_bf16 v[48:63], v[88:91], v[8:11], v[16:31]
    s_setprio 3
    s_nop 10
    v_exp_f32 v48, v48
    v_exp_f32 v49, v49
    s_waitcnt lgkmcnt(0)
    v_exp_f32 v50, v50
    v_exp_f32 v51, v51
    v_exp_f32 v52, v52
    v_exp_f32 v53, v53
    v_mfma_f32_32x32x16_bf16 v[64:79], v[92:95], v[8:11], v[16:31]
    ds_read_b128 v[88:91], v5 offset:2048
    s_mov_b64 exec, s[56:57]
    ds_read_b128 v[100:103], v119 offset:1024
    ds_read_b128 v[104:107], v119 offset:512
    s_mov_b64 exec, -1
    v_exp_f32 v54, v54
    v_exp_f32 v55, v55
    v_exp_f32 v56, v56
    v_exp_f32 v57, v57
    v_smfmac_f32_32x32x32_bf16 v[32:47], v[96:99], v[48:55], v112
    v_exp_f32 v58, v58
    v_exp_f32 v59, v59
    v_exp_f32 v60, v60
    v_exp_f32 v61, v61
    v_exp_f32 v62, v62
    v_exp_f32 v63, v63
    v_exp_f32 v64, v64
    v_exp_f32 v65, v65
    s_waitcnt lgkmcnt(0)
    v_smfmac_f32_32x32x32_bf16 v[32:47], v[104:107], v[56:63], v112
    v_exp_f32 v66, v66
    v_exp_f32 v67, v67
    v_exp_f32 v68, v68
    v_exp_f32 v69, v69
    v_mfma_f32_32x32x16_bf16 v[48:63], v[88:91], v[8:11], v[16:31]
    ds_read_b128 v[92:95], v5 offset:3072
    s_mov_b64 exec, s[56:57]
    ds_read_b128 v[96:99], v119 offset:2048
    ds_read_b128 v[104:107], v119 offset:1536
    s_mov_b64 exec, -1
    v_exp_f32 v70, v70
    v_exp_f32 v71, v71
    v_exp_f32 v72, v72
    v_exp_f32 v73, v73
    v_smfmac_f32_32x32x32_bf16 v[32:47], v[100:103], v[64:71], v112
    v_exp_f32 v74, v74
    v_exp_f32 v75, v75
    v_exp_f32 v76, v76
    v_exp_f32 v77, v77
    v_exp_f32 v78, v78
    v_exp_f32 v79, v79
    v_exp_f32 v48, v48
    v_exp_f32 v49, v49
    s_waitcnt lgkmcnt(0)
    v_smfmac_f32_32x32x32_bf16 v[32:47], v[104:107], v[72:79], v112
    v_exp_f32 v50, v50
    v_exp_f32 v51, v51
    v_exp_f32 v52, v52
    v_exp_f32 v53, v53
    v_mfma_f32_32x32x16_bf16 v[64:79], v[92:95], v[8:11], v[16:31]
    ds_read_b128 v[88:91], v5 offset:4096
    s_mov_b64 exec, s[56:57]
    ds_read_b128 v[100:103], v119 offset:3072
    ds_read_b128 v[104:107], v119 offset:2560
    s_mov_b64 exec, -1
    v_exp_f32 v54, v54
    v_exp_f32 v55, v55
    v_exp_f32 v56, v56
    v_exp_f32 v57, v57
    v_smfmac_f32_32x32x32_bf16 v[32:47], v[96:99], v[48:55], v112
    v_exp_f32 v58, v58
    v_exp_f32 v59, v59
    v_exp_f32 v60, v60
    v_exp_f32 v61, v61
    v_exp_f32 v62, v62
    v_exp_f32 v63, v63
    s_setprio 2
    v_exp_f32 v64, v64
    v_exp_f32 v65, v65
    s_waitcnt lgkmcnt(0)
    v_smfmac_f32_32x32x32_bf16 v[32:47], v[104:107], v[56:63], v112
    v_exp_f32 v66, v66
    v_exp_f32 v67, v67
    v_exp_f32 v68, v68
    v_exp_f32 v69, v69
    v_mfma_f32_32x32x16_bf16 v[48:63], v[88:91], v[8:11], v[16:31]
    ds_read_b128 v[92:95], v5 offset:5120
    s_mov_b64 exec, s[56:57]
    ds_read_b128 v[96:99], v119 offset:4096
    ds_read_b128 v[104:107], v119 offset:3584
    s_mov_b64 exec, -1
    v_exp_f32 v70, v70
    v_exp_f32 v71, v71
    v_exp_f32 v72, v72
    v_exp_f32 v73, v73
    v_smfmac_f32_32x32x32_bf16 v[32:47], v[100:103], v[64:71], v112
    v_exp_f32 v74, v74
    v_exp_f32 v75, v75
    v_exp_f32 v76, v76
    v_exp_f32 v77, v77
    v_exp_f32 v78, v78
    v_exp_f32 v79, v79
    v_exp_f32 v48, v48
    v_exp_f32 v49, v49
    s_waitcnt lgkmcnt(0)
    v_smfmac_f32_32x32x32_bf16 v[32:47], v[104:107], v[72:79], v112
    v_exp_f32 v50, v50
    v_exp_f32 v51, v51
    v_exp_f32 v52, v52
    v_exp_f32 v53, v53
    v_mfma_f32_32x32x16_bf16 v[64:79], v[92:95], v[8:11], v[16:31]
    ds_read_b128 v[88:91], v5 offset:6144
    s_mov_b64 exec, s[56:57]
    ds_read_b128 v[100:103], v119 offset:5120
    ds_read_b128 v[104:107], v119 offset:4608
    s_mov_b64 exec, -1
    v_exp_f32 v54, v54
    v_exp_f32 v55, v55
    v_exp_f32 v56, v56
    v_exp_f32 v57, v57
    v_smfmac_f32_32x32x32_bf16 v[32:47], v[96:99], v[48:55], v112
    v_exp_f32 v58, v58
    v_exp_f32 v59, v59
    v_exp_f32 v60, v60
    v_exp_f32 v61, v61
    v_exp_f32 v62, v62
    v_exp_f32 v63, v63
    v_exp_f32 v64, v64
    v_exp_f32 v65, v65
    s_waitcnt lgkmcnt(0)
    v_smfmac_f32_32x32x32_bf16 v[32:47], v[104:107], v[56:63], v112
    v_exp_f32 v66, v66
    v_exp_f32 v67, v67
    v_exp_f32 v68, v68
    v_exp_f32 v69, v69
    v_mfma_f32_32x32x16_bf16 v[48:63], v[88:91], v[8:11], v[16:31]
    ds_read_b128 v[92:95], v5 offset:7168
    s_mov_b64 exec, s[56:57]
    ds_read_b128 v[96:99], v119 offset:6144
    ds_read_b128 v[104:107], v119 offset:5632
    s_mov_b64 exec, -1
    v_exp_f32 v70, v70
    v_exp_f32 v71, v71
    v_exp_f32 v72, v72
    v_exp_f32 v73, v73
    v_smfmac_f32_32x32x32_bf16 v[32:47], v[100:103], v[64:71], v112
    v_exp_f32 v74, v74
    v_exp_f32 v75, v75
    v_exp_f32 v76, v76
    v_exp_f32 v77, v77
    v_exp_f32 v78, v78
    v_exp_f32 v79, v79
    s_setprio 1
    v_exp_f32 v48, v48
    v_exp_f32 v49, v49
    s_waitcnt lgkmcnt(0)
    v_smfmac_f32_32x32x32_bf16 v[32:47], v[104:107], v[72:79], v112
    v_exp_f32 v50, v50
    v_exp_f32 v51, v51
    v_exp_f32 v52, v52
    v_exp_f32 v53, v53
    v_mfma_f32_32x32x16_bf16 v[64:79], v[92:95], v[8:11], v[16:31]
    ds_read_b128 v[88:91], v5 offset:8192
    s_mov_b64 exec, s[56:57]
    ds_read_b128 v[100:103], v119 offset:7168
    ds_read_b128 v[104:107], v119 offset:6656
    s_mov_b64 exec, -1
    v_exp_f32 v54, v54
    v_exp_f32 v55, v55
    v_exp_f32 v56, v56
    v_exp_f32 v57, v57
    v_smfmac_f32_32x32x32_bf16 v[32:47], v[96:99], v[48:55], v112
    v_exp_f32 v58, v58
    v_exp_f32 v59, v59
    v_exp_f32 v60, v60
    v_exp_f32 v61, v61
    v_exp_f32 v62, v62
    v_exp_f32 v63, v63
    v_exp_f32 v64, v64
    v_exp_f32 v65, v65
    s_waitcnt lgkmcnt(0)
    v_smfmac_f32_32x32x32_bf16 v[32:47], v[104:107], v[56:63], v112
    v_exp_f32 v66, v66
    v_exp_f32 v67, v67
    v_exp_f32 v68, v68
    v_exp_f32 v69, v69
    v_mfma_f32_32x32x16_bf16 v[48:63], v[88:91], v[8:11], v[16:31]
    ds_read_b128 v[92:95], v5 offset:9216
    s_mov_b64 exec, s[56:57]
    ds_read_b128 v[96:99], v119 offset:8192
    ds_read_b128 v[104:107], v119 offset:7680
    s_mov_b64 exec, -1
    v_exp_f32 v70, v70
    v_exp_f32 v71, v71
    v_exp_f32 v72, v72
    v_exp_f32 v73, v73
    v_smfmac_f32_32x32x32_bf16 v[32:47], v[100:103], v[64:71], v112
    v_exp_f32 v74, v74
    v_exp_f32 v75, v75
    v_exp_f32 v76, v76
    v_exp_f32 v77, v77
    v_exp_f32 v78, v78
    v_exp_f32 v79, v79
    s_cmp_lg_u32 s20, 0
    s_cbranch_scc1 att_cok
    s_and_b32 s34, s2, 31
    s_lshl_b32 s34, s34, 8
    s_add_u32 s34, s34, 4096
    s_add_u32 s34, s34, s50
    s_mov_b32 s35, 0
    v_and_b32 v12, 15, v1
    v_lshlrev_b32 v12, 2, v12
gw23_poll:
    buffer_load_dword v13, v12, s[8:11], s34 offen sc1
    s_waitcnt vmcnt(0)
    v_cmp_ne_u32 vcc, 1, v13
    s_add_u32 s35, s35, 1
    s_cmp_gt_u32 s35, 262144
    s_cbranch_scc1 gw23_ok
    s_nop 1
    s_cbranch_vccz gw23_ok
    s_sleep 2
    s_branch gw23_poll
gw23_ok:
att_cok:
    s_barrier
    s_setprio 3
    v_exp_f32 v48, v48
    v_exp_f32 v49, v49
    s_waitcnt lgkmcnt(0)
    v_smfmac_f32_32x32x32_bf16 v[32:47], v[104:107], v[72:79], v112
    s_add_u32 m0, s40, 16384
    s_add_u32 s22, s41, 16384
    buffer_load_dwordx4 v118, s[8:11], s22 offen lds
    v_exp_f32 v50, v50
    v_exp_f32 v51, v51
    v_exp_f32 v52, v52
    v_exp_f32 v53, v53
    v_mfma_f32_32x32x16_bf16 v[64:79], v[92:95], v[8:11], v[16:31]
    ds_read_b128 v[88:91], v5 offset:10240
    s_mov_b64 exec, s[56:57]
    ds_read_b128 v[100:103], v119 offset:9216
    ds_read_b128 v[104:107], v119 offset:8704
    s_mov_b64 exec, -1
    s_add_u32 m0, s47, 16384
    s_add_u32 s22, s42, 16384
    buffer_load_dwordx4 v118, s[8:11], s22 offen lds
    v_exp_f32 v54, v54
    v_exp_f32 v55, v55
    v_exp_f32 v56, v56
    v_exp_f32 v57, v57
    v_smfmac_f32_32x32x32_bf16 v[32:47], v[96:99], v[48:55], v112
    v_exp_f32 v58, v58
    v_exp_f32 v59, v59
    v_exp_f32 v60, v60
    v_exp_f32 v61, v61
    s_add_u32 m0, s40, 24576
    s_add_u32 s22, s41, 24576
    buffer_load_dwordx4 v118, s[8:11], s22 offen lds
    v_exp_f32 v62, v62
    v_exp_f32 v63, v63
    v_exp_f32 v64, v64
    v_exp_f32 v65, v65
    s_waitcnt lgkmcnt(0)
    v_smfmac_f32_32x32x32_bf16 v[32:47], v[104:107], v[56:63], v112
    s_add_u32 m0, s47, 24576
    s_add_u32 s22, s42, 24576
    buffer_load_dwordx4 v118, s[8:11], s22 offen lds
    v_exp_f32 v66, v66
    v_exp_f32 v67, v67
    v_exp_f32 v68, v68
    v_exp_f32 v69, v69
    v_mfma_f32_32x32x16_bf16 v[48:63], v[88:91], v[8:11], v[16:31]
    ds_read_b128 v[92:95], v5 offset:11264
    s_mov_b64 exec, s[56:57]
    ds_read_b128 v[96:99], v119 offset:10240
    ds_read_b128 v[104:107], v119 offset:9728
    s_mov_b64 exec, -1
    s_add_u32 m0, s40, 32768
    s_add_u32 s22, s41, 32768
    buffer_load_dwordx4 v118, s[8:11], s22 offen lds
    v_exp_f32 v70, v70
    v_exp_f32 v71, v71
    v_exp_f32 v72, v72
    v_exp_f32 v73, v73
    v_smfmac_f32_32x32x32_bf16 v[32:47], v[100:103], v[64:71], v112
    v_exp_f32 v74, v74
    v_exp_f32 v75, v75
    v_exp_f32 v76, v76
    v_exp_f32 v77, v77
    s_add_u32 m0, s47, 32768
    s_add_u32 s22, s42, 32768
    buffer_load_dwordx4 v118, s[8:11], s22 offen lds
    v_exp_f32 v78, v78
    v_exp_f32 v79, v79
    s_setprio 2
    v_exp_f32 v48, v48
    v_exp_f32 v49, v49
    s_waitcnt lgkmcnt(0)
    v_smfmac_f32_32x32x32_bf16 v[32:47], v[104:107], v[72:79], v112
    s_add_u32 m0, s40, 40960
    s_add_u32 s22, s41, 40960
    buffer_load_dwordx4 v118, s[8:11], s22 offen lds
    v_exp_f32 v50, v50
    v_exp_f32 v51, v51
    v_exp_f32 v52, v52
    v_exp_f32 v53, v53
    v_mfma_f32_32x32x16_bf16 v[64:79], v[92:95], v[8:11], v[16:31]
    ds_read_b128 v[88:91], v5 offset:12288
    s_mov_b64 exec, s[56:57]
    ds_read_b128 v[100:103], v119 offset:11264
    ds_read_b128 v[104:107], v119 offset:10752
    s_mov_b64 exec, -1
    s_add_u32 m0, s47, 40960
    s_add_u32 s22, s42, 40960
    buffer_load_dwordx4 v118, s[8:11], s22 offen lds
    v_exp_f32 v54, v54
    v_exp_f32 v55, v55
    v_exp_f32 v56, v56
    v_exp_f32 v57, v57
    v_smfmac_f32_32x32x32_bf16 v[32:47], v[96:99], v[48:55], v112
    v_exp_f32 v58, v58
    v_exp_f32 v59, v59
    v_exp_f32 v60, v60
    v_exp_f32 v61, v61
    s_add_u32 m0, s40, 49152
    s_add_u32 s22, s41, 49152
    buffer_load_dwordx4 v118, s[8:11], s22 offen lds
    v_exp_f32 v62, v62
    v_exp_f32 v63, v63
    v_exp_f32 v64, v64
    v_exp_f32 v65, v65
    s_waitcnt lgkmcnt(0)
    v_smfmac_f32_32x32x32_bf16 v[32:47], v[104:107], v[56:63], v112
    s_add_u32 m0, s47, 49152
    s_add_u32 s22, s42, 49152
    buffer_load_dwordx4 v118, s[8:11], s22 offen lds
    v_exp_f32 v66, v66
    v_exp_f32 v67, v67
    v_exp_f32 v68, v68
    v_exp_f32 v69, v69
    v_mfma_f32_32x32x16_bf16 v[48:63], v[88:91], v[8:11], v[16:31]
    ds_read_b128 v[92:95], v5 offset:13312
    s_mov_b64 exec, s[56:57]
    ds_read_b128 v[96:99], v119 offset:12288
    ds_read_b128 v[104:107], v119 offset:11776
    s_mov_b64 exec, -1
    s_add_u32 m0, s40, 57344
    s_add_u32 s22, s41, 57344
    buffer_load_dwordx4 v118, s[8:11], s22 offen lds
    v_exp_f32 v70, v70
    v_exp_f32 v71, v71
    v_exp_f32 v72, v72
    v_exp_f32 v73, v73
    v_smfmac_f32_32x32x32_bf16 v[32:47], v[100:103], v[64:71], v112
    v_exp_f32 v74, v74
    v_exp_f32 v75, v75
    v_exp_f32 v76, v76
    v_exp_f32 v77, v77
    s_add_u32 m0, s47, 57344
    s_add_u32 s22, s42, 57344
    buffer_load_dwordx4 v118, s[8:11], s22 offen lds
    v_exp_f32 v78, v78
    v_exp_f32 v79, v79
    s_setprio 1
    v_exp_f32 v48, v48
    v_exp_f32 v49, v49
    s_waitcnt lgkmcnt(0)
    v_smfmac_f32_32x32x32_bf16 v[32:47], v[104:107], v[72:79], v112
    v_exp_f32 v50, v50
    v_exp_f32 v51, v51
    v_exp_f32 v52, v52
    v_exp_f32 v53, v53
    v_mfma_f32_32x32x16_bf16 v[64:79], v[92:95], v[8:11], v[16:31]
    ds_read_b128 v[88:91], v5 offset:14336
    s_mov_b64 exec, s[56:57]
    ds_read_b128 v[100:103], v119 offset:13312
    ds_read_b128 v[104:107], v119 offset:12800
    s_mov_b64 exec, -1
    v_exp_f32 v54, v54
    v_exp_f32 v55, v55
    v_exp_f32 v56, v56
    v_exp_f32 v57, v57
    v_smfmac_f32_32x32x32_bf16 v[32:47], v[96:99], v[48:55], v112
    v_exp_f32 v58, v58
    v_exp_f32 v59, v59
    v_exp_f32 v60, v60
    v_exp_f32 v61, v61
    v_exp_f32 v62, v62
    v_exp_f32 v63, v63
    v_exp_f32 v64, v64
    v_exp_f32 v65, v65
    s_waitcnt lgkmcnt(0)
    v_smfmac_f32_32x32x32_bf16 v[32:47], v[104:107], v[56:63], v112
    v_exp_f32 v66, v66
    v_exp_f32 v67, v67
    v_exp_f32 v68, v68
    v_exp_f32 v69, v69
    v_mfma_f32_32x32x16_bf16 v[48:63], v[88:91], v[8:11], v[16:31]
    ds_read_b128 v[92:95], v5 offset:15360
    s_mov_b64 exec, s[56:57]
    ds_read_b128 v[96:99], v119 offset:14336
    ds_read_b128 v[104:107], v119 offset:13824
    s_mov_b64 exec, -1
    v_exp_f32 v70, v70
    v_exp_f32 v71, v71
    v_exp_f32 v72, v72
    v_exp_f32 v73, v73
    v_smfmac_f32_32x32x32_bf16 v[32:47], v[100:103], v[64:71], v112
    v_exp_f32 v74, v74
    v_exp_f32 v75, v75
    v_exp_f32 v76, v76
    v_exp_f32 v77, v77
    v_exp_f32 v78, v78
    v_exp_f32 v79, v79
    s_waitcnt vmcnt(10)
    s_barrier
    s_cmp_eq_u32 s21, 0
    s_cbranch_scc1 att_mid1
    s_add_u32 s24, s43, 10485760
    s_lshl_b32 s22, s20, 12
    s_setprio 3
    v_exp_f32 v48, v48
    v_exp_f32 v49, v49
    s_waitcnt lgkmcnt(0)
    v_smfmac_f32_32x32x32_bf16 v[32:47], v[104:107], v[72:79], v112
    buffer_load_dwordx4 v[128:131], v3, s[8:11], s53 offen offset:0
    v_exp_f32 v50, v50
    v_exp_f32 v51, v51
    v_exp_f32 v52, v52
    v_exp_f32 v53, v53
    v_mfma_f32_32x32x16_bf16 v[64:79], v[92:95], v[8:11], v[16:31]
    ds_read_b128 v[88:91], v5 offset:16384
    s_mov_b64 exec, s[56:57]
    ds_read_b128 v[100:103], v119 offset:15360
    ds_read_b128 v[104:107], v119 offset:14848
    s_mov_b64 exec, -1
    buffer_load_dwordx4 v[132:135], v3, s[8:11], s53 offen offset:512
    v_exp_f32 v54, v54
    v_exp_f32 v55, v55
    v_exp_f32 v56, v56
    v_exp_f32 v57, v57
    v_smfmac_f32_32x32x32_bf16 v[32:47], v[96:99], v[48:55], v112
    v_exp_f32 v58, v58
    v_exp_f32 v59, v59
    v_exp_f32 v60, v60
    v_exp_f32 v61, v61
    v_exp_f32 v62, v62
    v_exp_f32 v63, v63
    v_exp_f32 v64, v64
    v_exp_f32 v65, v65
    s_waitcnt lgkmcnt(0)
    v_smfmac_f32_32x32x32_bf16 v[32:47], v[104:107], v[56:63], v112
    buffer_load_dwordx4 v[136:139], v3, s[8:11], s53 offen offset:2048
    v_exp_f32 v66, v66
    v_exp_f32 v67, v67
    v_exp_f32 v68, v68
    v_exp_f32 v69, v69
    v_mfma_f32_32x32x16_bf16 v[48:63], v[88:91], v[8:11], v[16:31]
    ds_read_b128 v[92:95], v5 offset:17408
    s_mov_b64 exec, s[56:57]
    ds_read_b128 v[96:99], v119 offset:16384
    ds_read_b128 v[104:107], v119 offset:15872
    s_mov_b64 exec, -1
    buffer_load_dwordx4 v[140:143], v3, s[8:11], s53 offen offset:2560
    s_add_u32 s53, s53, 4096
    v_exp_f32 v70, v70
    v_exp_f32 v71, v71
    v_exp_f32 v72, v72
    v_exp_f32 v73, v73
    v_smfmac_f32_32x32x32_bf16 v[32:47], v[100:103], v[64:71], v112
    v_exp_f32 v74, v74
    v_exp_f32 v75, v75
    v_exp_f32 v76, v76
    v_exp_f32 v77, v77
    v_exp_f32 v78, v78
    v_exp_f32 v79, v79
    s_setprio 2
    v_exp_f32 v48, v48
    v_exp_f32 v49, v49
    s_waitcnt lgkmcnt(0)
    v_smfmac_f32_32x32x32_bf16 v[32:47], v[104:107], v[72:79], v112
    buffer_load_dwordx4 v[144:147], v3, s[8:11], s53 offen offset:0
    v_exp_f32 v50, v50
    v_exp_f32 v51, v51
    v_exp_f32 v52, v52
    v_exp_f32 v53, v53
    v_mfma_f32_32x32x16_bf16 v[64:79], v[92:95], v[8:11], v[16:31]
    ds_read_b128 v[88:91], v5 offset:18432
    s_mov_b64 exec, s[56:57]
    ds_read_b128 v[100:103], v119 offset:17408
    ds_read_b128 v[104:107], v119 offset:16896
    s_mov_b64 exec, -1
    buffer_load_dwordx4 v[148:151], v3, s[8:11], s53 offen offset:512
    v_exp_f32 v54, v54
    v_exp_f32 v55, v55
    v_exp_f32 v56, v56
    v_exp_f32 v57, v57
    v_smfmac_f32_32x32x32_bf16 v[32:47], v[96:99], v[48:55], v112
    v_exp_f32 v58, v58
    v_exp_f32 v59, v59
    v_exp_f32 v60, v60
    v_exp_f32 v61, v61
    v_exp_f32 v62, v62
    v_exp_f32 v63, v63
    v_exp_f32 v64, v64
    v_exp_f32 v65, v65
    s_waitcnt lgkmcnt(0)
    v_smfmac_f32_32x32x32_bf16 v[32:47], v[104:107], v[56:63], v112
    buffer_load_dwordx4 v[152:155], v3, s[8:11], s53 offen offset:2048
    v_exp_f32 v66, v66
    v_exp_f32 v67, v67
    v_exp_f32 v68, v68
    v_exp_f32 v69, v69
    v_mfma_f32_32x32x16_bf16 v[48:63], v[88:91], v[8:11], v[16:31]
    ds_read_b128 v[92:95], v5 offset:19456
    s_mov_b64 exec, s[56:57]
    ds_read_b128 v[96:99], v119 offset:18432
    ds_read_b128 v[104:107], v119 offset:17920
    s_mov_b64 exec, -1
    buffer_load_dwordx4 v[156:159], v3, s[8:11], s53 offen offset:2560
    s_add_u32 s53, s53, 4096
    v_exp_f32 v70, v70
    v_exp_f32 v71, v71
    v_exp_f32 v72, v72
    v_exp_f32 v73, v73
    v_smfmac_f32_32x32x32_bf16 v[32:47], v[100:103], v[64:71], v112
    v_exp_f32 v74, v74
    v_exp_f32 v75, v75
    v_exp_f32 v76, v76
    v_exp_f32 v77, v77
    v_exp_f32 v78, v78
    v_exp_f32 v79, v79
    s_setprio 1
    v_exp_f32 v48, v48
    v_exp_f32 v49, v49
    s_waitcnt lgkmcnt(0)
    v_smfmac_f32_32x32x32_bf16 v[32:47], v[104:107], v[72:79], v112
    buffer_load_dwordx4 v[160:163], v3, s[8:11], s53 offen offset:0
    v_exp_f32 v50, v50
    v_exp_f32 v51, v51
    v_exp_f32 v52, v52
    v_exp_f32 v53, v53
    v_mfma_f32_32x32x16_bf16 v[64:79], v[92:95], v[8:11], v[16:31]
    ds_read_b128 v[88:91], v5 offset:20480
    s_mov_b64 exec, s[56:57]
    ds_read_b128 v[100:103], v119 offset:19456
    ds_read_b128 v[104:107], v119 offset:18944
    s_mov_b64 exec, -1
    buffer_load_dwordx4 v[164:167], v3, s[8:11], s53 offen offset:512
    v_exp_f32 v54, v54
    v_exp_f32 v55, v55
    v_exp_f32 v56, v56
    v_exp_f32 v57, v57
    v_smfmac_f32_32x32x32_bf16 v[32:47], v[96:99], v[48:55], v112
    v_exp_f32 v58, v58
    v_exp_f32 v59, v59
    v_exp_f32 v60, v60
    v_exp_f32 v61, v61
    v_exp_f32 v62, v62
    v_exp_f32 v63, v63
    v_exp_f32 v64, v64
    v_exp_f32 v65, v65
    s_waitcnt lgkmcnt(0)
    v_smfmac_f32_32x32x32_bf16 v[32:47], v[104:107], v[56:63], v112
    buffer_load_dwordx4 v[168:171], v3, s[8:11], s53 offen offset:2048
    v_exp_f32 v66, v66
    v_exp_f32 v67, v67
    v_exp_f32 v68, v68
    v_exp_f32 v69, v69
    v_mfma_f32_32x32x16_bf16 v[48:63], v[88:91], v[8:11], v[16:31]
    ds_read_b128 v[92:95], v5 offset:21504
    s_mov_b64 exec, s[56:57]
    ds_read_b128 v[96:99], v119 offset:20480
    ds_read_b128 v[104:107], v119 offset:19968
    s_mov_b64 exec, -1
    buffer_load_dwordx4 v[172:175], v3, s[8:11], s53 offen offset:2560
    s_add_u32 s53, s53, 4096
    v_exp_f32 v70, v70
    v_exp_f32 v71, v71
    v_exp_f32 v72, v72
    v_exp_f32 v73, v73
    v_smfmac_f32_32x32x32_bf16 v[32:47], v[100:103], v[64:71], v112
    v_exp_f32 v74, v74
    v_exp_f32 v75, v75
    v_exp_f32 v76, v76
    v_exp_f32 v77, v77
    v_exp_f32 v78, v78
    v_exp_f32 v79, v79
    s_setprio 0
    v_exp_f32 v48, v48
    v_exp_f32 v49, v49
    s_waitcnt lgkmcnt(0)
    v_smfmac_f32_32x32x32_bf16 v[32:47], v[104:107], v[72:79], v112
    buffer_load_dwordx4 v[176:179], v3, s[8:11], s53 offen offset:0
    v_exp_f32 v50, v50
    v_exp_f32 v51, v51
    v_exp_f32 v52, v52
    v_exp_f32 v53, v53
    v_mfma_f32_32x32x16_bf16 v[64:79], v[92:95], v[8:11], v[16:31]
    ds_read_b128 v[88:91], v5 offset:22528
    s_mov_b64 exec, s[56:57]
    ds_read_b128 v[100:103], v119 offset:21504
    ds_read_b128 v[104:107], v119 offset:20992
    s_mov_b64 exec, -1
    buffer_load_dwordx4 v[180:183], v3, s[8:11], s53 offen offset:512
    v_exp_f32 v54, v54
    v_exp_f32 v55, v55
    v_exp_f32 v56, v56
    v_exp_f32 v57, v57
    v_smfmac_f32_32x32x32_bf16 v[32:47], v[96:99], v[48:55], v112
    v_exp_f32 v58, v58
    v_exp_f32 v59, v59
    v_exp_f32 v60, v60
    v_exp_f32 v61, v61
    v_exp_f32 v62, v62
    v_exp_f32 v63, v63
    v_exp_f32 v64, v64
    v_exp_f32 v65, v65
    s_waitcnt lgkmcnt(0)
    v_smfmac_f32_32x32x32_bf16 v[32:47], v[104:107], v[56:63], v112
    buffer_load_dwordx4 v[184:187], v3, s[8:11], s53 offen offset:2048
    v_exp_f32 v66, v66
    v_exp_f32 v67, v67
    v_exp_f32 v68, v68
    v_exp_f32 v69, v69
    v_mfma_f32_32x32x16_bf16 v[48:63], v[88:91], v[8:11], v[16:31]
    ds_read_b128 v[92:95], v5 offset:23552
    s_mov_b64 exec, s[56:57]
    ds_read_b128 v[96:99], v119 offset:22528
    ds_read_b128 v[104:107], v119 offset:22016
    s_mov_b64 exec, -1
    buffer_load_dwordx4 v[188:191], v3, s[8:11], s53 offen offset:2560
    s_add_u32 s53, s53, 4096
    v_exp_f32 v70, v70
    v_exp_f32 v71, v71
    v_exp_f32 v72, v72
    v_exp_f32 v73, v73
    v_smfmac_f32_32x32x32_bf16 v[32:47], v[100:103], v[64:71], v112
    v_exp_f32 v74, v74
    v_exp_f32 v75, v75
    v_exp_f32 v76, v76
    v_exp_f32 v77, v77
    v_exp_f32 v78, v78
    v_exp_f32 v79, v79
    s_waitcnt vmcnt(16)
    s_barrier
    s_setprio 3
    v_exp_f32 v48, v48
    v_exp_f32 v49, v49
    s_waitcnt lgkmcnt(0)
    v_smfmac_f32_32x32x32_bf16 v[32:47], v[104:107], v[72:79], v112
    buffer_load_dwordx4 v[192:195], v3, s[8:11], s54 offen offset:0
    v_exp_f32 v50, v50
    v_exp_f32 v51, v51
    v_exp_f32 v52, v52
    v_exp_f32 v53, v53
    v_mfma_f32_32x32x16_bf16 v[64:79], v[92:95], v[8:11], v[16:31]
    ds_read_b128 v[88:91], v5 offset:24576
    s_mov_b64 exec, s[56:57]
    ds_read_b128 v[100:103], v119 offset:23552
    ds_read_b128 v[104:107], v119 offset:23040
    s_mov_b64 exec, -1
    buffer_load_dwordx4 v[196:199], v3, s[8:11], s54 offen offset:512
    v_exp_f32 v54, v54
    v_exp_f32 v55, v55
    v_exp_f32 v56, v56
    v_exp_f32 v57, v57
    v_smfmac_f32_32x32x32_bf16 v[32:47], v[96:99], v[48:55], v112
    v_exp_f32 v58, v58
    v_exp_f32 v59, v59
    v_exp_f32 v60, v60
    v_exp_f32 v61, v61
    v_exp_f32 v62, v62
    v_exp_f32 v63, v63
    v_exp_f32 v64, v64
    v_exp_f32 v65, v65
    s_waitcnt lgkmcnt(0)
    v_smfmac_f32_32x32x32_bf16 v[32:47], v[104:107], v[56:63], v112
    buffer_load_dwordx4 v[200:203], v3, s[8:11], s54 offen offset:2048
    v_exp_f32 v66, v66
    v_exp_f32 v67, v67
    v_exp_f32 v68, v68
    v_exp_f32 v69, v69
    v_mfma_f32_32x32x16_bf16 v[48:63], v[88:91], v[8:11], v[16:31]
    ds_read_b128 v[92:95], v5 offset:25600
    s_mov_b64 exec, s[56:57]
    ds_read_b128 v[96:99], v119 offset:24576
    ds_read_b128 v[104:107], v119 offset:24064
    s_mov_b64 exec, -1
    buffer_load_dwordx4 v[204:207], v3, s[8:11], s54 offen offset:2560
    s_add_u32 s54, s54, 4096
    v_exp_f32 v70, v70
    v_exp_f32 v71, v71
    v_exp_f32 v72, v72
    v_exp_f32 v73, v73
    v_smfmac_f32_32x32x32_bf16 v[32:47], v[100:103], v[64:71], v112
    v_exp_f32 v74, v74
    v_exp_f32 v75, v75
    v_exp_f32 v76, v76
    v_exp_f32 v77, v77
    v_exp_f32 v78, v78
    v_exp_f32 v79, v79
    v_exp_f32 v48, v48
    v_exp_f32 v49, v49
    s_waitcnt lgkmcnt(0)
    v_smfmac_f32_32x32x32_bf16 v[32:47], v[104:107], v[72:79], v112
    buffer_load_dwordx4 v[208:211], v3, s[8:11], s54 offen offset:0
    v_exp_f32 v50, v50
    v_exp_f32 v51, v51
    v_exp_f32 v52, v52
    v_exp_f32 v53, v53
    v_mfma_f32_32x32x16_bf16 v[64:79], v[92:95], v[8:11], v[16:31]
    ds_read_b128 v[88:91], v5 offset:26624
    s_mov_b64 exec, s[56:57]
    ds_read_b128 v[100:103], v119 offset:25600
    ds_read_b128 v[104:107], v119 offset:25088
    s_mov_b64 exec, -1
    buffer_load_dwordx4 v[212:215], v3, s[8:11], s54 offen offset:512
    v_exp_f32 v54, v54
    v_exp_f32 v55, v55
    v_exp_f32 v56, v56
    v_exp_f32 v57, v57
    v_smfmac_f32_32x32x32_bf16 v[32:47], v[96:99], v[48:55], v112
    v_exp_f32 v58, v58
    v_exp_f32 v59, v59
    v_exp_f32 v60, v60
    v_exp_f32 v61, v61
    v_exp_f32 v62, v62
    v_exp_f32 v63, v63
    v_exp_f32 v64, v64
    v_exp_f32 v65, v65
    s_waitcnt lgkmcnt(0)
    v_smfmac_f32_32x32x32_bf16 v[32:47], v[104:107], v[56:63], v112
    buffer_load_dwordx4 v[216:219], v3, s[8:11], s54 offen offset:2048
    v_exp_f32 v66, v66
    v_exp_f32 v67, v67
    v_exp_f32 v68, v68
    v_exp_f32 v69, v69
    v_mfma_f32_32x32x16_bf16 v[48:63], v[88:91], v[8:11], v[16:31]
    ds_read_b128 v[92:95], v5 offset:27648
    s_mov_b64 exec, s[56:57]
    ds_read_b128 v[96:99], v119 offset:26624
    ds_read_b128 v[104:107], v119 offset:26112
    s_mov_b64 exec, -1
    buffer_load_dwordx4 v[220:223], v3, s[8:11], s54 offen offset:2560
    s_add_u32 s54, s54, 4096
    v_exp_f32 v70, v70
    v_exp_f32 v71, v71
    v_exp_f32 v72, v72
    v_exp_f32 v73, v73
    v_smfmac_f32_32x32x32_bf16 v[32:47], v[100:103], v[64:71], v112
    v_exp_f32 v74, v74
    v_exp_f32 v75, v75
    v_exp_f32 v76, v76
    v_exp_f32 v77, v77
    v_exp_f32 v78, v78
    v_exp_f32 v79, v79
    v_exp_f32 v48, v48
    v_exp_f32 v49, v49
    s_waitcnt lgkmcnt(0)
    v_smfmac_f32_32x32x32_bf16 v[32:47], v[104:107], v[72:79], v112
    buffer_load_dwordx4 v[224:227], v3, s[8:11], s54 offen offset:0
    v_exp_f32 v50, v50
    v_exp_f32 v51, v51
    v_exp_f32 v52, v52
    v_exp_f32 v53, v53
    v_mfma_f32_32x32x16_bf16 v[64:79], v[92:95], v[8:11], v[16:31]
    ds_read_b128 v[88:91], v5 offset:28672
    s_mov_b64 exec, s[56:57]
    ds_read_b128 v[100:103], v119 offset:27648
    ds_read_b128 v[104:107], v119 offset:27136
    s_mov_b64 exec, -1
    buffer_load_dwordx4 v[228:231], v3, s[8:11], s54 offen offset:512
    v_exp_f32 v54, v54
    v_exp_f32 v55, v55
    v_exp_f32 v56, v56
    v_exp_f32 v57, v57
    v_smfmac_f32_32x32x32_bf16 v[32:47], v[96:99], v[48:55], v112
    v_exp_f32 v58, v58
    v_exp_f32 v59, v59
    v_exp_f32 v60, v60
    v_exp_f32 v61, v61
    v_exp_f32 v62, v62
    v_exp_f32 v63, v63
    v_exp_f32 v64, v64
    v_exp_f32 v65, v65
    s_waitcnt lgkmcnt(0)
    v_smfmac_f32_32x32x32_bf16 v[32:47], v[104:107], v[56:63], v112
    buffer_load_dwordx4 v[232:235], v3, s[8:11], s54 offen offset:2048
    v_exp_f32 v66, v66
    v_exp_f32 v67, v67
    v_exp_f32 v68, v68
    v_exp_f32 v69, v69
    v_mfma_f32_32x32x16_bf16 v[48:63], v[88:91], v[8:11], v[16:31]
    ds_read_b128 v[92:95], v5 offset:29696
    s_mov_b64 exec, s[56:57]
    ds_read_b128 v[96:99], v119 offset:28672
    ds_read_b128 v[104:107], v119 offset:28160
    s_mov_b64 exec, -1
    buffer_load_dwordx4 v[236:239], v3, s[8:11], s54 offen offset:2560
    s_add_u32 s54, s54, 4096
    v_exp_f32 v70, v70
    v_exp_f32 v71, v71
    v_exp_f32 v72, v72
    v_exp_f32 v73, v73
    v_smfmac_f32_32x32x32_bf16 v[32:47], v[100:103], v[64:71], v112
    v_exp_f32 v74, v74
    v_exp_f32 v75, v75
    v_exp_f32 v76, v76
    v_exp_f32 v77, v77
    v_exp_f32 v78, v78
    v_exp_f32 v79, v79
    v_exp_f32 v48, v48
    v_exp_f32 v49, v49
    s_waitcnt lgkmcnt(0)
    v_smfmac_f32_32x32x32_bf16 v[32:47], v[104:107], v[72:79], v112
    buffer_load_dwordx4 v[240:243], v3, s[8:11], s54 offen offset:0
    v_exp_f32 v50, v50
    v_exp_f32 v51, v51
    v_exp_f32 v52, v52
    v_exp_f32 v53, v53
    v_mfma_f32_32x32x16_bf16 v[64:79], v[92:95], v[8:11], v[16:31]
    ds_read_b128 v[88:91], v5 offset:30720
    s_mov_b64 exec, s[56:57]
    ds_read_b128 v[100:103], v119 offset:29696
    ds_read_b128 v[104:107], v119 offset:29184
    s_mov_b64 exec, -1
    buffer_load_dwordx4 v[244:247], v3, s[8:11], s54 offen offset:512
    v_exp_f32 v54, v54
    v_exp_f32 v55, v55
    v_exp_f32 v56, v56
    v_exp_f32 v57, v57
    v_smfmac_f32_32x32x32_bf16 v[32:47], v[96:99], v[48:55], v112
    v_exp_f32 v58, v58
    v_exp_f32 v59, v59
    v_exp_f32 v60, v60
    v_exp_f32 v61, v61
    v_exp_f32 v62, v62
    v_exp_f32 v63, v63
    v_exp_f32 v64, v64
    v_exp_f32 v65, v65
    s_waitcnt lgkmcnt(0)
    v_smfmac_f32_32x32x32_bf16 v[32:47], v[104:107], v[56:63], v112
    buffer_load_dwordx4 v[248:251], v3, s[8:11], s54 offen offset:2048
    v_exp_f32 v66, v66
    v_exp_f32 v67, v67
    v_exp_f32 v68, v68
    v_exp_f32 v69, v69
    v_mfma_f32_32x32x16_bf16 v[48:63], v[88:91], v[8:11], v[16:31]
    ds_read_b128 v[92:95], v5 offset:31744
    s_mov_b64 exec, s[56:57]
    ds_read_b128 v[96:99], v119 offset:30720
    ds_read_b128 v[104:107], v119 offset:30208
    s_mov_b64 exec, -1
    buffer_load_dwordx4 v[252:255], v3, s[8:11], s54 offen offset:2560
    s_add_u32 s54, s54, 4096
    v_exp_f32 v70, v70
    v_exp_f32 v71, v71
    v_exp_f32 v72, v72
    v_exp_f32 v73, v73
    v_smfmac_f32_32x32x32_bf16 v[32:47], v[100:103], v[64:71], v112
    v_exp_f32 v74, v74
    v_exp_f32 v75, v75
    v_exp_f32 v76, v76
    v_exp_f32 v77, v77
    v_exp_f32 v78, v78
    v_exp_f32 v79, v79
    v_exp_f32 v48, v48
    v_exp_f32 v49, v49
    s_waitcnt lgkmcnt(0)
    v_smfmac_f32_32x32x32_bf16 v[32:47], v[104:107], v[72:79], v112
    s_add_u32 m0, s22, 131072
    s_add_u32 s23, s55, 0
    buffer_load_dwordx4 v2, s[8:11], s23 offen sc1 lds
    v_exp_f32 v50, v50
    v_exp_f32 v51, v51
    v_exp_f32 v52, v52
    v_exp_f32 v53, v53
    v_mfma_f32_32x32x16_bf16 v[64:79], v[92:95], v[8:11], v[16:31]
    ds_read_b128 v[88:91], v5 offset:32768
    s_mov_b64 exec, s[56:57]
    ds_read_b128 v[100:103], v119 offset:31744
    ds_read_b128 v[104:107], v119 offset:31232
    s_mov_b64 exec, -1
    s_add_u32 m0, s22, 132096
    s_add_u32 s23, s55, 67584
    buffer_load_dwordx4 v2, s[8:11], s23 offen sc1 lds
    v_exp_f32 v54, v54
    v_exp_f32 v55, v55
    v_exp_f32 v56, v56
    v_exp_f32 v57, v57
    v_smfmac_f32_32x32x32_bf16 v[32:47], v[96:99], v[48:55], v112
    v_exp_f32 v58, v58
    v_exp_f32 v59, v59
    v_exp_f32 v60, v60
    v_exp_f32 v61, v61
    v_exp_f32 v62, v62
    v_exp_f32 v63, v63
    v_exp_f32 v64, v64
    v_exp_f32 v65, v65
    s_waitcnt lgkmcnt(0)
    v_smfmac_f32_32x32x32_bf16 v[32:47], v[104:107], v[56:63], v112
    s_add_u32 m0, s22, 133120
    s_add_u32 s23, s55, 135168
    buffer_load_dwordx4 v2, s[8:11], s23 offen sc1 lds
    v_exp_f32 v66, v66
    v_exp_f32 v67, v67
    v_exp_f32 v68, v68
    v_exp_f32 v69, v69
    v_mfma_f32_32x32x16_bf16 v[48:63], v[88:91], v[8:11], v[16:31]
    ds_read_b128 v[92:95], v5 offset:33792
    s_mov_b64 exec, s[56:57]
    ds_read_b128 v[96:99], v119 offset:32768
    ds_read_b128 v[104:107], v119 offset:32256
    s_mov_b64 exec, -1
    s_add_u32 m0, s22, 134144
    s_add_u32 s23, s55, 202752
    buffer_load_dwordx4 v2, s[8:11], s23 offen sc1 lds
    v_exp_f32 v70, v70
    v_exp_f32 v71, v71
    v_exp_f32 v72, v72
    v_exp_f32 v73, v73
    v_smfmac_f32_32x32x32_bf16 v[32:47], v[100:103], v[64:71], v112
    v_exp_f32 v74, v74
    v_exp_f32 v75, v75
    v_exp_f32 v76, v76
    v_exp_f32 v77, v77
    v_exp_f32 v78, v78
    v_exp_f32 v79, v79
    v_exp_f32 v48, v48
    v_exp_f32 v49, v49
    s_waitcnt lgkmcnt(0)
    v_smfmac_f32_32x32x32_bf16 v[32:47], v[104:107], v[72:79], v112
    buffer_load_dwordx4 v[114:117], v6, s[12:15], s60 offen
    v_exp_f32 v50, v50
    v_exp_f32 v51, v51
    v_exp_f32 v52, v52
    v_exp_f32 v53, v53
    v_mfma_f32_32x32x16_bf16 v[64:79], v[92:95], v[8:11], v[16:31]
    ds_read_b128 v[88:91], v5 offset:34816
    s_mov_b64 exec, s[56:57]
    ds_read_b128 v[100:103], v119 offset:33792
    ds_read_b128 v[104:107], v119 offset:33280
    s_mov_b64 exec, -1
    buffer_load_dwordx4 v[12:15], v7, s[8:11], s24 offen sc1
    v_exp_f32 v54, v54
    v_exp_f32 v55, v55
    v_exp_f32 v56, v56
    v_exp_f32 v57, v57
    v_smfmac_f32_32x32x32_bf16 v[32:47], v[96:99], v[48:55], v112
    v_exp_f32 v58, v58
    v_exp_f32 v59, v59
    v_exp_f32 v60, v60
    v_exp_f32 v61, v61
    v_exp_f32 v62, v62
    v_exp_f32 v63, v63
    s_setprio 2
    v_exp_f32 v64, v64
    v_exp_f32 v65, v65
    s_waitcnt lgkmcnt(0)
    v_smfmac_f32_32x32x32_bf16 v[32:47], v[104:107], v[56:63], v112
    v_exp_f32 v66, v66
    v_exp_f32 v67, v67
    v_exp_f32 v68, v68
    v_exp_f32 v69, v69
    v_mfma_f32_32x32x16_bf16 v[48:63], v[88:91], v[8:11], v[16:31]
    ds_read_b128 v[92:95], v5 offset:35840
    s_mov_b64 exec, s[56:57]
    ds_read_b128 v[96:99], v119 offset:34816
    ds_read_b128 v[104:107], v119 offset:34304
    s_mov_b64 exec, -1
    v_exp_f32 v70, v70
    v_exp_f32 v71, v71
    v_exp_f32 v72, v72
    v_exp_f32 v73, v73
    v_smfmac_f32_32x32x32_bf16 v[32:47], v[100:103], v[64:71], v112
    v_exp_f32 v74, v74
    v_exp_f32 v75, v75
    v_exp_f32 v76, v76
    v_exp_f32 v77, v77
    v_exp_f32 v78, v78
    v_exp_f32 v79, v79
    v_exp_f32 v48, v48
    v_exp_f32 v49, v49
    s_waitcnt lgkmcnt(0)
    v_smfmac_f32_32x32x32_bf16 v[32:47], v[104:107], v[72:79], v112
    v_exp_f32 v50, v50
    v_exp_f32 v51, v51
    v_exp_f32 v52, v52
    v_exp_f32 v53, v53
    v_mfma_f32_32x32x16_bf16 v[64:79], v[92:95], v[8:11], v[16:31]
    ds_read_b128 v[88:91], v5 offset:36864
    s_mov_b64 exec, s[56:57]
    ds_read_b128 v[100:103], v119 offset:35840
    ds_read_b128 v[104:107], v119 offset:35328
    s_mov_b64 exec, -1
    v_exp_f32 v54, v54
    v_exp_f32 v55, v55
    v_exp_f32 v56, v56
    v_exp_f32 v57, v57
    v_smfmac_f32_32x32x32_bf16 v[32:47], v[96:99], v[48:55], v112
    v_exp_f32 v58, v58
    v_exp_f32 v59, v59
    v_exp_f32 v60, v60
    v_exp_f32 v61, v61
    v_exp_f32 v62, v62
    v_exp_f32 v63, v63
    v_exp_f32 v64, v64
    v_exp_f32 v65, v65
    s_waitcnt lgkmcnt(0)
    v_smfmac_f32_32x32x32_bf16 v[32:47], v[104:107], v[56:63], v112
    v_exp_f32 v66, v66
    v_exp_f32 v67, v67
    v_exp_f32 v68, v68
    v_exp_f32 v69, v69
    v_mfma_f32_32x32x16_bf16 v[48:63], v[88:91], v[8:11], v[16:31]
    ds_read_b128 v[92:95], v5 offset:37888
    s_mov_b64 exec, s[56:57]
    ds_read_b128 v[96:99], v119 offset:36864
    ds_read_b128 v[104:107], v119 offset:36352
    s_mov_b64 exec, -1
    v_exp_f32 v70, v70
    v_exp_f32 v71, v71
    v_exp_f32 v72, v72
    v_exp_f32 v73, v73
    v_smfmac_f32_32x32x32_bf16 v[32:47], v[100:103], v[64:71], v112
    v_exp_f32 v74, v74
    v_exp_f32 v75, v75
    v_exp_f32 v76, v76
    v_exp_f32 v77, v77
    v_exp_f32 v78, v78
    v_exp_f32 v79, v79
    v_exp_f32 v48, v48
    v_exp_f32 v49, v49
    s_waitcnt lgkmcnt(0)
    v_smfmac_f32_32x32x32_bf16 v[32:47], v[104:107], v[72:79], v112
    v_exp_f32 v50, v50
    v_exp_f32 v51, v51
    v_exp_f32 v52, v52
    v_exp_f32 v53, v53
    v_mfma_f32_32x32x16_bf16 v[64:79], v[92:95], v[8:11], v[16:31]
    ds_read_b128 v[88:91], v5 offset:38912
    s_mov_b64 exec, s[56:57]
    ds_read_b128 v[100:103], v119 offset:37888
    ds_read_b128 v[104:107], v119 offset:37376
    s_mov_b64 exec, -1
    v_exp_f32 v54, v54
    v_exp_f32 v55, v55
    v_exp_f32 v56, v56
    v_exp_f32 v57, v57
    v_smfmac_f32_32x32x32_bf16 v[32:47], v[96:99], v[48:55], v112
    v_exp_f32 v58, v58
    v_exp_f32 v59, v59
    v_exp_f32 v60, v60
    v_exp_f32 v61, v61
    v_exp_f32 v62, v62
    v_exp_f32 v63, v63
    v_exp_f32 v64, v64
    v_exp_f32 v65, v65
    s_waitcnt lgkmcnt(0)
    v_smfmac_f32_32x32x32_bf16 v[32:47], v[104:107], v[56:63], v112
    v_exp_f32 v66, v66
    v_exp_f32 v67, v67
    v_exp_f32 v68, v68
    v_exp_f32 v69, v69
    v_mfma_f32_32x32x16_bf16 v[48:63], v[88:91], v[8:11], v[16:31]
    ds_read_b128 v[92:95], v5 offset:39936
    s_mov_b64 exec, s[56:57]
    ds_read_b128 v[96:99], v119 offset:38912
    ds_read_b128 v[104:107], v119 offset:38400
    s_mov_b64 exec, -1
    v_exp_f32 v70, v70
    v_exp_f32 v71, v71
    v_exp_f32 v72, v72
    v_exp_f32 v73, v73
    v_smfmac_f32_32x32x32_bf16 v[32:47], v[100:103], v[64:71], v112
    v_exp_f32 v74, v74
    v_exp_f32 v75, v75
    v_exp_f32 v76, v76
    v_exp_f32 v77, v77
    v_exp_f32 v78, v78
    v_exp_f32 v79, v79
    v_exp_f32 v48, v48
    v_exp_f32 v49, v49
    s_waitcnt lgkmcnt(0)
    v_smfmac_f32_32x32x32_bf16 v[32:47], v[104:107], v[72:79], v112
    v_exp_f32 v50, v50
    v_exp_f32 v51, v51
    v_exp_f32 v52, v52
    v_exp_f32 v53, v53
    v_mfma_f32_32x32x16_bf16 v[64:79], v[92:95], v[8:11], v[16:31]
    ds_read_b128 v[88:91], v5 offset:40960
    s_mov_b64 exec, s[56:57]
    ds_read_b128 v[100:103], v119 offset:39936
    ds_read_b128 v[104:107], v119 offset:39424
    s_mov_b64 exec, -1
    v_exp_f32 v54, v54
    v_exp_f32 v55, v55
    v_exp_f32 v56, v56
    v_exp_f32 v57, v57
    v_smfmac_f32_32x32x32_bf16 v[32:47], v[96:99], v[48:55], v112
    v_exp_f32 v58, v58
    v_exp_f32 v59, v59
    v_exp_f32 v60, v60
    v_exp_f32 v61, v61
    v_exp_f32 v62, v62
    v_exp_f32 v63, v63
    v_exp_f32 v64, v64
    v_exp_f32 v65, v65
    s_waitcnt lgkmcnt(0)
    v_smfmac_f32_32x32x32_bf16 v[32:47], v[104:107], v[56:63], v112
    v_exp_f32 v66, v66
    v_exp_f32 v67, v67
    v_exp_f32 v68, v68
    v_exp_f32 v69, v69
    v_mfma_f32_32x32x16_bf16 v[48:63], v[88:91], v[8:11], v[16:31]
    ds_read_b128 v[92:95], v5 offset:41984
    s_mov_b64 exec, s[56:57]
    ds_read_b128 v[96:99], v119 offset:40960
    ds_read_b128 v[104:107], v119 offset:40448
    s_mov_b64 exec, -1
    v_exp_f32 v70, v70
    v_exp_f32 v71, v71
    v_exp_f32 v72, v72
    v_exp_f32 v73, v73
    v_smfmac_f32_32x32x32_bf16 v[32:47], v[100:103], v[64:71], v112
    v_exp_f32 v74, v74
    v_exp_f32 v75, v75
    v_exp_f32 v76, v76
    v_exp_f32 v77, v77
    v_exp_f32 v78, v78
    v_exp_f32 v79, v79
    v_exp_f32 v48, v48
    v_exp_f32 v49, v49
    s_waitcnt lgkmcnt(0)
    v_smfmac_f32_32x32x32_bf16 v[32:47], v[104:107], v[72:79], v112
    v_exp_f32 v50, v50
    v_exp_f32 v51, v51
    v_exp_f32 v52, v52
    v_exp_f32 v53, v53
    v_mfma_f32_32x32x16_bf16 v[64:79], v[92:95], v[8:11], v[16:31]
    ds_read_b128 v[88:91], v5 offset:43008
    s_mov_b64 exec, s[56:57]
    ds_read_b128 v[100:103], v119 offset:41984
    ds_read_b128 v[104:107], v119 offset:41472
    s_mov_b64 exec, -1
    v_exp_f32 v54, v54
    v_exp_f32 v55, v55
    v_exp_f32 v56, v56
    v_exp_f32 v57, v57
    v_smfmac_f32_32x32x32_bf16 v[32:47], v[96:99], v[48:55], v112
    v_exp_f32 v58, v58
    v_exp_f32 v59, v59
    v_exp_f32 v60, v60
    v_exp_f32 v61, v61
    v_exp_f32 v62, v62
    v_exp_f32 v63, v63
    v_exp_f32 v64, v64
    v_exp_f32 v65, v65
    s_waitcnt lgkmcnt(0)
    v_smfmac_f32_32x32x32_bf16 v[32:47], v[104:107], v[56:63], v112
    v_exp_f32 v66, v66
    v_exp_f32 v67, v67
    v_exp_f32 v68, v68
    v_exp_f32 v69, v69
    v_mfma_f32_32x32x16_bf16 v[48:63], v[88:91], v[8:11], v[16:31]
    ds_read_b128 v[92:95], v5 offset:44032
    s_mov_b64 exec, s[56:57]
    ds_read_b128 v[96:99], v119 offset:43008
    ds_read_b128 v[104:107], v119 offset:42496
    s_mov_b64 exec, -1
    v_exp_f32 v70, v70
    v_exp_f32 v71, v71
    v_exp_f32 v72, v72
    v_exp_f32 v73, v73
    v_smfmac_f32_32x32x32_bf16 v[32:47], v[100:103], v[64:71], v112
    v_exp_f32 v74, v74
    v_exp_f32 v75, v75
    v_exp_f32 v76, v76
    v_exp_f32 v77, v77
    v_exp_f32 v78, v78
    v_exp_f32 v79, v79
    v_exp_f32 v48, v48
    v_exp_f32 v49, v49
    s_waitcnt lgkmcnt(0)
    v_smfmac_f32_32x32x32_bf16 v[32:47], v[104:107], v[72:79], v112
    v_exp_f32 v50, v50
    v_exp_f32 v51, v51
    v_exp_f32 v52, v52
    v_exp_f32 v53, v53
    v_mfma_f32_32x32x16_bf16 v[64:79], v[92:95], v[8:11], v[16:31]
    ds_read_b128 v[88:91], v5 offset:45056
    s_mov_b64 exec, s[56:57]
    ds_read_b128 v[100:103], v119 offset:44032
    ds_read_b128 v[104:107], v119 offset:43520
    s_mov_b64 exec, -1
    v_exp_f32 v54, v54
    v_exp_f32 v55, v55
    v_exp_f32 v56, v56
    v_exp_f32 v57, v57
    v_smfmac_f32_32x32x32_bf16 v[32:47], v[96:99], v[48:55], v112
    v_exp_f32 v58, v58
    v_exp_f32 v59, v59
    v_exp_f32 v60, v60
    v_exp_f32 v61, v61
    v_exp_f32 v62, v62
    v_exp_f32 v63, v63
    v_exp_f32 v64, v64
    v_exp_f32 v65, v65
    s_waitcnt lgkmcnt(0)
    v_smfmac_f32_32x32x32_bf16 v[32:47], v[104:107], v[56:63], v112
    v_exp_f32 v66, v66
    v_exp_f32 v67, v67
    v_exp_f32 v68, v68
    v_exp_f32 v69, v69
    v_mfma_f32_32x32x16_bf16 v[48:63], v[88:91], v[8:11], v[16:31]
    ds_read_b128 v[92:95], v5 offset:46080
    s_mov_b64 exec, s[56:57]
    ds_read_b128 v[96:99], v119 offset:45056
    ds_read_b128 v[104:107], v119 offset:44544
    s_mov_b64 exec, -1
    v_exp_f32 v70, v70
    v_exp_f32 v71, v71
    v_exp_f32 v72, v72
    v_exp_f32 v73, v73
    v_smfmac_f32_32x32x32_bf16 v[32:47], v[100:103], v[64:71], v112
    v_exp_f32 v74, v74
    v_exp_f32 v75, v75
    v_exp_f32 v76, v76
    v_exp_f32 v77, v77
    v_exp_f32 v78, v78
    v_exp_f32 v79, v79
    s_setprio 1
    v_exp_f32 v48, v48
    v_exp_f32 v49, v49
    s_waitcnt lgkmcnt(0)
    v_smfmac_f32_32x32x32_bf16 v[32:47], v[104:107], v[72:79], v112
    v_exp_f32 v50, v50
    v_exp_f32 v51, v51
    v_exp_f32 v52, v52
    v_exp_f32 v53, v53
    v_mfma_f32_32x32x16_bf16 v[64:79], v[92:95], v[8:11], v[16:31]
    ds_read_b128 v[88:91], v5 offset:47104
    s_mov_b64 exec, s[56:57]
    ds_read_b128 v[100:103], v119 offset:46080
    ds_read_b128 v[104:107], v119 offset:45568
    s_mov_b64 exec, -1
    v_exp_f32 v54, v54
    v_exp_f32 v55, v55
    v_exp_f32 v56, v56
    v_exp_f32 v57, v57
    v_smfmac_f32_32x32x32_bf16 v[32:47], v[96:99], v[48:55], v112
    v_exp_f32 v58, v58
    v_exp_f32 v59, v59
    v_exp_f32 v60, v60
    v_exp_f32 v61, v61
    v_exp_f32 v62, v62
    v_exp_f32 v63, v63
    v_exp_f32 v64, v64
    v_exp_f32 v65, v65
    s_waitcnt lgkmcnt(0)
    v_smfmac_f32_32x32x32_bf16 v[32:47], v[104:107], v[56:63], v112
    v_exp_f32 v66, v66
    v_exp_f32 v67, v67
    v_exp_f32 v68, v68
    v_exp_f32 v69, v69
    v_mfma_f32_32x32x16_bf16 v[48:63], v[88:91], v[8:11], v[16:31]
    ds_read_b128 v[92:95], v5 offset:48128
    s_mov_b64 exec, s[56:57]
    ds_read_b128 v[96:99], v119 offset:47104
    ds_read_b128 v[104:107], v119 offset:46592
    s_mov_b64 exec, -1
    v_exp_f32 v70, v70
    v_exp_f32 v71, v71
    v_exp_f32 v72, v72
    v_exp_f32 v73, v73
    v_smfmac_f32_32x32x32_bf16 v[32:47], v[100:103], v[64:71], v112
    v_exp_f32 v74, v74
    v_exp_f32 v75, v75
    v_exp_f32 v76, v76
    v_exp_f32 v77, v77
    v_exp_f32 v78, v78
    v_exp_f32 v79, v79
    s_branch att_mid_done
att_mid1:
    s_lshl_b32 s22, s2, 13
    s_add_u32 s22, s22, s40
    s_mul_i32 s23, s2, 8448
    s_add_u32 s23, s23, s40
    v_mov_b32 v12, 0
    v_mov_b32 v13, 0
    v_mov_b32 v14, 0
    v_mov_b32 v15, 0
    s_setprio 3
    v_exp_f32 v48, v48
    v_exp_f32 v49, v49
    s_waitcnt lgkmcnt(0)
    v_smfmac_f32_32x32x32_bf16 v[32:47], v[104:107], v[72:79], v112
    buffer_load_dwordx4 v[128:131], v118, s[8:11], s54 offen offset:0
    v_exp_f32 v50, v50
    v_exp_f32 v51, v51
    v_exp_f32 v52, v52
    v_exp_f32 v53, v53
    v_mfma_f32_32x32x16_bf16 v[64:79], v[92:95], v[8:11], v[16:31]
    ds_read_b128 v[88:91], v5 offset:16384
    s_mov_b64 exec, s[56:57]
    ds_read_b128 v[100:103], v119 offset:15360
    ds_read_b128 v[104:107], v119 offset:14848
    s_mov_b64 exec, -1
    buffer_load_dwordx4 v[132:135], v118, s[8:11], s54 offen offset:1024
    v_exp_f32 v54, v54
    v_exp_f32 v55, v55
    v_exp_f32 v56, v56
    v_exp_f32 v57, v57
    v_smfmac_f32_32x32x32_bf16 v[32:47], v[96:99], v[48:55], v112
    v_exp_f32 v58, v58
    v_exp_f32 v59, v59
    v_exp_f32 v60, v60
    v_exp_f32 v61, v61
    v_exp_f32 v62, v62
    v_exp_f32 v63, v63
    v_exp_f32 v64, v64
    v_exp_f32 v65, v65
    s_waitcnt lgkmcnt(0)
    v_smfmac_f32_32x32x32_bf16 v[32:47], v[104:107], v[56:63], v112
    buffer_load_dwordx4 v[136:139], v118, s[8:11], s54 offen offset:2048
    v_exp_f32 v66, v66
    v_exp_f32 v67, v67
    v_exp_f32 v68, v68
    v_exp_f32 v69, v69
    v_mfma_f32_32x32x16_bf16 v[48:63], v[88:91], v[8:11], v[16:31]
    ds_read_b128 v[92:95], v5 offset:17408
    s_mov_b64 exec, s[56:57]
    ds_read_b128 v[96:99], v119 offset:16384
    ds_read_b128 v[104:107], v119 offset:15872
    s_mov_b64 exec, -1
    buffer_load_dwordx4 v[140:143], v118, s[8:11], s54 offen offset:3072
    s_add_u32 s54, s54, 4096
    v_exp_f32 v70, v70
    v_exp_f32 v71, v71
    v_exp_f32 v72, v72
    v_exp_f32 v73, v73
    v_smfmac_f32_32x32x32_bf16 v[32:47], v[100:103], v[64:71], v112
    v_exp_f32 v74, v74
    v_exp_f32 v75, v75
    v_exp_f32 v76, v76
    v_exp_f32 v77, v77
    v_exp_f32 v78, v78
    v_exp_f32 v79, v79
    s_setprio 2
    v_exp_f32 v48, v48
    v_exp_f32 v49, v49
    s_waitcnt lgkmcnt(0)
    v_smfmac_f32_32x32x32_bf16 v[32:47], v[104:107], v[72:79], v112
    buffer_load_dwordx4 v[144:147], v118, s[8:11], s54 offen offset:0
    v_exp_f32 v50, v50
    v_exp_f32 v51, v51
    v_exp_f32 v52, v52
    v_exp_f32 v53, v53
    v_mfma_f32_32x32x16_bf16 v[64:79], v[92:95], v[8:11], v[16:31]
    ds_read_b128 v[88:91], v5 offset:18432
    s_mov_b64 exec, s[56:57]
    ds_read_b128 v[100:103], v119 offset:17408
    ds_read_b128 v[104:107], v119 offset:16896
    s_mov_b64 exec, -1
    buffer_load_dwordx4 v[148:151], v118, s[8:11], s54 offen offset:1024
    v_exp_f32 v54, v54
    v_exp_f32 v55, v55
    v_exp_f32 v56, v56
    v_exp_f32 v57, v57
    v_smfmac_f32_32x32x32_bf16 v[32:47], v[96:99], v[48:55], v112
    v_exp_f32 v58, v58
    v_exp_f32 v59, v59
    v_exp_f32 v60, v60
    v_exp_f32 v61, v61
    v_exp_f32 v62, v62
    v_exp_f32 v63, v63
    v_exp_f32 v64, v64
    v_exp_f32 v65, v65
    s_waitcnt lgkmcnt(0)
    v_smfmac_f32_32x32x32_bf16 v[32:47], v[104:107], v[56:63], v112
    buffer_load_dwordx4 v[152:155], v118, s[8:11], s54 offen offset:2048
    v_exp_f32 v66, v66
    v_exp_f32 v67, v67
    v_exp_f32 v68, v68
    v_exp_f32 v69, v69
    v_mfma_f32_32x32x16_bf16 v[48:63], v[88:91], v[8:11], v[16:31]
    ds_read_b128 v[92:95], v5 offset:19456
    s_mov_b64 exec, s[56:57]
    ds_read_b128 v[96:99], v119 offset:18432
    ds_read_b128 v[104:107], v119 offset:17920
    s_mov_b64 exec, -1
    buffer_load_dwordx4 v[156:159], v118, s[8:11], s54 offen offset:3072
    s_add_u32 s54, s54, 4096
    v_exp_f32 v70, v70
    v_exp_f32 v71, v71
    v_exp_f32 v72, v72
    v_exp_f32 v73, v73
    v_smfmac_f32_32x32x32_bf16 v[32:47], v[100:103], v[64:71], v112
    v_exp_f32 v74, v74
    v_exp_f32 v75, v75
    v_exp_f32 v76, v76
    v_exp_f32 v77, v77
    v_exp_f32 v78, v78
    v_exp_f32 v79, v79
    s_setprio 1
    v_exp_f32 v48, v48
    v_exp_f32 v49, v49
    s_waitcnt lgkmcnt(0)
    v_smfmac_f32_32x32x32_bf16 v[32:47], v[104:107], v[72:79], v112
    buffer_load_dwordx4 v[160:163], v118, s[8:11], s54 offen offset:0
    v_exp_f32 v50, v50
    v_exp_f32 v51, v51
    v_exp_f32 v52, v52
    v_exp_f32 v53, v53
    v_mfma_f32_32x32x16_bf16 v[64:79], v[92:95], v[8:11], v[16:31]
    ds_read_b128 v[88:91], v5 offset:20480
    s_mov_b64 exec, s[56:57]
    ds_read_b128 v[100:103], v119 offset:19456
    ds_read_b128 v[104:107], v119 offset:18944
    s_mov_b64 exec, -1
    buffer_load_dwordx4 v[164:167], v118, s[8:11], s54 offen offset:1024
    v_exp_f32 v54, v54
    v_exp_f32 v55, v55
    v_exp_f32 v56, v56
    v_exp_f32 v57, v57
    v_smfmac_f32_32x32x32_bf16 v[32:47], v[96:99], v[48:55], v112
    v_exp_f32 v58, v58
    v_exp_f32 v59, v59
    v_exp_f32 v60, v60
    v_exp_f32 v61, v61
    v_exp_f32 v62, v62
    v_exp_f32 v63, v63
    v_exp_f32 v64, v64
    v_exp_f32 v65, v65
    s_waitcnt lgkmcnt(0)
    v_smfmac_f32_32x32x32_bf16 v[32:47], v[104:107], v[56:63], v112
    buffer_load_dwordx4 v[168:171], v118, s[8:11], s54 offen offset:2048
    v_exp_f32 v66, v66
    v_exp_f32 v67, v67
    v_exp_f32 v68, v68
    v_exp_f32 v69, v69
    v_mfma_f32_32x32x16_bf16 v[48:63], v[88:91], v[8:11], v[16:31]
    ds_read_b128 v[92:95], v5 offset:21504
    s_mov_b64 exec, s[56:57]
    ds_read_b128 v[96:99], v119 offset:20480
    ds_read_b128 v[104:107], v119 offset:19968
    s_mov_b64 exec, -1
    buffer_load_dwordx4 v[172:175], v118, s[8:11], s54 offen offset:3072
    s_add_u32 s54, s54, 4096
    v_exp_f32 v70, v70
    v_exp_f32 v71, v71
    v_exp_f32 v72, v72
    v_exp_f32 v73, v73
    v_smfmac_f32_32x32x32_bf16 v[32:47], v[100:103], v[64:71], v112
    v_exp_f32 v74, v74
    v_exp_f32 v75, v75
    v_exp_f32 v76, v76
    v_exp_f32 v77, v77
    v_exp_f32 v78, v78
    v_exp_f32 v79, v79
    s_setprio 0
    v_exp_f32 v48, v48
    v_exp_f32 v49, v49
    s_waitcnt lgkmcnt(0)
    v_smfmac_f32_32x32x32_bf16 v[32:47], v[104:107], v[72:79], v112
    buffer_load_dwordx4 v[176:179], v118, s[8:11], s54 offen offset:0
    v_exp_f32 v50, v50
    v_exp_f32 v51, v51
    v_exp_f32 v52, v52
    v_exp_f32 v53, v53
    v_mfma_f32_32x32x16_bf16 v[64:79], v[92:95], v[8:11], v[16:31]
    ds_read_b128 v[88:91], v5 offset:22528
    s_mov_b64 exec, s[56:57]
    ds_read_b128 v[100:103], v119 offset:21504
    ds_read_b128 v[104:107], v119 offset:20992
    s_mov_b64 exec, -1
    buffer_load_dwordx4 v[180:183], v118, s[8:11], s54 offen offset:1024
    v_exp_f32 v54, v54
    v_exp_f32 v55, v55
    v_exp_f32 v56, v56
    v_exp_f32 v57, v57
    v_smfmac_f32_32x32x32_bf16 v[32:47], v[96:99], v[48:55], v112
    v_exp_f32 v58, v58
    v_exp_f32 v59, v59
    v_exp_f32 v60, v60
    v_exp_f32 v61, v61
    v_exp_f32 v62, v62
    v_exp_f32 v63, v63
    v_exp_f32 v64, v64
    v_exp_f32 v65, v65
    s_waitcnt lgkmcnt(0)
    v_smfmac_f32_32x32x32_bf16 v[32:47], v[104:107], v[56:63], v112
    buffer_load_dwordx4 v[184:187], v118, s[8:11], s54 offen offset:2048
    v_exp_f32 v66, v66
    v_exp_f32 v67, v67
    v_exp_f32 v68, v68
    v_exp_f32 v69, v69
    v_mfma_f32_32x32x16_bf16 v[48:63], v[88:91], v[8:11], v[16:31]
    ds_read_b128 v[92:95], v5 offset:23552
    s_mov_b64 exec, s[56:57]
    ds_read_b128 v[96:99], v119 offset:22528
    ds_read_b128 v[104:107], v119 offset:22016
    s_mov_b64 exec, -1
    buffer_load_dwordx4 v[188:191], v118, s[8:11], s54 offen offset:3072
    s_add_u32 s54, s54, 4096
    v_exp_f32 v70, v70
    v_exp_f32 v71, v71
    v_exp_f32 v72, v72
    v_exp_f32 v73, v73
    v_smfmac_f32_32x32x32_bf16 v[32:47], v[100:103], v[64:71], v112
    v_exp_f32 v74, v74
    v_exp_f32 v75, v75
    v_exp_f32 v76, v76
    v_exp_f32 v77, v77
    v_exp_f32 v78, v78
    v_exp_f32 v79, v79
    s_waitcnt vmcnt(16)
    s_barrier
    s_setprio 3
    v_exp_f32 v48, v48
    v_exp_f32 v49, v49
    s_waitcnt lgkmcnt(0)
    v_smfmac_f32_32x32x32_bf16 v[32:47], v[104:107], v[72:79], v112
    buffer_load_dwordx4 v[192:195], v118, s[8:11], s54 offen offset:0
    v_exp_f32 v50, v50
    v_exp_f32 v51, v51
    v_exp_f32 v52, v52
    v_exp_f32 v53, v53
    v_mfma_f32_32x32x16_bf16 v[64:79], v[92:95], v[8:11], v[16:31]
    ds_read_b128 v[88:91], v5 offset:24576
    s_mov_b64 exec, s[56:57]
    ds_read_b128 v[100:103], v119 offset:23552
    ds_read_b128 v[104:107], v119 offset:23040
    s_mov_b64 exec, -1
    buffer_load_dwordx4 v[196:199], v118, s[8:11], s54 offen offset:1024
    v_exp_f32 v54, v54
    v_exp_f32 v55, v55
    v_exp_f32 v56, v56
    v_exp_f32 v57, v57
    v_smfmac_f32_32x32x32_bf16 v[32:47], v[96:99], v[48:55], v112
    v_exp_f32 v58, v58
    v_exp_f32 v59, v59
    v_exp_f32 v60, v60
    v_exp_f32 v61, v61
    v_exp_f32 v62, v62
    v_exp_f32 v63, v63
    v_exp_f32 v64, v64
    v_exp_f32 v65, v65
    s_waitcnt lgkmcnt(0)
    v_smfmac_f32_32x32x32_bf16 v[32:47], v[104:107], v[56:63], v112
    buffer_load_dwordx4 v[200:203], v118, s[8:11], s54 offen offset:2048
    v_exp_f32 v66, v66
    v_exp_f32 v67, v67
    v_exp_f32 v68, v68
    v_exp_f32 v69, v69
    v_mfma_f32_32x32x16_bf16 v[48:63], v[88:91], v[8:11], v[16:31]
    ds_read_b128 v[92:95], v5 offset:25600
    s_mov_b64 exec, s[56:57]
    ds_read_b128 v[96:99], v119 offset:24576
    ds_read_b128 v[104:107], v119 offset:24064
    s_mov_b64 exec, -1
    buffer_load_dwordx4 v[204:207], v118, s[8:11], s54 offen offset:3072
    s_add_u32 s54, s54, 4096
    v_exp_f32 v70, v70
    v_exp_f32 v71, v71
    v_exp_f32 v72, v72
    v_exp_f32 v73, v73
    v_smfmac_f32_32x32x32_bf16 v[32:47], v[100:103], v[64:71], v112
    v_exp_f32 v74, v74
    v_exp_f32 v75, v75
    v_exp_f32 v76, v76
    v_exp_f32 v77, v77
    v_exp_f32 v78, v78
    v_exp_f32 v79, v79
    v_exp_f32 v48, v48
    v_exp_f32 v49, v49
    s_waitcnt lgkmcnt(0)
    v_smfmac_f32_32x32x32_bf16 v[32:47], v[104:107], v[72:79], v112
    buffer_load_dwordx4 v[208:211], v118, s[8:11], s54 offen offset:0
    v_exp_f32 v50, v50
    v_exp_f32 v51, v51
    v_exp_f32 v52, v52
    v_exp_f32 v53, v53
    v_mfma_f32_32x32x16_bf16 v[64:79], v[92:95], v[8:11], v[16:31]
    ds_read_b128 v[88:91], v5 offset:26624
    s_mov_b64 exec, s[56:57]
    ds_read_b128 v[100:103], v119 offset:25600
    ds_read_b128 v[104:107], v119 offset:25088
    s_mov_b64 exec, -1
    buffer_load_dwordx4 v[212:215], v118, s[8:11], s54 offen offset:1024
    v_exp_f32 v54, v54
    v_exp_f32 v55, v55
    v_exp_f32 v56, v56
    v_exp_f32 v57, v57
    v_smfmac_f32_32x32x32_bf16 v[32:47], v[96:99], v[48:55], v112
    v_exp_f32 v58, v58
    v_exp_f32 v59, v59
    v_exp_f32 v60, v60
    v_exp_f32 v61, v61
    v_exp_f32 v62, v62
    v_exp_f32 v63, v63
    v_exp_f32 v64, v64
    v_exp_f32 v65, v65
    s_waitcnt lgkmcnt(0)
    v_smfmac_f32_32x32x32_bf16 v[32:47], v[104:107], v[56:63], v112
    buffer_load_dwordx4 v[216:219], v118, s[8:11], s54 offen offset:2048
    v_exp_f32 v66, v66
    v_exp_f32 v67, v67
    v_exp_f32 v68, v68
    v_exp_f32 v69, v69
    v_mfma_f32_32x32x16_bf16 v[48:63], v[88:91], v[8:11], v[16:31]
    ds_read_b128 v[92:95], v5 offset:27648
    s_mov_b64 exec, s[56:57]
    ds_read_b128 v[96:99], v119 offset:26624
    ds_read_b128 v[104:107], v119 offset:26112
    s_mov_b64 exec, -1
    buffer_load_dwordx4 v[220:223], v118, s[8:11], s54 offen offset:3072
    s_add_u32 s54, s54, 4096
    v_exp_f32 v70, v70
    v_exp_f32 v71, v71
    v_exp_f32 v72, v72
    v_exp_f32 v73, v73
    v_smfmac_f32_32x32x32_bf16 v[32:47], v[100:103], v[64:71], v112
    v_exp_f32 v74, v74
    v_exp_f32 v75, v75
    v_exp_f32 v76, v76
    v_exp_f32 v77, v77
    v_exp_f32 v78, v78
    v_exp_f32 v79, v79
    v_exp_f32 v48, v48
    v_exp_f32 v49, v49
    s_waitcnt lgkmcnt(0)
    v_smfmac_f32_32x32x32_bf16 v[32:47], v[104:107], v[72:79], v112
    buffer_load_dwordx4 v[224:227], v118, s[8:11], s54 offen offset:0
    v_exp_f32 v50, v50
    v_exp_f32 v51, v51
    v_exp_f32 v52, v52
    v_exp_f32 v53, v53
    v_mfma_f32_32x32x16_bf16 v[64:79], v[92:95], v[8:11], v[16:31]
    ds_read_b128 v[88:91], v5 offset:28672
    s_mov_b64 exec, s[56:57]
    ds_read_b128 v[100:103], v119 offset:27648
    ds_read_b128 v[104:107], v119 offset:27136
    s_mov_b64 exec, -1
    buffer_load_dwordx4 v[228:231], v118, s[8:11], s54 offen offset:1024
    v_exp_f32 v54, v54
    v_exp_f32 v55, v55
    v_exp_f32 v56, v56
    v_exp_f32 v57, v57
    v_smfmac_f32_32x32x32_bf16 v[32:47], v[96:99], v[48:55], v112
    v_exp_f32 v58, v58
    v_exp_f32 v59, v59
    v_exp_f32 v60, v60
    v_exp_f32 v61, v61
    v_exp_f32 v62, v62
    v_exp_f32 v63, v63
    v_exp_f32 v64, v64
    v_exp_f32 v65, v65
    s_waitcnt lgkmcnt(0)
    v_smfmac_f32_32x32x32_bf16 v[32:47], v[104:107], v[56:63], v112
    buffer_load_dwordx4 v[232:235], v118, s[8:11], s54 offen offset:2048
    v_exp_f32 v66, v66
    v_exp_f32 v67, v67
    v_exp_f32 v68, v68
    v_exp_f32 v69, v69
    v_mfma_f32_32x32x16_bf16 v[48:63], v[88:91], v[8:11], v[16:31]
    ds_read_b128 v[92:95], v5 offset:29696
    s_mov_b64 exec, s[56:57]
    ds_read_b128 v[96:99], v119 offset:28672
    ds_read_b128 v[104:107], v119 offset:28160
    s_mov_b64 exec, -1
    buffer_load_dwordx4 v[236:239], v118, s[8:11], s54 offen offset:3072
    s_add_u32 s54, s54, 4096
    v_exp_f32 v70, v70
    v_exp_f32 v71, v71
    v_exp_f32 v72, v72
    v_exp_f32 v73, v73
    v_smfmac_f32_32x32x32_bf16 v[32:47], v[100:103], v[64:71], v112
    v_exp_f32 v74, v74
    v_exp_f32 v75, v75
    v_exp_f32 v76, v76
    v_exp_f32 v77, v77
    v_exp_f32 v78, v78
    v_exp_f32 v79, v79
    v_exp_f32 v48, v48
    v_exp_f32 v49, v49
    s_waitcnt lgkmcnt(0)
    v_smfmac_f32_32x32x32_bf16 v[32:47], v[104:107], v[72:79], v112
    buffer_load_dwordx4 v[240:243], v118, s[8:11], s54 offen offset:0
    v_exp_f32 v50, v50
    v_exp_f32 v51, v51
    v_exp_f32 v52, v52
    v_exp_f32 v53, v53
    v_mfma_f32_32x32x16_bf16 v[64:79], v[92:95], v[8:11], v[16:31]
    ds_read_b128 v[88:91], v5 offset:30720
    s_mov_b64 exec, s[56:57]
    ds_read_b128 v[100:103], v119 offset:29696
    ds_read_b128 v[104:107], v119 offset:29184
    s_mov_b64 exec, -1
    buffer_load_dwordx4 v[244:247], v118, s[8:11], s54 offen offset:1024
    v_exp_f32 v54, v54
    v_exp_f32 v55, v55
    v_exp_f32 v56, v56
    v_exp_f32 v57, v57
    v_smfmac_f32_32x32x32_bf16 v[32:47], v[96:99], v[48:55], v112
    v_exp_f32 v58, v58
    v_exp_f32 v59, v59
    v_exp_f32 v60, v60
    v_exp_f32 v61, v61
    v_exp_f32 v62, v62
    v_exp_f32 v63, v63
    v_exp_f32 v64, v64
    v_exp_f32 v65, v65
    s_waitcnt lgkmcnt(0)
    v_smfmac_f32_32x32x32_bf16 v[32:47], v[104:107], v[56:63], v112
    buffer_load_dwordx4 v[248:251], v118, s[8:11], s54 offen offset:2048
    v_exp_f32 v66, v66
    v_exp_f32 v67, v67
    v_exp_f32 v68, v68
    v_exp_f32 v69, v69
    v_mfma_f32_32x32x16_bf16 v[48:63], v[88:91], v[8:11], v[16:31]
    ds_read_b128 v[92:95], v5 offset:31744
    s_mov_b64 exec, s[56:57]
    ds_read_b128 v[96:99], v119 offset:30720
    ds_read_b128 v[104:107], v119 offset:30208
    s_mov_b64 exec, -1
    buffer_load_dwordx4 v[252:255], v118, s[8:11], s54 offen offset:3072
    s_add_u32 s54, s54, 4096
    v_exp_f32 v70, v70
    v_exp_f32 v71, v71
    v_exp_f32 v72, v72
    v_exp_f32 v73, v73
    v_smfmac_f32_32x32x32_bf16 v[32:47], v[100:103], v[64:71], v112
    v_exp_f32 v74, v74
    v_exp_f32 v75, v75
    v_exp_f32 v76, v76
    v_exp_f32 v77, v77
    v_exp_f32 v78, v78
    v_exp_f32 v79, v79
    v_exp_f32 v48, v48
    v_exp_f32 v49, v49
    s_waitcnt lgkmcnt(0)
    v_smfmac_f32_32x32x32_bf16 v[32:47], v[104:107], v[72:79], v112
    s_add_u32 s24, s22, 16777216
    buffer_store_dwordx4 v[114:117], v118, s[8:11], s24 offen sc1
    v_exp_f32 v50, v50
    v_exp_f32 v51, v51
    v_exp_f32 v52, v52
    v_exp_f32 v53, v53
    v_mfma_f32_32x32x16_bf16 v[64:79], v[92:95], v[8:11], v[16:31]
    ds_read_b128 v[88:91], v5 offset:32768
    s_mov_b64 exec, s[56:57]
    ds_read_b128 v[100:103], v119 offset:31744
    ds_read_b128 v[104:107], v119 offset:31232
    s_mov_b64 exec, -1
    v_exp_f32 v54, v54
    v_exp_f32 v55, v55
    v_exp_f32 v56, v56
    v_exp_f32 v57, v57
    v_smfmac_f32_32x32x32_bf16 v[32:47], v[96:99], v[48:55], v112
    v_exp_f32 v58, v58
    v_exp_f32 v59, v59
    v_exp_f32 v60, v60
    v_exp_f32 v61, v61
    v_exp_f32 v62, v62
    v_exp_f32 v63, v63
    v_exp_f32 v64, v64
    v_exp_f32 v65, v65
    s_waitcnt lgkmcnt(0)
    v_smfmac_f32_32x32x32_bf16 v[32:47], v[104:107], v[56:63], v112
    v_exp_f32 v66, v66
    v_exp_f32 v67, v67
    v_exp_f32 v68, v68
    v_exp_f32 v69, v69
    v_mfma_f32_32x32x16_bf16 v[48:63], v[88:91], v[8:11], v[16:31]
    ds_read_b128 v[92:95], v5 offset:33792
    s_mov_b64 exec, s[56:57]
    ds_read_b128 v[96:99], v119 offset:32768
    ds_read_b128 v[104:107], v119 offset:32256
    s_mov_b64 exec, -1
    v_exp_f32 v70, v70
    v_exp_f32 v71, v71
    v_exp_f32 v72, v72
    v_exp_f32 v73, v73
    v_smfmac_f32_32x32x32_bf16 v[32:47], v[100:103], v[64:71], v112
    v_exp_f32 v74, v74
    v_exp_f32 v75, v75
    v_exp_f32 v76, v76
    v_exp_f32 v77, v77
    v_exp_f32 v78, v78
    v_exp_f32 v79, v79
    v_exp_f32 v48, v48
    v_exp_f32 v49, v49
    s_waitcnt lgkmcnt(0)
    v_smfmac_f32_32x32x32_bf16 v[32:47], v[104:107], v[72:79], v112
    s_add_u32 s24, s22, 18874368
    buffer_store_dwordx4 v[114:117], v118, s[8:11], s24 offen sc1
    v_exp_f32 v50, v50
    v_exp_f32 v51, v51
    v_exp_f32 v52, v52
    v_exp_f32 v53, v53
    v_mfma_f32_32x32x16_bf16 v[64:79], v[92:95], v[8:11], v[16:31]
    ds_read_b128 v[88:91], v5 offset:34816
    s_mov_b64 exec, s[56:57]
    ds_read_b128 v[100:103], v119 offset:33792
    ds_read_b128 v[104:107], v119 offset:33280
    s_mov_b64 exec, -1
    v_exp_f32 v54, v54
    v_exp_f32 v55, v55
    v_exp_f32 v56, v56
    v_exp_f32 v57, v57
    v_smfmac_f32_32x32x32_bf16 v[32:47], v[96:99], v[48:55], v112
    v_exp_f32 v58, v58
    v_exp_f32 v59, v59
    v_exp_f32 v60, v60
    v_exp_f32 v61, v61
    v_exp_f32 v62, v62
    v_exp_f32 v63, v63
    s_setprio 2
    v_exp_f32 v64, v64
    v_exp_f32 v65, v65
    s_waitcnt lgkmcnt(0)
    v_smfmac_f32_32x32x32_bf16 v[32:47], v[104:107], v[56:63], v112
    v_exp_f32 v66, v66
    v_exp_f32 v67, v67
    v_exp_f32 v68, v68
    v_exp_f32 v69, v69
    v_mfma_f32_32x32x16_bf16 v[48:63], v[88:91], v[8:11], v[16:31]
    ds_read_b128 v[92:95], v5 offset:35840
    s_mov_b64 exec, s[56:57]
    ds_read_b128 v[96:99], v119 offset:34816
    ds_read_b128 v[104:107], v119 offset:34304
    s_mov_b64 exec, -1
    v_exp_f32 v70, v70
    v_exp_f32 v71, v71
    v_exp_f32 v72, v72
    v_exp_f32 v73, v73
    v_smfmac_f32_32x32x32_bf16 v[32:47], v[100:103], v[64:71], v112
    v_exp_f32 v74, v74
    v_exp_f32 v75, v75
    v_exp_f32 v76, v76
    v_exp_f32 v77, v77
    v_exp_f32 v78, v78
    v_exp_f32 v79, v79
    v_exp_f32 v48, v48
    v_exp_f32 v49, v49
    s_waitcnt lgkmcnt(0)
    v_smfmac_f32_32x32x32_bf16 v[32:47], v[104:107], v[72:79], v112
    s_add_u32 s24, s22, 20971520
    buffer_store_dwordx4 v[114:117], v118, s[8:11], s24 offen sc1
    v_exp_f32 v50, v50
    v_exp_f32 v51, v51
    v_exp_f32 v52, v52
    v_exp_f32 v53, v53
    v_mfma_f32_32x32x16_bf16 v[64:79], v[92:95], v[8:11], v[16:31]
    ds_read_b128 v[88:91], v5 offset:36864
    s_mov_b64 exec, s[56:57]
    ds_read_b128 v[100:103], v119 offset:35840
    ds_read_b128 v[104:107], v119 offset:35328
    s_mov_b64 exec, -1
    v_exp_f32 v54, v54
    v_exp_f32 v55, v55
    v_exp_f32 v56, v56
    v_exp_f32 v57, v57
    v_smfmac_f32_32x32x32_bf16 v[32:47], v[96:99], v[48:55], v112
    v_exp_f32 v58, v58
    v_exp_f32 v59, v59
    v_exp_f32 v60, v60
    v_exp_f32 v61, v61
    v_exp_f32 v62, v62
    v_exp_f32 v63, v63
    v_exp_f32 v64, v64
    v_exp_f32 v65, v65
    s_waitcnt lgkmcnt(0)
    v_smfmac_f32_32x32x32_bf16 v[32:47], v[104:107], v[56:63], v112
    v_exp_f32 v66, v66
    v_exp_f32 v67, v67
    v_exp_f32 v68, v68
    v_exp_f32 v69, v69
    v_mfma_f32_32x32x16_bf16 v[48:63], v[88:91], v[8:11], v[16:31]
    ds_read_b128 v[92:95], v5 offset:37888
    s_mov_b64 exec, s[56:57]
    ds_read_b128 v[96:99], v119 offset:36864
    ds_read_b128 v[104:107], v119 offset:36352
    s_mov_b64 exec, -1
    v_exp_f32 v70, v70
    v_exp_f32 v71, v71
    v_exp_f32 v72, v72
    v_exp_f32 v73, v73
    v_smfmac_f32_32x32x32_bf16 v[32:47], v[100:103], v[64:71], v112
    v_exp_f32 v74, v74
    v_exp_f32 v75, v75
    v_exp_f32 v76, v76
    v_exp_f32 v77, v77
    v_exp_f32 v78, v78
    v_exp_f32 v79, v79
    v_exp_f32 v48, v48
    v_exp_f32 v49, v49
    s_waitcnt lgkmcnt(0)
    v_smfmac_f32_32x32x32_bf16 v[32:47], v[104:107], v[72:79], v112
    s_add_u32 s24, s22, 23068672
    buffer_store_dwordx4 v[114:117], v118, s[8:11], s24 offen sc1
    v_exp_f32 v50, v50
    v_exp_f32 v51, v51
    v_exp_f32 v52, v52
    v_exp_f32 v53, v53
    v_mfma_f32_32x32x16_bf16 v[64:79], v[92:95], v[8:11], v[16:31]
    ds_read_b128 v[88:91], v5 offset:38912
    s_mov_b64 exec, s[56:57]
    ds_read_b128 v[100:103], v119 offset:37888
    ds_read_b128 v[104:107], v119 offset:37376
    s_mov_b64 exec, -1
    v_exp_f32 v54, v54
    v_exp_f32 v55, v55
    v_exp_f32 v56, v56
    v_exp_f32 v57, v57
    v_smfmac_f32_32x32x32_bf16 v[32:47], v[96:99], v[48:55], v112
    v_exp_f32 v58, v58
    v_exp_f32 v59, v59
    v_exp_f32 v60, v60
    v_exp_f32 v61, v61
    v_exp_f32 v62, v62
    v_exp_f32 v63, v63
    v_exp_f32 v64, v64
    v_exp_f32 v65, v65
    s_waitcnt lgkmcnt(0)
    v_smfmac_f32_32x32x32_bf16 v[32:47], v[104:107], v[56:63], v112
    v_exp_f32 v66, v66
    v_exp_f32 v67, v67
    v_exp_f32 v68, v68
    v_exp_f32 v69, v69
    v_mfma_f32_32x32x16_bf16 v[48:63], v[88:91], v[8:11], v[16:31]
    ds_read_b128 v[92:95], v5 offset:39936
    s_mov_b64 exec, s[56:57]
    ds_read_b128 v[96:99], v119 offset:38912
    ds_read_b128 v[104:107], v119 offset:38400
    s_mov_b64 exec, -1
    v_exp_f32 v70, v70
    v_exp_f32 v71, v71
    v_exp_f32 v72, v72
    v_exp_f32 v73, v73
    v_smfmac_f32_32x32x32_bf16 v[32:47], v[100:103], v[64:71], v112
    v_exp_f32 v74, v74
    v_exp_f32 v75, v75
    v_exp_f32 v76, v76
    v_exp_f32 v77, v77
    v_exp_f32 v78, v78
    v_exp_f32 v79, v79
    v_exp_f32 v48, v48
    v_exp_f32 v49, v49
    s_waitcnt lgkmcnt(0)
    v_smfmac_f32_32x32x32_bf16 v[32:47], v[104:107], v[72:79], v112
    s_add_u32 s24, s23, 25165824
    buffer_store_dwordx4 v[114:117], v118, s[8:11], s24 offen sc1
    v_exp_f32 v50, v50
    v_exp_f32 v51, v51
    v_exp_f32 v52, v52
    v_exp_f32 v53, v53
    v_mfma_f32_32x32x16_bf16 v[64:79], v[92:95], v[8:11], v[16:31]
    ds_read_b128 v[88:91], v5 offset:40960
    s_mov_b64 exec, s[56:57]
    ds_read_b128 v[100:103], v119 offset:39936
    ds_read_b128 v[104:107], v119 offset:39424
    s_mov_b64 exec, -1
    v_exp_f32 v54, v54
    v_exp_f32 v55, v55
    v_exp_f32 v56, v56
    v_exp_f32 v57, v57
    v_smfmac_f32_32x32x32_bf16 v[32:47], v[96:99], v[48:55], v112
    v_exp_f32 v58, v58
    v_exp_f32 v59, v59
    v_exp_f32 v60, v60
    v_exp_f32 v61, v61
    v_exp_f32 v62, v62
    v_exp_f32 v63, v63
    v_exp_f32 v64, v64
    v_exp_f32 v65, v65
    s_waitcnt lgkmcnt(0)
    v_smfmac_f32_32x32x32_bf16 v[32:47], v[104:107], v[56:63], v112
    v_exp_f32 v66, v66
    v_exp_f32 v67, v67
    v_exp_f32 v68, v68
    v_exp_f32 v69, v69
    v_mfma_f32_32x32x16_bf16 v[48:63], v[88:91], v[8:11], v[16:31]
    ds_read_b128 v[92:95], v5 offset:41984
    s_mov_b64 exec, s[56:57]
    ds_read_b128 v[96:99], v119 offset:40960
    ds_read_b128 v[104:107], v119 offset:40448
    s_mov_b64 exec, -1
    v_exp_f32 v70, v70
    v_exp_f32 v71, v71
    v_exp_f32 v72, v72
    v_exp_f32 v73, v73
    v_smfmac_f32_32x32x32_bf16 v[32:47], v[100:103], v[64:71], v112
    v_exp_f32 v74, v74
    v_exp_f32 v75, v75
    v_exp_f32 v76, v76
    v_exp_f32 v77, v77
    v_exp_f32 v78, v78
    v_exp_f32 v79, v79
    v_exp_f32 v48, v48
    v_exp_f32 v49, v49
    s_waitcnt lgkmcnt(0)
    v_smfmac_f32_32x32x32_bf16 v[32:47], v[104:107], v[72:79], v112
    s_add_u32 s24, s23, 27525120
    buffer_store_dwordx4 v[12:15], v118, s[8:11], s24 offen sc1
    v_exp_f32 v50, v50
    v_exp_f32 v51, v51
    v_exp_f32 v52, v52
    v_exp_f32 v53, v53
    v_mfma_f32_32x32x16_bf16 v[64:79], v[92:95], v[8:11], v[16:31]
    ds_read_b128 v[88:91], v5 offset:43008
    s_mov_b64 exec, s[56:57]
    ds_read_b128 v[100:103], v119 offset:41984
    ds_read_b128 v[104:107], v119 offset:41472
    s_mov_b64 exec, -1
    v_exp_f32 v54, v54
    v_exp_f32 v55, v55
    v_exp_f32 v56, v56
    v_exp_f32 v57, v57
    v_smfmac_f32_32x32x32_bf16 v[32:47], v[96:99], v[48:55], v112
    v_exp_f32 v58, v58
    v_exp_f32 v59, v59
    v_exp_f32 v60, v60
    v_exp_f32 v61, v61
    v_exp_f32 v62, v62
    v_exp_f32 v63, v63
    v_exp_f32 v64, v64
    v_exp_f32 v65, v65
    s_waitcnt lgkmcnt(0)
    v_smfmac_f32_32x32x32_bf16 v[32:47], v[104:107], v[56:63], v112
    v_exp_f32 v66, v66
    v_exp_f32 v67, v67
    v_exp_f32 v68, v68
    v_exp_f32 v69, v69
    v_mfma_f32_32x32x16_bf16 v[48:63], v[88:91], v[8:11], v[16:31]
    ds_read_b128 v[92:95], v5 offset:44032
    s_mov_b64 exec, s[56:57]
    ds_read_b128 v[96:99], v119 offset:43008
    ds_read_b128 v[104:107], v119 offset:42496
    s_mov_b64 exec, -1
    v_exp_f32 v70, v70
    v_exp_f32 v71, v71
    v_exp_f32 v72, v72
    v_exp_f32 v73, v73
    v_smfmac_f32_32x32x32_bf16 v[32:47], v[100:103], v[64:71], v112
    v_exp_f32 v74, v74
    v_exp_f32 v75, v75
    v_exp_f32 v76, v76
    v_exp_f32 v77, v77
    v_exp_f32 v78, v78
    v_exp_f32 v79, v79
    v_exp_f32 v48, v48
    v_exp_f32 v49, v49
    s_waitcnt lgkmcnt(0)
    v_smfmac_f32_32x32x32_bf16 v[32:47], v[104:107], v[72:79], v112
    v_exp_f32 v50, v50
    v_exp_f32 v51, v51
    v_exp_f32 v52, v52
    v_exp_f32 v53, v53
    v_mfma_f32_32x32x16_bf16 v[64:79], v[92:95], v[8:11], v[16:31]
    ds_read_b128 v[88:91], v5 offset:45056
    s_mov_b64 exec, s[56:57]
    ds_read_b128 v[100:103], v119 offset:44032
    ds_read_b128 v[104:107], v119 offset:43520
    s_mov_b64 exec, -1
    v_exp_f32 v54, v54
    v_exp_f32 v55, v55
    v_exp_f32 v56, v56
    v_exp_f32 v57, v57
    v_smfmac_f32_32x32x32_bf16 v[32:47], v[96:99], v[48:55], v112
    v_exp_f32 v58, v58
    v_exp_f32 v59, v59
    v_exp_f32 v60, v60
    v_exp_f32 v61, v61
    v_exp_f32 v62, v62
    v_exp_f32 v63, v63
    v_exp_f32 v64, v64
    v_exp_f32 v65, v65
    s_waitcnt lgkmcnt(0)
    v_smfmac_f32_32x32x32_bf16 v[32:47], v[104:107], v[56:63], v112
    buffer_load_dword v114, v6, s[8:11], s60 offen sc1
    v_exp_f32 v66, v66
    v_exp_f32 v67, v67
    v_exp_f32 v68, v68
    v_exp_f32 v69, v69
    v_mfma_f32_32x32x16_bf16 v[48:63], v[88:91], v[8:11], v[16:31]
    ds_read_b128 v[92:95], v5 offset:46080
    s_mov_b64 exec, s[56:57]
    ds_read_b128 v[96:99], v119 offset:45056
    ds_read_b128 v[104:107], v119 offset:44544
    s_mov_b64 exec, -1
    buffer_load_dword v115, v6, s[8:11], s61 offen sc1
    v_exp_f32 v70, v70
    v_exp_f32 v71, v71
    v_exp_f32 v72, v72
    v_exp_f32 v73, v73
    v_smfmac_f32_32x32x32_bf16 v[32:47], v[100:103], v[64:71], v112
    v_exp_f32 v74, v74
    v_exp_f32 v75, v75
    v_exp_f32 v76, v76
    v_exp_f32 v77, v77
    v_exp_f32 v78, v78
    v_exp_f32 v79, v79
    s_setprio 1
    v_exp_f32 v48, v48
    v_exp_f32 v49, v49
    s_waitcnt lgkmcnt(0)
    v_smfmac_f32_32x32x32_bf16 v[32:47], v[104:107], v[72:79], v112
    buffer_load_dword v116, v6, s[8:11], s62 offen sc1
    v_exp_f32 v50, v50
    v_exp_f32 v51, v51
    v_exp_f32 v52, v52
    v_exp_f32 v53, v53
    v_mfma_f32_32x32x16_bf16 v[64:79], v[92:95], v[8:11], v[16:31]
    ds_read_b128 v[88:91], v5 offset:47104
    s_mov_b64 exec, s[56:57]
    ds_read_b128 v[100:103], v119 offset:46080
    ds_read_b128 v[104:107], v119 offset:45568
    s_mov_b64 exec, -1
    buffer_load_dword v117, v6, s[8:11], s63 offen sc1
    v_exp_f32 v54, v54
    v_exp_f32 v55, v55
    v_exp_f32 v56, v56
    v_exp_f32 v57, v57
    v_smfmac_f32_32x32x32_bf16 v[32:47], v[96:99], v[48:55], v112
    v_exp_f32 v58, v58
    v_exp_f32 v59, v59
    v_exp_f32 v60, v60
    v_exp_f32 v61, v61
    v_exp_f32 v62, v62
    v_exp_f32 v63, v63
    v_exp_f32 v64, v64
    v_exp_f32 v65, v65
    s_waitcnt lgkmcnt(0)
    v_smfmac_f32_32x32x32_bf16 v[32:47], v[104:107], v[56:63], v112
    v_exp_f32 v66, v66
    v_exp_f32 v67, v67
    v_exp_f32 v68, v68
    v_exp_f32 v69, v69
    v_mfma_f32_32x32x16_bf16 v[48:63], v[88:91], v[8:11], v[16:31]
    ds_read_b128 v[92:95], v5 offset:48128
    s_mov_b64 exec, s[56:57]
    ds_read_b128 v[96:99], v119 offset:47104
    ds_read_b128 v[104:107], v119 offset:46592
    s_mov_b64 exec, -1
    v_exp_f32 v70, v70
    v_exp_f32 v71, v71
    v_exp_f32 v72, v72
    v_exp_f32 v73, v73
    v_smfmac_f32_32x32x32_bf16 v[32:47], v[100:103], v[64:71], v112
    v_exp_f32 v74, v74
    v_exp_f32 v75, v75
    v_exp_f32 v76, v76
    v_exp_f32 v77, v77
    v_exp_f32 v78, v78
    v_exp_f32 v79, v79
att_mid_done:
    v_exp_f32 v48, v48
    v_exp_f32 v49, v49
    s_waitcnt lgkmcnt(0)
    v_smfmac_f32_32x32x32_bf16 v[32:47], v[104:107], v[72:79], v112
    v_exp_f32 v50, v50
    v_exp_f32 v51, v51
    v_exp_f32 v52, v52
    v_exp_f32 v53, v53
    v_mfma_f32_32x32x16_bf16 v[64:79], v[92:95], v[8:11], v[16:31]
    ds_read_b128 v[88:91], v5 offset:49152
    s_mov_b64 exec, s[56:57]
    ds_read_b128 v[100:103], v119 offset:48128
    ds_read_b128 v[104:107], v119 offset:47616
    s_mov_b64 exec, -1
    v_exp_f32 v54, v54
    v_exp_f32 v55, v55
    v_exp_f32 v56, v56
    v_exp_f32 v57, v57
    v_smfmac_f32_32x32x32_bf16 v[32:47], v[96:99], v[48:55], v112
    v_exp_f32 v58, v58
    v_exp_f32 v59, v59
    v_exp_f32 v60, v60
    v_exp_f32 v61, v61
    v_exp_f32 v62, v62
    v_exp_f32 v63, v63
    v_exp_f32 v64, v64
    v_exp_f32 v65, v65
    s_waitcnt lgkmcnt(0)
    v_smfmac_f32_32x32x32_bf16 v[32:47], v[104:107], v[56:63], v112
    v_exp_f32 v66, v66
    v_exp_f32 v67, v67
    v_exp_f32 v68, v68
    v_exp_f32 v69, v69
    v_mfma_f32_32x32x16_bf16 v[48:63], v[88:91], v[8:11], v[16:31]
    ds_read_b128 v[92:95], v5 offset:50176
    s_mov_b64 exec, s[56:57]
    ds_read_b128 v[96:99], v119 offset:49152
    ds_read_b128 v[104:107], v119 offset:48640
    s_mov_b64 exec, -1
    v_exp_f32 v70, v70
    v_exp_f32 v71, v71
    v_exp_f32 v72, v72
    v_exp_f32 v73, v73
    v_smfmac_f32_32x32x32_bf16 v[32:47], v[100:103], v[64:71], v112
    v_exp_f32 v74, v74
    v_exp_f32 v75, v75
    v_exp_f32 v76, v76
    v_exp_f32 v77, v77
    v_exp_f32 v78, v78
    v_exp_f32 v79, v79
    v_exp_f32 v48, v48
    v_exp_f32 v49, v49
    s_waitcnt lgkmcnt(0)
    v_smfmac_f32_32x32x32_bf16 v[32:47], v[104:107], v[72:79], v112
    v_exp_f32 v50, v50
    v_exp_f32 v51, v51
    v_exp_f32 v52, v52
    v_exp_f32 v53, v53
    v_mfma_f32_32x32x16_bf16 v[64:79], v[92:95], v[8:11], v[16:31]
    ds_read_b128 v[88:91], v5 offset:51200
    s_mov_b64 exec, s[56:57]
    ds_read_b128 v[100:103], v119 offset:50176
    ds_read_b128 v[104:107], v119 offset:49664
    s_mov_b64 exec, -1
    v_exp_f32 v54, v54
    v_exp_f32 v55, v55
    v_exp_f32 v56, v56
    v_exp_f32 v57, v57
    v_smfmac_f32_32x32x32_bf16 v[32:47], v[96:99], v[48:55], v112
    v_exp_f32 v58, v58
    v_exp_f32 v59, v59
    v_exp_f32 v60, v60
    v_exp_f32 v61, v61
    v_exp_f32 v62, v62
    v_exp_f32 v63, v63
    v_exp_f32 v64, v64
    v_exp_f32 v65, v65
    s_waitcnt lgkmcnt(0)
    v_smfmac_f32_32x32x32_bf16 v[32:47], v[104:107], v[56:63], v112
    v_exp_f32 v66, v66
    v_exp_f32 v67, v67
    v_exp_f32 v68, v68
    v_exp_f32 v69, v69
    v_mfma_f32_32x32x16_bf16 v[48:63], v[88:91], v[8:11], v[16:31]
    ds_read_b128 v[92:95], v5 offset:52224
    s_mov_b64 exec, s[56:57]
    ds_read_b128 v[96:99], v119 offset:51200
    ds_read_b128 v[104:107], v119 offset:50688
    s_mov_b64 exec, -1
    v_exp_f32 v70, v70
    v_exp_f32 v71, v71
    v_exp_f32 v72, v72
    v_exp_f32 v73, v73
    v_smfmac_f32_32x32x32_bf16 v[32:47], v[100:103], v[64:71], v112
    v_exp_f32 v74, v74
    v_exp_f32 v75, v75
    v_exp_f32 v76, v76
    v_exp_f32 v77, v77
    v_exp_f32 v78, v78
    v_exp_f32 v79, v79
    v_exp_f32 v48, v48
    v_exp_f32 v49, v49
    s_waitcnt lgkmcnt(0)
    v_smfmac_f32_32x32x32_bf16 v[32:47], v[104:107], v[72:79], v112
    v_exp_f32 v50, v50
    v_exp_f32 v51, v51
    v_exp_f32 v52, v52
    v_exp_f32 v53, v53
    v_mfma_f32_32x32x16_bf16 v[64:79], v[92:95], v[8:11], v[16:31]
    ds_read_b128 v[88:91], v5 offset:53248
    s_mov_b64 exec, s[56:57]
    ds_read_b128 v[100:103], v119 offset:52224
    ds_read_b128 v[104:107], v119 offset:51712
    s_mov_b64 exec, -1
    v_exp_f32 v54, v54
    v_exp_f32 v55, v55
    v_exp_f32 v56, v56
    v_exp_f32 v57, v57
    v_smfmac_f32_32x32x32_bf16 v[32:47], v[96:99], v[48:55], v112
    v_exp_f32 v58, v58
    v_exp_f32 v59, v59
    v_exp_f32 v60, v60
    v_exp_f32 v61, v61
    v_exp_f32 v62, v62
    v_exp_f32 v63, v63
    v_exp_f32 v64, v64
    v_exp_f32 v65, v65
    s_waitcnt lgkmcnt(0)
    v_smfmac_f32_32x32x32_bf16 v[32:47], v[104:107], v[56:63], v112
    v_exp_f32 v66, v66
    v_exp_f32 v67, v67
    v_exp_f32 v68, v68
    v_exp_f32 v69, v69
    v_mfma_f32_32x32x16_bf16 v[48:63], v[88:91], v[8:11], v[16:31]
    ds_read_b128 v[92:95], v5 offset:54272
    s_mov_b64 exec, s[56:57]
    ds_read_b128 v[96:99], v119 offset:53248
    ds_read_b128 v[104:107], v119 offset:52736
    s_mov_b64 exec, -1
    v_exp_f32 v70, v70
    v_exp_f32 v71, v71
    v_exp_f32 v72, v72
    v_exp_f32 v73, v73
    v_smfmac_f32_32x32x32_bf16 v[32:47], v[100:103], v[64:71], v112
    v_exp_f32 v74, v74
    v_exp_f32 v75, v75
    v_exp_f32 v76, v76
    v_exp_f32 v77, v77
    v_exp_f32 v78, v78
    v_exp_f32 v79, v79
    v_exp_f32 v48, v48
    v_exp_f32 v49, v49
    s_waitcnt lgkmcnt(0)
    v_smfmac_f32_32x32x32_bf16 v[32:47], v[104:107], v[72:79], v112
    v_exp_f32 v50, v50
    v_exp_f32 v51, v51
    v_exp_f32 v52, v52
    v_exp_f32 v53, v53
    v_mfma_f32_32x32x16_bf16 v[64:79], v[92:95], v[8:11], v[16:31]
    ds_read_b128 v[88:91], v5 offset:55296
    s_mov_b64 exec, s[56:57]
    ds_read_b128 v[100:103], v119 offset:54272
    ds_read_b128 v[104:107], v119 offset:53760
    s_mov_b64 exec, -1
    v_exp_f32 v54, v54
    v_exp_f32 v55, v55
    v_exp_f32 v56, v56
    v_exp_f32 v57, v57
    v_smfmac_f32_32x32x32_bf16 v[32:47], v[96:99], v[48:55], v112
    v_exp_f32 v58, v58
    v_exp_f32 v59, v59
    v_exp_f32 v60, v60
    v_exp_f32 v61, v61
    v_exp_f32 v62, v62
    v_exp_f32 v63, v63
    v_exp_f32 v64, v64
    v_exp_f32 v65, v65
    s_waitcnt lgkmcnt(0)
    v_smfmac_f32_32x32x32_bf16 v[32:47], v[104:107], v[56:63], v112
    v_exp_f32 v66, v66
    v_exp_f32 v67, v67
    v_exp_f32 v68, v68
    v_exp_f32 v69, v69
    v_mfma_f32_32x32x16_bf16 v[48:63], v[88:91], v[8:11], v[16:31]
    ds_read_b128 v[92:95], v5 offset:56320
    s_mov_b64 exec, s[56:57]
    ds_read_b128 v[96:99], v119 offset:55296
    ds_read_b128 v[104:107], v119 offset:54784
    s_mov_b64 exec, -1
    v_exp_f32 v70, v70
    v_exp_f32 v71, v71
    v_exp_f32 v72, v72
    v_exp_f32 v73, v73
    v_smfmac_f32_32x32x32_bf16 v[32:47], v[100:103], v[64:71], v112
    v_exp_f32 v74, v74
    v_exp_f32 v75, v75
    v_exp_f32 v76, v76
    v_exp_f32 v77, v77
    v_exp_f32 v78, v78
    v_exp_f32 v79, v79
    v_exp_f32 v48, v48
    v_exp_f32 v49, v49
    s_waitcnt lgkmcnt(0)
    v_smfmac_f32_32x32x32_bf16 v[32:47], v[104:107], v[72:79], v112
    v_exp_f32 v50, v50
    v_exp_f32 v51, v51
    v_exp_f32 v52, v52
    v_exp_f32 v53, v53
    v_mfma_f32_32x32x16_bf16 v[64:79], v[92:95], v[8:11], v[16:31]
    ds_read_b128 v[88:91], v5 offset:57344
    s_mov_b64 exec, s[56:57]
    ds_read_b128 v[100:103], v119 offset:56320
    ds_read_b128 v[104:107], v119 offset:55808
    s_mov_b64 exec, -1
    v_exp_f32 v54, v54
    v_exp_f32 v55, v55
    v_exp_f32 v56, v56
    v_exp_f32 v57, v57
    v_smfmac_f32_32x32x32_bf16 v[32:47], v[96:99], v[48:55], v112
    v_exp_f32 v58, v58
    v_exp_f32 v59, v59
    v_exp_f32 v60, v60
    v_exp_f32 v61, v61
    v_exp_f32 v62, v62
    v_exp_f32 v63, v63
    s_setprio 0
    v_exp_f32 v64, v64
    v_exp_f32 v65, v65
    s_waitcnt lgkmcnt(0)
    v_smfmac_f32_32x32x32_bf16 v[32:47], v[104:107], v[56:63], v112
    v_exp_f32 v66, v66
    v_exp_f32 v67, v67
    v_exp_f32 v68, v68
    v_exp_f32 v69, v69
    v_mfma_f32_32x32x16_bf16 v[48:63], v[88:91], v[8:11], v[16:31]
    ds_read_b128 v[92:95], v5 offset:58368
    s_mov_b64 exec, s[56:57]
    ds_read_b128 v[96:99], v119 offset:57344
    ds_read_b128 v[104:107], v119 offset:56832
    s_mov_b64 exec, -1
    v_exp_f32 v70, v70
    v_exp_f32 v71, v71
    v_exp_f32 v72, v72
    v_exp_f32 v73, v73
    v_smfmac_f32_32x32x32_bf16 v[32:47], v[100:103], v[64:71], v112
    v_exp_f32 v74, v74
    v_exp_f32 v75, v75
    v_exp_f32 v76, v76
    v_exp_f32 v77, v77
    v_exp_f32 v78, v78
    v_exp_f32 v79, v79
    v_exp_f32 v48, v48
    v_exp_f32 v49, v49
    s_waitcnt lgkmcnt(0)
    v_smfmac_f32_32x32x32_bf16 v[32:47], v[104:107], v[72:79], v112
    v_exp_f32 v50, v50
    v_exp_f32 v51, v51
    v_exp_f32 v52, v52
    v_exp_f32 v53, v53
    v_mfma_f32_32x32x16_bf16 v[64:79], v[92:95], v[8:11], v[16:31]
    ds_read_b128 v[88:91], v5 offset:59392
    s_mov_b64 exec, s[56:57]
    ds_read_b128 v[100:103], v119 offset:58368
    ds_read_b128 v[104:107], v119 offset:57856
    s_mov_b64 exec, -1
    v_exp_f32 v54, v54
    v_exp_f32 v55, v55
    v_exp_f32 v56, v56
    v_exp_f32 v57, v57
    v_smfmac_f32_32x32x32_bf16 v[32:47], v[96:99], v[48:55], v112
    v_exp_f32 v58, v58
    v_exp_f32 v59, v59
    v_exp_f32 v60, v60
    v_exp_f32 v61, v61
    v_exp_f32 v62, v62
    v_exp_f32 v63, v63
    v_exp_f32 v64, v64
    v_exp_f32 v65, v65
    s_waitcnt lgkmcnt(0)
    v_smfmac_f32_32x32x32_bf16 v[32:47], v[104:107], v[56:63], v112
    v_exp_f32 v66, v66
    v_exp_f32 v67, v67
    v_exp_f32 v68, v68
    v_exp_f32 v69, v69
    v_mfma_f32_32x32x16_bf16 v[48:63], v[88:91], v[8:11], v[16:31]
    ds_read_b128 v[92:95], v5 offset:60416
    s_mov_b64 exec, s[56:57]
    ds_read_b128 v[96:99], v119 offset:59392
    ds_read_b128 v[104:107], v119 offset:58880
    s_mov_b64 exec, -1
    v_exp_f32 v70, v70
    v_exp_f32 v71, v71
    v_exp_f32 v72, v72
    v_exp_f32 v73, v73
    v_smfmac_f32_32x32x32_bf16 v[32:47], v[100:103], v[64:71], v112
    v_exp_f32 v74, v74
    v_exp_f32 v75, v75
    v_exp_f32 v76, v76
    v_exp_f32 v77, v77
    v_exp_f32 v78, v78
    v_exp_f32 v79, v79
    v_exp_f32 v48, v48
    v_exp_f32 v49, v49
    s_waitcnt lgkmcnt(0)
    v_smfmac_f32_32x32x32_bf16 v[32:47], v[104:107], v[72:79], v112
    v_exp_f32 v50, v50
    v_exp_f32 v51, v51
    v_exp_f32 v52, v52
    v_exp_f32 v53, v53
    v_mfma_f32_32x32x16_bf16 v[64:79], v[92:95], v[8:11], v[16:31]
    ds_read_b128 v[88:91], v5 offset:61440
    s_mov_b64 exec, s[56:57]
    ds_read_b128 v[100:103], v119 offset:60416
    ds_read_b128 v[104:107], v119 offset:59904
    s_mov_b64 exec, -1
    v_exp_f32 v54, v54
    v_exp_f32 v55, v55
    v_exp_f32 v56, v56
    v_exp_f32 v57, v57
    v_smfmac_f32_32x32x32_bf16 v[32:47], v[96:99], v[48:55], v112
    v_exp_f32 v58, v58
    v_exp_f32 v59, v59
    v_exp_f32 v60, v60
    v_exp_f32 v61, v61
    v_exp_f32 v62, v62
    v_exp_f32 v63, v63
    v_exp_f32 v64, v64
    v_exp_f32 v65, v65
    s_waitcnt lgkmcnt(0)
    v_smfmac_f32_32x32x32_bf16 v[32:47], v[104:107], v[56:63], v112
    v_exp_f32 v66, v66
    v_exp_f32 v67, v67
    v_exp_f32 v68, v68
    v_exp_f32 v69, v69
    v_mfma_f32_32x32x16_bf16 v[48:63], v[88:91], v[8:11], v[16:31]
    ds_read_b128 v[92:95], v5 offset:62464
    s_mov_b64 exec, s[56:57]
    ds_read_b128 v[96:99], v119 offset:61440
    ds_read_b128 v[104:107], v119 offset:60928
    s_mov_b64 exec, -1
    v_exp_f32 v70, v70
    v_exp_f32 v71, v71
    v_exp_f32 v72, v72
    v_exp_f32 v73, v73
    v_smfmac_f32_32x32x32_bf16 v[32:47], v[100:103], v[64:71], v112
    v_exp_f32 v74, v74
    v_exp_f32 v75, v75
    v_exp_f32 v76, v76
    v_exp_f32 v77, v77
    v_exp_f32 v78, v78
    v_exp_f32 v79, v79
    v_exp_f32 v48, v48
    v_exp_f32 v49, v49
    s_waitcnt lgkmcnt(0)
    v_smfmac_f32_32x32x32_bf16 v[32:47], v[104:107], v[72:79], v112
    v_exp_f32 v50, v50
    v_exp_f32 v51, v51
    v_exp_f32 v52, v52
    v_exp_f32 v53, v53
    v_mfma_f32_32x32x16_bf16 v[64:79], v[92:95], v[8:11], v[16:31]
    ds_read_b128 v[88:91], v5 offset:63488
    s_mov_b64 exec, s[56:57]
    ds_read_b128 v[100:103], v119 offset:62464
    ds_read_b128 v[104:107], v119 offset:61952
    s_mov_b64 exec, -1
    v_exp_f32 v54, v54
    v_exp_f32 v55, v55
    v_exp_f32 v56, v56
    v_exp_f32 v57, v57
    v_smfmac_f32_32x32x32_bf16 v[32:47], v[96:99], v[48:55], v112
    v_exp_f32 v58, v58
    v_exp_f32 v59, v59
    v_exp_f32 v60, v60
    v_exp_f32 v61, v61
    v_exp_f32 v62, v62
    v_exp_f32 v63, v63
    v_exp_f32 v64, v64
    v_exp_f32 v65, v65
    s_waitcnt lgkmcnt(0)
    v_smfmac_f32_32x32x32_bf16 v[32:47], v[104:107], v[56:63], v112
    v_exp_f32 v66, v66
    v_exp_f32 v67, v67
    v_exp_f32 v68, v68
    v_exp_f32 v69, v69
    v_mfma_f32_32x32x16_bf16 v[48:63], v[88:91], v[8:11], v[16:31]
    ds_read_b128 v[92:95], v5 offset:64512
    s_mov_b64 exec, s[56:57]
    ds_read_b128 v[96:99], v119 offset:63488
    ds_read_b128 v[104:107], v119 offset:62976
    s_mov_b64 exec, -1
    v_exp_f32 v70, v70
    v_exp_f32 v71, v71
    v_exp_f32 v72, v72
    v_exp_f32 v73, v73
    v_smfmac_f32_32x32x32_bf16 v[32:47], v[100:103], v[64:71], v112
    v_exp_f32 v74, v74
    v_exp_f32 v75, v75
    v_exp_f32 v76, v76
    v_exp_f32 v77, v77
    v_exp_f32 v78, v78
    v_exp_f32 v79, v79
    v_exp_f32 v48, v48
    v_exp_f32 v49, v49
    s_waitcnt lgkmcnt(0)
    v_smfmac_f32_32x32x32_bf16 v[32:47], v[104:107], v[72:79], v112
    v_exp_f32 v50, v50
    v_exp_f32 v51, v51
    v_exp_f32 v52, v52
    v_exp_f32 v53, v53
    v_mfma_f32_32x32x16_bf16 v[64:79], v[92:95], v[8:11], v[16:31]
    s_mov_b64 exec, s[56:57]
    ds_read_b128 v[100:103], v119 offset:64512
    ds_read_b128 v[104:107], v119 offset:64000
    s_mov_b64 exec, -1
    v_exp_f32 v54, v54
    v_exp_f32 v55, v55
    v_exp_f32 v56, v56
    v_exp_f32 v57, v57
    v_smfmac_f32_32x32x32_bf16 v[32:47], v[96:99], v[48:55], v112
    v_exp_f32 v58, v58
    v_exp_f32 v59, v59
    v_exp_f32 v60, v60
    v_exp_f32 v61, v61
    v_exp_f32 v62, v62
    v_exp_f32 v63, v63
    v_exp_f32 v64, v64
    v_exp_f32 v65, v65
    s_waitcnt lgkmcnt(0)
    v_smfmac_f32_32x32x32_bf16 v[32:47], v[104:107], v[56:63], v112
    v_exp_f32 v66, v66
    v_exp_f32 v67, v67
    v_exp_f32 v68, v68
    v_exp_f32 v69, v69
    s_mov_b64 exec, s[56:57]
    ds_read_b128 v[104:107], v119 offset:65024
    s_mov_b64 exec, -1
    v_exp_f32 v70, v70
    v_exp_f32 v71, v71
    v_exp_f32 v72, v72
    v_exp_f32 v73, v73
    v_smfmac_f32_32x32x32_bf16 v[32:47], v[100:103], v[64:71], v112
    v_exp_f32 v74, v74
    v_exp_f32 v75, v75
    v_exp_f32 v76, v76
    v_exp_f32 v77, v77
    v_exp_f32 v78, v78
    v_exp_f32 v79, v79
    s_mov_b32 s34, 0
    s_waitcnt lgkmcnt(0)
    v_smfmac_f32_32x32x32_bf16 v[32:47], v[104:107], v[72:79], v112
att_check:
    s_nop 11
    v_max3_f32 v48, |v32|, |v33|, |v34|
    v_max3_f32 v48, v48, |v35|, |v36|
    v_max3_f32 v48, v48, |v37|, |v38|
    v_mul_f32 v49, 0x5d800000, v40
    v_max3_f32 v48, v48, |v39|, v49
    v_pk_add_f32 v[50:51], v[32:33], v[34:35]
    v_pk_add_f32 v[52:53], v[36:37], v[38:39]
    v_pk_add_f32 v[50:51], v[50:51], v[52:53]
    v_add_f32 v50, v50, v51
    v_add_f32 v50, v50, v40
    v_fmac_f32 v48, 0, v50
    v_mov_b32 v50, 0x7b800000
    v_cmp_nlt_f32 vcc, v48, v50
    v_rcp_f32 v48, v40
    s_cmp_lg_u32 s34, 0
    s_cbranch_scc1 att_fin
    s_nop 1
    s_cbranch_vccnz att_fallback
att_fin:
    s_add_u32 s23, s43, s49
    s_waitcnt vmcnt(0)
    v_lshlrev_b32 v50, 16, v12
    v_and_b32 v51, 0xffff0000, v12
    v_lshlrev_b32 v52, 16, v13
    v_and_b32 v53, 0xffff0000, v13
    v_lshlrev_b32 v54, 16, v14
    v_and_b32 v55, 0xffff0000, v14
    v_lshlrev_b32 v56, 16, v15
    v_and_b32 v57, 0xffff0000, v15
    v_pk_fma_f32 v[50:51], v[32:33], v[48:49], v[50:51] op_sel_hi:[1,0,1]
    v_pk_fma_f32 v[52:53], v[34:35], v[48:49], v[52:53] op_sel_hi:[1,0,1]
    v_pk_fma_f32 v[54:55], v[36:37], v[48:49], v[54:55] op_sel_hi:[1,0,1]
    v_pk_fma_f32 v[56:57], v[38:39], v[48:49], v[56:57] op_sel_hi:[1,0,1]
    v_cvt_pk_bf16_f32 v88, v50, v51
    v_cvt_pk_bf16_f32 v89, v52, v53
    v_cvt_pk_bf16_f32 v90, v54, v55
    v_cvt_pk_bf16_f32 v91, v56, v57
    buffer_store_dwordx4 v[88:91], v7, s[8:11], s23 offen sc1
    s_cmp_lg_u32 s21, 0
    s_cbranch_scc1 fin_start
    s_lshl_b32 s22, s51, 14
    s_add_u32 s22, s22, s49
    s_lshl_b32 s23, s20, 11
    s_add_u32 s22, s22, s23
    v_add_u32 v2, 0, v118
    v_add_u32 v3, s23, v2
    s_mov_b32 s35, 0
    v_lshlrev_b32 v80, 16, v114
    v_and_b32 v81, 0xffff0000, v114
    v_lshlrev_b32 v82, 16, v115
    v_and_b32 v83, 0xffff0000, v115
    v_lshlrev_b32 v84, 16, v116
    v_and_b32 v85, 0xffff0000, v116
    v_lshlrev_b32 v86, 16, v117
    v_and_b32 v87, 0xffff0000, v117
    s_barrier
    s_sleep 20
out_poll:
    buffer_load_dwordx4 v[16:19], v118, s[8:11], s22 offen sc1
    buffer_load_dwordx4 v[20:23], v118, s[8:11], s22 offen offset:1024 sc1
    s_waitcnt vmcnt(0)
    v_max3_u32 v4, v16, v17, v18
    v_max3_u32 v4, v4, v19, v20
    v_max3_u32 v4, v4, v21, v22
    v_max_u32 v4, v4, v23
    v_cmp_eq_u32 vcc, -1, v4
    s_add_u32 s35, s35, 1
    s_cmp_gt_u32 s35, 262144
    s_cbranch_scc1 out_ok
    s_nop 1
    s_cbranch_vccz out_ok
    s_sleep 4
    s_branch out_poll
out_ok:
    ds_write_b128 v3, v[16:19]
    ds_write_b128 v3, v[20:23] offset:1024
    s_waitcnt lgkmcnt(0)
    s_barrier
    ds_read_b128 v[16:19], v2 offset:0
    ds_read_b128 v[20:23], v2 offset:1024
    ds_read_b128 v[24:27], v2 offset:2048
    ds_read_b128 v[28:31], v2 offset:3072
    ds_read_b128 v[32:35], v2 offset:4096
    ds_read_b128 v[36:39], v2 offset:5120
    ds_read_b128 v[40:43], v2 offset:6144
    ds_read_b128 v[44:47], v2 offset:7168
    ds_read_b128 v[48:51], v2 offset:8192
    ds_read_b128 v[52:55], v2 offset:9216
    ds_read_b128 v[56:59], v2 offset:10240
    ds_read_b128 v[60:63], v2 offset:11264
    ds_read_b128 v[64:67], v2 offset:12288
    ds_read_b128 v[68:71], v2 offset:13312
    ds_read_b128 v[72:75], v2 offset:14336
    ds_read_b128 v[76:79], v2 offset:15360
    s_waitcnt lgkmcnt(15)
    v_mfma_f32_16x16x32_bf16 v[120:123], v[128:131], v[16:19], 0
    v_mfma_f32_16x16x32_bf16 v[124:127], v[132:135], v[16:19], 0
    s_waitcnt lgkmcnt(14)
    v_mfma_f32_16x16x32_bf16 v[120:123], v[136:139], v[20:23], v[120:123]
    v_mfma_f32_16x16x32_bf16 v[124:127], v[140:143], v[20:23], v[124:127]
    s_waitcnt lgkmcnt(13)
    v_mfma_f32_16x16x32_bf16 v[120:123], v[144:147], v[24:27], v[120:123]
    v_mfma_f32_16x16x32_bf16 v[124:127], v[148:151], v[24:27], v[124:127]
    s_waitcnt lgkmcnt(12)
    v_mfma_f32_16x16x32_bf16 v[120:123], v[152:155], v[28:31], v[120:123]
    v_mfma_f32_16x16x32_bf16 v[124:127], v[156:159], v[28:31], v[124:127]
    s_waitcnt lgkmcnt(11)
    v_mfma_f32_16x16x32_bf16 v[120:123], v[160:163], v[32:35], v[120:123]
    v_mfma_f32_16x16x32_bf16 v[124:127], v[164:167], v[32:35], v[124:127]
    s_waitcnt lgkmcnt(10)
    v_mfma_f32_16x16x32_bf16 v[120:123], v[168:171], v[36:39], v[120:123]
    v_mfma_f32_16x16x32_bf16 v[124:127], v[172:175], v[36:39], v[124:127]
    s_waitcnt lgkmcnt(9)
    v_mfma_f32_16x16x32_bf16 v[120:123], v[176:179], v[40:43], v[120:123]
    v_mfma_f32_16x16x32_bf16 v[124:127], v[180:183], v[40:43], v[124:127]
    s_waitcnt lgkmcnt(8)
    v_mfma_f32_16x16x32_bf16 v[120:123], v[184:187], v[44:47], v[120:123]
    v_mfma_f32_16x16x32_bf16 v[124:127], v[188:191], v[44:47], v[124:127]
    s_waitcnt lgkmcnt(7)
    v_mfma_f32_16x16x32_bf16 v[120:123], v[192:195], v[48:51], v[120:123]
    v_mfma_f32_16x16x32_bf16 v[124:127], v[196:199], v[48:51], v[124:127]
    s_waitcnt lgkmcnt(6)
    v_mfma_f32_16x16x32_bf16 v[120:123], v[200:203], v[52:55], v[120:123]
    v_mfma_f32_16x16x32_bf16 v[124:127], v[204:207], v[52:55], v[124:127]
    s_waitcnt lgkmcnt(5)
    v_mfma_f32_16x16x32_bf16 v[120:123], v[208:211], v[56:59], v[120:123]
    v_mfma_f32_16x16x32_bf16 v[124:127], v[212:215], v[56:59], v[124:127]
    s_waitcnt lgkmcnt(4)
    v_mfma_f32_16x16x32_bf16 v[120:123], v[216:219], v[60:63], v[120:123]
    v_mfma_f32_16x16x32_bf16 v[124:127], v[220:223], v[60:63], v[124:127]
    s_waitcnt lgkmcnt(3)
    v_mfma_f32_16x16x32_bf16 v[120:123], v[224:227], v[64:67], v[120:123]
    v_mfma_f32_16x16x32_bf16 v[124:127], v[228:231], v[64:67], v[124:127]
    s_waitcnt lgkmcnt(2)
    v_mfma_f32_16x16x32_bf16 v[120:123], v[232:235], v[68:71], v[120:123]
    v_mfma_f32_16x16x32_bf16 v[124:127], v[236:239], v[68:71], v[124:127]
    s_waitcnt lgkmcnt(1)
    v_mfma_f32_16x16x32_bf16 v[120:123], v[240:243], v[72:75], v[120:123]
    v_mfma_f32_16x16x32_bf16 v[124:127], v[244:247], v[72:75], v[124:127]
    s_waitcnt lgkmcnt(0)
    v_mfma_f32_16x16x32_bf16 v[120:123], v[248:251], v[76:79], v[120:123]
    v_mfma_f32_16x16x32_bf16 v[124:127], v[252:255], v[76:79], v[124:127]
    s_lshl_b32 s22, s20, 6
    s_add_u32 s22, s22, 148480
    v_and_b32 v4, 15, v1
    v_lshl_add_u32 v3, v4, 2, s22
    s_nop 2
    v_pk_add_f32 v[80:81], v[80:81], v[120:121]
    v_pk_add_f32 v[82:83], v[82:83], v[122:123]
    v_pk_add_f32 v[84:85], v[84:85], v[124:125]
    v_pk_add_f32 v[86:87], v[86:87], v[126:127]
    v_pk_mul_f32 v[92:93], v[80:81], v[80:81]
    v_pk_fma_f32 v[92:93], v[82:83], v[82:83], v[92:93]
    v_pk_fma_f32 v[92:93], v[84:85], v[84:85], v[92:93]
    v_pk_fma_f32 v[92:93], v[86:87], v[86:87], v[92:93]
    v_add_u32 v80, 0x10000, v80
    v_add_u32 v82, 0x10000, v82
    v_add_u32 v84, 0x10000, v84
    v_add_u32 v86, 0x10000, v86
    v_and_b32 v80, 0xfffe0000, v80
    v_and_b32 v82, 0xfffe0000, v82
    v_and_b32 v84, 0xfffe0000, v84
    v_and_b32 v86, 0xfffe0000, v86
    v_add_f32 v92, v92, v93
    v_mov_b32 v93, v92
    v_cvt_pk_bf16_f32 v88, v80, v81
    v_cvt_pk_bf16_f32 v89, v82, v83
    v_permlane32_swap_b32 v92, v93
    v_add_f32 v92, v92, v93
    v_mov_b32 v93, v92
    v_cvt_pk_bf16_f32 v90, v84, v85
    v_cvt_pk_bf16_f32 v91, v86, v87
    v_permlane16_swap_b32 v92, v93
    v_add_f32 v92, v92, v93
    ds_write_b32 v3, v92
    buffer_store_dword v88, v6, s[8:11], s60 offen sc1
    buffer_store_dword v89, v6, s[8:11], s61 offen sc1
    buffer_store_dword v90, v6, s[8:11], s62 offen sc1
    buffer_store_dword v91, v6, s[8:11], s63 offen sc1
    s_waitcnt lgkmcnt(0)
    s_barrier
    s_cmp_lg_u32 s20, 7
    s_cbranch_scc1 out_nosum
    v_lshlrev_b32 v3, 2, v1
    v_add_u32 v2, 148480, v3
    ds_read2st64_b32 v[92:93], v2 offset0:0 offset1:1
    s_lshr_b32 s22, s52, 3
    s_lshl_b32 s22, s22, 13
    s_lshl_b32 s23, s51, 6
    s_add_u32 s22, s22, s23
    s_add_u32 s22, s22, 3948544
    s_waitcnt lgkmcnt(0)
    v_add_f32 v92, v92, v93
    v_mov_b32 v93, v92
    s_nop 1
    v_permlane32_swap_b32 v92, v93
    v_add_f32 v92, v92, v93
    v_mov_b32 v93, v92
    s_nop 1
    v_permlane16_swap_b32 v92, v93
    v_add_f32 v92, v92, v93
    s_mov_b64 exec, 0xffff
    buffer_store_dword v92, v3, s[8:11], s22 offen sc1
    s_mov_b64 exec, -1
out_nosum:
    s_mov_b32 s21, 1
    s_mov_b32 s44, 0
    s_mov_b32 s45, 27525120
    s_mov_b32 s46, 3948544
    s_mov_b32 s48, 16777216
    s_mov_b32 s49, 23068672
    s_add_u32 s50, s50, 16384
    s_branch fft_l2
fin_start:
    s_lshl_b32 s22, s51, 15
    s_add_u32 s22, s22, s49
    s_lshl_b32 s23, s20, 12
    s_add_u32 s22, s22, s23
    v_add_u32 v5, s23, v118
    s_lshr_b32 s24, s20, 2
    v_lshrrev_b32 v4, 5, v1
    v_and_b32 v7, 31, v1
    s_lshl_b32 s23, s24, 14
    s_add_u32 s23, s23, 131072
    v_lshlrev_b32 v2, 7, v4
    v_lshl_add_u32 v2, v7, 2, v2
    v_add_u32 v2, s23, v2
    v_and_b32 v3, 16, v1
    v_lshlrev_b32 v3, 10, v3
    v_lshl_add_u32 v3, v4, 8, v3
    v_and_b32 v112, 15, v1
    v_lshl_add_u32 v3, v112, 4, v3
    s_lshl_b32 s23, s24, 13
    v_add_u32 v3, s23, v3
    s_mul_i32 s23, s24, 16896
    s_lshl_b32 s25, s3, 7
    s_add_u32 s23, s23, s25
    s_add_u32 s23, s23, 32768
    v_mul_u32_u24 v113, 528, v7
    v_lshl_add_u32 v113, v4, 4, v113
    v_add_u32 v7, s23, v113
    s_mul_i32 s23, s20, 2112
    s_add_u32 s23, s23, 32768
    v_lshrrev_b32 v113, 4, v1
    v_mul_u32_u24 v113, 528, v113
    v_lshrrev_b32 v4, 2, v112
    v_lshl_add_u32 v113, v4, 7, v113
    v_and_b32 v4, 3, v112
    v_lshl_add_u32 v113, v4, 4, v113
    v_add_u32 v113, s23, v113
    s_mov_b32 s35, 0
    s_barrier
    ds_read2st64_b32 v[16:17], v2 offset0:0 offset1:2
    ds_read2st64_b32 v[18:19], v2 offset0:4 offset1:6
    ds_read2st64_b32 v[20:21], v2 offset0:1 offset1:3
    ds_read2st64_b32 v[22:23], v2 offset0:5 offset1:7
    ds_read2st64_b32 v[24:25], v2 offset0:8 offset1:10
    ds_read2st64_b32 v[26:27], v2 offset0:12 offset1:14
    ds_read2st64_b32 v[28:29], v2 offset0:9 offset1:11
    ds_read2st64_b32 v[30:31], v2 offset0:13 offset1:15
    ds_read2st64_b32 v[32:33], v2 offset0:16 offset1:18
    ds_read2st64_b32 v[34:35], v2 offset0:20 offset1:22
    ds_read2st64_b32 v[36:37], v2 offset0:17 offset1:19
    ds_read2st64_b32 v[38:39], v2 offset0:21 offset1:23
    s_waitcnt lgkmcnt(10)
    v_mfma_f32_32x32x16_bf16 v[64:79], v[128:131], v[16:19], 0
    ds_read2st64_b32 v[40:41], v2 offset0:24 offset1:26
    ds_read2st64_b32 v[42:43], v2 offset0:28 offset1:30
    s_waitcnt lgkmcnt(10)
    v_mfma_f32_32x32x16_bf16 v[64:79], v[132:135], v[20:23], v[64:79]
    ds_read2st64_b32 v[44:45], v2 offset0:25 offset1:27
    ds_read2st64_b32 v[46:47], v2 offset0:29 offset1:31
    s_waitcnt lgkmcnt(10)
    v_mfma_f32_32x32x16_bf16 v[64:79], v[136:139], v[24:27], v[64:79]
    ds_read2st64_b32 v[16:17], v2 offset0:32 offset1:34
    ds_read2st64_b32 v[18:19], v2 offset0:36 offset1:38
    s_waitcnt lgkmcnt(10)
    v_mfma_f32_32x32x16_bf16 v[64:79], v[140:143], v[28:31], v[64:79]
    ds_read2st64_b32 v[20:21], v2 offset0:33 offset1:35
    ds_read2st64_b32 v[22:23], v2 offset0:37 offset1:39
    s_waitcnt lgkmcnt(10)
    v_mfma_f32_32x32x16_bf16 v[64:79], v[144:147], v[32:35], v[64:79]
    ds_read2st64_b32 v[24:25], v2 offset0:40 offset1:42
    ds_read2st64_b32 v[26:27], v2 offset0:44 offset1:46
    s_waitcnt lgkmcnt(10)
    v_mfma_f32_32x32x16_bf16 v[64:79], v[148:151], v[36:39], v[64:79]
    ds_read2st64_b32 v[28:29], v2 offset0:41 offset1:43
    ds_read2st64_b32 v[30:31], v2 offset0:45 offset1:47
    s_waitcnt lgkmcnt(10)
    v_mfma_f32_32x32x16_bf16 v[64:79], v[152:155], v[40:43], v[64:79]
    ds_read2st64_b32 v[32:33], v2 offset0:48 offset1:50
    ds_read2st64_b32 v[34:35], v2 offset0:52 offset1:54
    s_waitcnt lgkmcnt(10)
    v_mfma_f32_32x32x16_bf16 v[64:79], v[156:159], v[44:47], v[64:79]
    ds_read2st64_b32 v[36:37], v2 offset0:49 offset1:51
    ds_read2st64_b32 v[38:39], v2 offset0:53 offset1:55
    s_waitcnt lgkmcnt(10)
    v_mfma_f32_32x32x16_bf16 v[64:79], v[160:163], v[16:19], v[64:79]
    ds_read2st64_b32 v[40:41], v2 offset0:56 offset1:58
    ds_read2st64_b32 v[42:43], v2 offset0:60 offset1:62
    s_waitcnt lgkmcnt(10)
    v_mfma_f32_32x32x16_bf16 v[64:79], v[164:167], v[20:23], v[64:79]
    ds_read2st64_b32 v[44:45], v2 offset0:57 offset1:59
    ds_read2st64_b32 v[46:47], v2 offset0:61 offset1:63
    s_waitcnt lgkmcnt(10)
    v_mfma_f32_32x32x16_bf16 v[64:79], v[168:171], v[24:27], v[64:79]
    s_waitcnt lgkmcnt(8)
    v_mfma_f32_32x32x16_bf16 v[64:79], v[172:175], v[28:31], v[64:79]
    buffer_load_dwordx4 v[48:51], v118, s[8:11], s22 offen offset:0 sc1
    buffer_load_dwordx4 v[52:55], v118, s[8:11], s22 offen offset:1024 sc1
    buffer_load_dwordx4 v[56:59], v118, s[8:11], s22 offen offset:2048 sc1
    buffer_load_dwordx4 v[60:63], v118, s[8:11], s22 offen offset:3072 sc1
    s_waitcnt lgkmcnt(6)
    v_mfma_f32_32x32x16_bf16 v[64:79], v[176:179], v[32:35], v[64:79]
    s_waitcnt lgkmcnt(4)
    v_mfma_f32_32x32x16_bf16 v[64:79], v[180:183], v[36:39], v[64:79]
    s_waitcnt lgkmcnt(2)
    v_mfma_f32_32x32x16_bf16 v[64:79], v[184:187], v[40:43], v[64:79]
    s_waitcnt lgkmcnt(0)
    v_mfma_f32_32x32x16_bf16 v[64:79], v[188:191], v[44:47], v[64:79]
    s_branch fin_chk
fin_poll:
    buffer_load_dwordx4 v[48:51], v118, s[8:11], s22 offen offset:0 sc1
    buffer_load_dwordx4 v[52:55], v118, s[8:11], s22 offen offset:1024 sc1
    buffer_load_dwordx4 v[56:59], v118, s[8:11], s22 offen offset:2048 sc1
    buffer_load_dwordx4 v[60:63], v118, s[8:11], s22 offen offset:3072 sc1
fin_chk:
    s_waitcnt vmcnt(0)
    v_max3_u32 v4, v48, v49, v50
    v_max3_u32 v4, v4, v51, v52
    v_max3_u32 v4, v4, v53, v54
    v_max3_u32 v4, v4, v55, v56
    v_max3_u32 v4, v4, v57, v58
    v_max3_u32 v4, v4, v59, v60
    v_max3_u32 v4, v4, v61, v62
    v_max_u32 v4, v4, v63
    v_cmp_eq_u32 vcc, -1, v4
    s_add_u32 s35, s35, 1
    s_cmp_gt_u32 s35, 262144
    s_cbranch_scc1 fin_ok
    s_nop 1
    s_cbranch_vccz fin_ok
    s_sleep 4
    s_branch fin_poll
fin_ok:
    ds_write_b128 v5, v[48:51] offset:0
    ds_write_b128 v5, v[52:55] offset:1024
    ds_write_b128 v5, v[56:59] offset:2048
    ds_write_b128 v5, v[60:63] offset:3072
    s_waitcnt lgkmcnt(0)
    s_barrier
    ds_read_b128 v[128:131], v3 offset:0
    ds_read_b128 v[132:135], v3 offset:512
    ds_read_b128 v[136:139], v3 offset:1024
    ds_read_b128 v[140:143], v3 offset:1536
    ds_read_b128 v[144:147], v3 offset:2048
    ds_read_b128 v[148:151], v3 offset:2560
    ds_read_b128 v[152:155], v3 offset:3072
    ds_read_b128 v[156:159], v3 offset:3584
    ds_read_b128 v[160:163], v3 offset:4096
    ds_read_b128 v[164:167], v3 offset:4608
    ds_read_b128 v[168:171], v3 offset:5120
    ds_read_b128 v[172:175], v3 offset:5632
    ds_read_b128 v[176:179], v3 offset:6144
    ds_read_b128 v[180:183], v3 offset:6656
    ds_read_b128 v[184:187], v3 offset:7168
    ds_read_b128 v[188:191], v3 offset:7680
    v_lshlrev_b32 v80, 16, v114
    v_and_b32 v84, 0xffff0000, v114
    v_lshlrev_b32 v81, 16, v115
    v_and_b32 v85, 0xffff0000, v115
    v_lshlrev_b32 v82, 16, v116
    v_and_b32 v86, 0xffff0000, v116
    v_lshlrev_b32 v83, 16, v117
    v_and_b32 v87, 0xffff0000, v117
    s_waitcnt lgkmcnt(15)
    v_mfma_f32_32x32x16_bf16 v[64:79], v[192:195], v[128:131], v[64:79]
    s_waitcnt lgkmcnt(14)
    v_mfma_f32_32x32x16_bf16 v[64:79], v[196:199], v[132:135], v[64:79]
    s_waitcnt lgkmcnt(13)
    v_mfma_f32_32x32x16_bf16 v[64:79], v[200:203], v[136:139], v[64:79]
    s_waitcnt lgkmcnt(12)
    v_mfma_f32_32x32x16_bf16 v[64:79], v[204:207], v[140:143], v[64:79]
    s_waitcnt lgkmcnt(11)
    v_mfma_f32_32x32x16_bf16 v[64:79], v[208:211], v[144:147], v[64:79]
    s_waitcnt lgkmcnt(10)
    v_mfma_f32_32x32x16_bf16 v[64:79], v[212:215], v[148:151], v[64:79]
    s_waitcnt lgkmcnt(9)
    v_mfma_f32_32x32x16_bf16 v[64:79], v[216:219], v[152:155], v[64:79]
    s_waitcnt lgkmcnt(8)
    v_mfma_f32_32x32x16_bf16 v[64:79], v[220:223], v[156:159], v[64:79]
    s_waitcnt lgkmcnt(7)
    v_mfma_f32_32x32x16_bf16 v[64:79], v[224:227], v[160:163], v[64:79]
    s_waitcnt lgkmcnt(6)
    v_mfma_f32_32x32x16_bf16 v[64:79], v[228:231], v[164:167], v[64:79]
    s_waitcnt lgkmcnt(5)
    v_mfma_f32_32x32x16_bf16 v[64:79], v[232:235], v[168:171], v[64:79]
    s_waitcnt lgkmcnt(4)
    v_mfma_f32_32x32x16_bf16 v[64:79], v[236:239], v[172:175], v[64:79]
    s_waitcnt lgkmcnt(3)
    v_mfma_f32_32x32x16_bf16 v[64:79], v[240:243], v[176:179], v[64:79]
    s_waitcnt lgkmcnt(2)
    v_mfma_f32_32x32x16_bf16 v[64:79], v[244:247], v[180:183], v[64:79]
    s_waitcnt lgkmcnt(1)
    v_mfma_f32_32x32x16_bf16 v[64:79], v[248:251], v[184:187], v[64:79]
    s_waitcnt lgkmcnt(0)
    v_mfma_f32_32x32x16_bf16 v[64:79], v[252:255], v[188:191], v[64:79]
    s_nop 11
    ds_write_b128 v7, v[64:67] offset:0
    ds_write_b128 v7, v[68:71] offset:32
    ds_write_b128 v7, v[72:75] offset:64
    ds_write_b128 v7, v[76:79] offset:96
    s_waitcnt lgkmcnt(0)
    s_barrier
    ds_read_b128 v[88:91], v113
    ds_read_b128 v[92:95], v113 offset:64
    ds_read_b128 v[96:99], v113 offset:16896
    ds_read_b128 v[100:103], v113 offset:16960
    s_waitcnt lgkmcnt(2)
    v_pk_add_f32 v[80:81], v[80:81], v[88:89]
    v_pk_add_f32 v[82:83], v[82:83], v[90:91]
    v_pk_add_f32 v[84:85], v[84:85], v[92:93]
    v_pk_add_f32 v[86:87], v[86:87], v[94:95]
    s_waitcnt lgkmcnt(0)
    v_pk_add_f32 v[80:81], v[80:81], v[96:97]
    v_pk_add_f32 v[82:83], v[82:83], v[98:99]
    v_pk_add_f32 v[84:85], v[84:85], v[100:101]
    v_pk_add_f32 v[86:87], v[86:87], v[102:103]
    v_cvt_pk_bf16_f32 v104, v80, v84
    v_cvt_pk_bf16_f32 v105, v81, v85
    v_cvt_pk_bf16_f32 v106, v82, v86
    v_cvt_pk_bf16_f32 v107, v83, v87
    buffer_store_dwordx4 v[104:107], v6, s[16:19], s60 offen sc1
main_done:
    s_endpgm
att_fallback:
    s_mov_b32 s34, 1
    v_mov_b32 v4, v5
    v_mov_b32 v80, 0xff800000
    s_mov_b32 s35, 0
att_maxloop:
    ds_read_b128 v[88:91], v4
    v_add_u32 v4, 1024, v4
    s_waitcnt lgkmcnt(0)
    v_mfma_f32_32x32x16_bf16 v[48:63], v[88:91], v[8:11], 0
    s_nop 11
    v_max3_f32 v80, v80, v48, v49
    v_max3_f32 v80, v80, v50, v51
    v_max3_f32 v80, v80, v52, v53
    v_max3_f32 v80, v80, v54, v55
    v_max3_f32 v80, v80, v56, v57
    v_max3_f32 v80, v80, v58, v59
    v_max3_f32 v80, v80, v60, v61
    v_max3_f32 v80, v80, v62, v63
    s_add_u32 s35, s35, 1
    s_cmp_lt_u32 s35, 64
    s_cbranch_scc1 att_maxloop
    v_mov_b32 v81, v80
    s_nop 1
    v_permlane32_swap_b32 v80, v81
    v_max_f32 v80, v80, v81
    v_sub_f32 v16, 0, v80
    v_sub_f32 v17, 0, v80
    v_sub_f32 v18, 0, v80
    v_sub_f32 v19, 0, v80
    v_sub_f32 v20, 0, v80
    v_sub_f32 v21, 0, v80
    v_sub_f32 v22, 0, v80
    v_sub_f32 v23, 0, v80
    v_sub_f32 v24, 0, v80
    v_sub_f32 v25, 0, v80
    v_sub_f32 v26, 0, v80
    v_sub_f32 v27, 0, v80
    v_sub_f32 v28, 0, v80
    v_sub_f32 v29, 0, v80
    v_sub_f32 v30, 0, v80
    v_sub_f32 v31, 0, v80
    v_mov_b32 v32, 0
    v_mov_b32 v33, 0
    v_mov_b32 v34, 0
    v_mov_b32 v35, 0
    v_mov_b32 v36, 0
    v_mov_b32 v37, 0
    v_mov_b32 v38, 0
    v_mov_b32 v39, 0
    v_mov_b32 v40, 0
    v_mov_b32 v41, 0
    v_mov_b32 v42, 0
    v_mov_b32 v43, 0
    v_mov_b32 v44, 0
    v_mov_b32 v45, 0
    v_mov_b32 v46, 0
    v_mov_b32 v47, 0
    v_mov_b32 v4, v5
    v_mov_b32 v64, v119
    s_mov_b32 s35, 0
att_slowloop:
    ds_read_b128 v[88:91], v4
    s_mov_b64 exec, s[56:57]
    ds_read_b128 v[96:99], v64
    ds_read_b128 v[104:107], v64 offset:512
    s_mov_b64 exec, -1
    v_add_u32 v4, 1024, v4
    v_add_u32 v64, 1024, v64
    s_waitcnt lgkmcnt(0)
    v_mfma_f32_32x32x16_bf16 v[48:63], v[88:91], v[8:11], v[16:31]
    s_nop 11
    v_exp_f32 v48, v48
    v_exp_f32 v49, v49
    v_exp_f32 v50, v50
    v_exp_f32 v51, v51
    v_exp_f32 v52, v52
    v_exp_f32 v53, v53
    v_exp_f32 v54, v54
    v_exp_f32 v55, v55
    v_exp_f32 v56, v56
    v_exp_f32 v57, v57
    v_exp_f32 v58, v58
    v_exp_f32 v59, v59
    v_exp_f32 v60, v60
    v_exp_f32 v61, v61
    v_exp_f32 v62, v62
    v_exp_f32 v63, v63
    v_smfmac_f32_32x32x32_bf16 v[32:47], v[96:99], v[48:55], v112
    s_nop 0
    v_smfmac_f32_32x32x32_bf16 v[32:47], v[104:107], v[56:63], v112
    s_add_u32 s35, s35, 1
    s_cmp_lt_u32 s35, 64
    s_cbranch_scc1 att_slowloop
    s_branch att_check
code_end:
.section .rodata,"a"
.p2align 6
.amdhsa_kernel interleave_layers__spectral_gfnet__softmax_full_mha__prompt_kernel
  .amdhsa_next_free_vgpr 256
  .amdhsa_next_free_sgpr 64
  .amdhsa_accum_offset 256
  .amdhsa_group_segment_fixed_size 0
  .amdhsa_kernarg_size 72
  .amdhsa_user_sgpr_count 2
  .amdhsa_user_sgpr_kernarg_segment_ptr 1
  .amdhsa_system_sgpr_workgroup_id_x 1
.end_amdhsa_kernel
```
